```python
import torch

def _softmax(x, axis=-1):
    return torch.softmax(x, dim=axis)
def _gelu(x):
    return torch.nn.functional.gelu(x, approximate="tanh")
def _silu(x):
    return torch.nn.functional.silu(x)
def _sigmoid(x):
    return torch.sigmoid(x)
def _layernorm(x, axis=-1, eps=1e-5):
    m = x.mean(dim=axis, keepdim=True)
    v = x.var(dim=axis, keepdim=True, unbiased=False)
    return (x - m) / torch.sqrt(v + eps)
def _scatter_add(tgt, idx, src, axis=0):
    return tgt.clone().index_add_(axis, idx, src)
def _segment_sum(src, seg, n):
    out = torch.zeros((n,) + src.shape[1:], dtype=src.dtype)
    return out.index_add_(0, seg, src)
def _pad(x, pw):
    flat = tuple(v for pair in reversed(pw) for v in pair)
    return torch.nn.functional.pad(x, flat)

kernel_name = 'parallel_sum__ssm_conv_s4__swiglu_ffn__prompt'

def setup_inputs():

    _w = (lambda a: (lambda t: t.to(torch.bfloat16) if t.is_floating_point() else t)(torch.as_tensor(a)))
    def _A_setup():
        B, L, D, N = 1, 2048, 640, 192
        A_re = -(lambda _x: torch.exp(torch.as_tensor(_x)))((lambda *s: torch.randn(*s, dtype=torch.bfloat16) * 3.2)(D, N))
        A_im = torch.pi * (lambda *s: torch.randn(*s, dtype=torch.bfloat16) * 0.2)(D, N)
        B_re = (lambda *s: torch.randn(*s, dtype=torch.bfloat16) * 0.4)(D, N)
        B_im = (lambda *s: torch.randn(*s, dtype=torch.bfloat16) * 0.4)(D, N)
        C_re = (lambda *s: torch.randn(*s, dtype=torch.bfloat16) * 0.4)(D, N)
        C_im = (lambda *s: torch.randn(*s, dtype=torch.bfloat16) * 0.4)(D, N)
        log_dt = (lambda *s: torch.randn(*s, dtype=torch.bfloat16) * 0.2)(D) * 0.5 - 4.0
        Dskip = (lambda *s: torch.randn(*s, dtype=torch.bfloat16) * 0.4)(D)
        return {
            "u": _w((lambda *s: torch.randn(*s, dtype=torch.bfloat16) * 0.05)(B, L, D)),
            "A_re": _w(A_re),
            "A_im": _w(A_im),
            "B_re": _w(B_re),
            "B_im": _w(B_im),
            "C_re": _w(C_re),
            "C_im": _w(C_im),
            "log_dt": _w(log_dt),
            "Dskip": _w(Dskip),
        }
    _A_in = _A_setup()

    def _B_setup():
        B, S, D, F = 1, 2048, 640, 1536
        return {
            "x": _w((lambda *s: torch.randn(*s, dtype=torch.bfloat16) * 0.05)(B, S, D)),
            "w_gate": _w((lambda *s: torch.randn(*s, dtype=torch.bfloat16) * 0.05)(D, F)),
            "w_up": _w((lambda *s: torch.randn(*s, dtype=torch.bfloat16) * 0.05)(D, F)),
            "w_down": _w((lambda *s: torch.randn(*s, dtype=torch.bfloat16) * 0.05)(F, D)),
        }
    _B_in = _B_setup()

    return {
        "A_u": _A_in["u"],
        "A_A_re": _A_in["A_re"],
        "A_A_im": _A_in["A_im"],
        "A_B_re": _A_in["B_re"],
        "A_B_im": _A_in["B_im"],
        "A_C_re": _A_in["C_re"],
        "A_C_im": _A_in["C_im"],
        "A_log_dt": _A_in["log_dt"],
        "A_Dskip": _A_in["Dskip"],
        "B_x": _B_in["x"],
        "B_w_gate": _B_in["w_gate"],
        "B_w_up": _B_in["w_up"],
        "B_w_down": _B_in["w_down"],
    }

def reference(A_u, A_A_re, A_A_im, A_B_re, A_B_im, A_C_re, A_C_im, A_log_dt, A_Dskip, B_x, B_w_gate, B_w_up, B_w_down):
    def _A_ref(u, A_re, A_im, B_re, B_im, C_re, C_im, log_dt, Dskip):
        Bsz, L, D = u.shape
        dt = torch.exp(log_dt)[:, None]
        A = A_re + 1j * A_im
        Bc = B_re + 1j * B_im
        Cc = C_re + 1j * C_im
        logdA = dt * A
        dB = dt * Bc
        l = (lambda x, dt: x.to(dt))(torch.arange(L), A_re.dtype)
        P = torch.exp(logdA[:, :, None] * l[None, None, :])
        K = torch.einsum("dn,dnl,dn->dl", Cc, P, dB).real
        L2 = 2 * L
        Kp = _pad(K, ((0, 0), (0, L)))
        up = (lambda x, *d: x.permute(*d))(u, 0, 2, 1)
        up = _pad(up, ((0, 0), (0, 0), (0, L)))
        Kf = (lambda x, axes=(-2,-1): torch.fft.rfft2(x.float(), dim=axes))(Kp[:, None, :], axes=(-2, -1))
        Uf = (lambda x, axes=(-2,-1): torch.fft.rfft2(x.float(), dim=axes))(up[:, :, None, :], axes=(-2, -1))
        Yf = Uf * Kf[None, :, :, :]
        y = (lambda x, s, axes=(-2,-1): torch.fft.irfft2(x, s=s, dim=axes).to(torch.bfloat16))(Yf, (1, L2), axes=(-2, -1))[:, :, 0, :L]
        y = (lambda x, *d: x.permute(*d))(y, 0, 2, 1) + u * Dskip[None, None, :]
        return y

    def _B_ref(x, w_gate, w_up, w_down):
        g = _silu(x @ w_gate)
        u = x @ w_up
        return (g * u) @ w_down

    x = A_u
    xn = _layernorm(x, axis=-1)
    return x + _A_ref(xn, A_A_re, A_A_im, A_B_re, A_B_im, A_C_re, A_C_im, A_log_dt, A_Dskip) + _B_ref(xn, B_w_gate, B_w_up, B_w_down)
```

```asm
; @launch grid=(256,1,1) block=(512,1,1) lds=163840
.amdgcn_target "amdgcn-amd-amdhsa--gfx950"
.text
.globl parallel_sum__ssm_conv_s4__swiglu_ffn__prompt_kernel
.p2align 8
.type parallel_sum__ssm_conv_s4__swiglu_ffn__prompt_kernel,@function
parallel_sum__ssm_conv_s4__swiglu_ffn__prompt_kernel:
  s_cmp_lt_u32 s2, 256
  s_cbranch_scc1 Lgo_1
Lexit_2:
  s_endpgm
Lgo_1:
  s_load_dwordx16 s[16:31], s[0:1], 0
  s_load_dwordx16 s[32:47], s[0:1], 64
  v_lshrrev_b32 v2, 6, v0
  v_and_b32 v1, 63, v0
  v_readfirstlane_b32 s3, v2
  v_and_b32 v2, 31, v0
  v_lshlrev_b32 v2, 2, v2
  v_add_u32 v2, 0, v2
  v_mov_b32 v3, 0
  ds_write_b32 v2, v3
  s_cmp_lg_u32 s3, 2
  s_cbranch_scc1 Lw_3
  s_getpc_b64 s[4:5]
Lpc_4:
  s_sub_u32 s4, s4, Lpc_4-parallel_sum__ssm_conv_s4__swiglu_ffn__prompt_kernel
  s_subb_u32 s5, s5, 0
  s_lshr_b32 s6, s2, 3
  s_lshl_b32 s6, s6, 11
  v_lshlrev_b32 v254, 7, v1
  v_add_u32 v254, s6, v254
  s_mov_b32 s6, Lcode_end-parallel_sum__ssm_conv_s4__swiglu_ffn__prompt_kernel-4
  v_min_u32 v254, s6, v254
  s_mov_b64 exec, 0xffff
  global_load_dword v57, v254, s[4:5]
  s_mov_b64 exec, -1
Lw_3:
  s_cmp_ge_u32 s2, 192
  s_cbranch_scc1 LS_7
  s_cmp_lt_u32 s3, 4
  s_cbranch_scc1 Lrest_11
  s_cmp_eq_u32 s3, 6
  s_cbranch_scc1 Ljob_9
  s_cmp_lg_u32 s3, 7
  s_cbranch_scc1 Lch_5
Lload_6:
  s_setprio 1
  s_and_b32 s4, s2, 7
  s_lshr_b32 s5, s2, 3
  s_and_b32 s60, s4, 1
  s_lshl_b32 s60, s60, 3
  s_and_b32 s6, s5, 7
  s_add_u32 s60, s60, s6
  s_lshr_b32 s61, s4, 1
  s_mul_i32 s61, s61, 3
  s_lshr_b32 s6, s5, 3
  s_add_u32 s61, s61, s6
  v_lshrrev_b32 v40, 4, v1
  v_mul_u32_u24 v40, 12288, v40
  v_and_b32 v41, 15, v1
  v_lshl_add_u32 v20, v41, 4, v40
  v_add_u32 v21, 1984, v20
  v_add_u32 v22, 3968, v20
  v_add_u32 v23, 5952, v20
  v_lshrrev_b32 v40, 3, v1
  v_mul_u32_u24 v40, 1280, v40
  v_and_b32 v41, 7, v1
  v_lshrrev_b32 v42, 4, v1
  v_xor_b32 v41, v41, v42
  v_lshl_add_u32 v28, v41, 4, v40
  v_xor_b32 v29, 64, v28
  v_add_u32 v29, 9216, v29
  v_add_u32 v30, 18432, v28
  v_add_u32 v31, 18432, v29
  s_cmp_ge_u32 s60, 10
  s_cselect_b32 s5, 10, 0
  s_sub_u32 s4, s60, s5
  s_lshl_b32 s66, s61, 8
  s_add_u32 s69, s66, 1966080
  s_mul_i32 s5, s4, 196608
  s_add_u32 s64, s66, s5
  s_mul_i32 s10, s60, 163840
  s_add_u32 s11, s10, 1280
  s_lshl_b32 s4, s4, 7
  s_add_u32 s65, s10, s4
  v_lshlrev_b32 v2, 2, v1
  v_mov_b32 v3, 1
  ds_write_b32 v2, v3 offset:1408
  ds_write_b32 v2, v3 offset:1664
  ds_write_b32 v2, v3 offset:1792
  s_waitcnt lgkmcnt(0)
  s_mov_b32 s0, 0x40000
  s_mov_b32 s48, s46
  s_mov_b32 s49, s47
  s_mov_b32 s50, 0x1200000
  s_mov_b32 s51, 0x20000
  v_mov_b32 v36, 0
  v_mov_b32 v27, 0x7ffffff0
  s_mov_b32 s12, s16
  s_mov_b32 s13, s17
  s_mov_b32 s14, 0x280000
  s_mov_b32 s15, 0x20000
  s_mov_b32 s52, s36
  s_mov_b32 s53, s37
  s_mov_b32 s54, 0x1e0000
  s_mov_b32 s55, 0x20000
  s_mov_b32 s56, s38
  s_mov_b32 s57, s39
  s_mov_b32 s58, 0x1e0000
  s_mov_b32 s59, 0x20000
  s_mov_b32 m0, 2048
  s_add_u32 s7, s65, 0
  buffer_load_dwordx4 v28, s[12:15], s7 offen offset:0 lds
  buffer_load_dwordx4 v29, s[12:15], s7 offen offset:1024 lds
  buffer_load_dwordx4 v30, s[12:15], s7 offen offset:2048 lds
  buffer_load_dwordx4 v31, s[12:15], s7 offen offset:3072 lds
  buffer_load_dword v35, v27, s[48:51], 0 offen
  s_mov_b32 m0, 6144
  s_add_u32 s7, s65, 40960
  buffer_load_dwordx4 v28, s[12:15], s7 offen offset:0 lds
  buffer_load_dwordx4 v29, s[12:15], s7 offen offset:1024 lds
  buffer_load_dwordx4 v30, s[12:15], s7 offen offset:2048 lds
  buffer_load_dwordx4 v31, s[12:15], s7 offen offset:3072 lds
  buffer_load_dword v35, v27, s[48:51], 0 offen
  s_barrier
  s_lshr_b32 s5, s2, 3
  s_and_b32 s62, s2, 1
  s_lshl_b32 s62, s62, 4
  s_bfe_u32 s4, s2, 0x10001
  s_lshl_b32 s4, s4, 3
  s_add_u32 s62, s62, s4
  s_and_b32 s6, s5, 7
  s_add_u32 s62, s62, s6
  s_and_b32 s63, s2, 4
  s_lshr_b32 s6, s5, 3
  s_add_u32 s63, s63, s6
  s_mov_b32 m0, 10240
  s_add_u32 s7, s65, 81920
  buffer_load_dwordx4 v28, s[12:15], s7 offen offset:0 lds
  buffer_load_dwordx4 v29, s[12:15], s7 offen offset:1024 lds
  buffer_load_dwordx4 v30, s[12:15], s7 offen offset:2048 lds
  buffer_load_dwordx4 v31, s[12:15], s7 offen offset:3072 lds
  buffer_load_dword v35, v27, s[48:51], 0 offen
  s_mov_b32 m0, 14336
  s_add_u32 s7, s65, 122880
  buffer_load_dwordx4 v28, s[12:15], s7 offen offset:0 lds
  buffer_load_dwordx4 v29, s[12:15], s7 offen offset:1024 lds
  buffer_load_dwordx4 v30, s[12:15], s7 offen offset:2048 lds
  buffer_load_dwordx4 v31, s[12:15], s7 offen offset:3072 lds
  buffer_load_dword v35, v27, s[48:51], 0 offen
  s_add_u32 s65, s65, 128
  s_cmp_ge_u32 s65, s11
  s_cselect_b32 s65, s10, s65
  s_mov_b32 m0, 129536
  s_add_u32 s6, s64, 49152
  buffer_load_dwordx4 v20, s[52:55], s64 offen offset:0 lds
  buffer_load_dwordx4 v21, s[52:55], s64 offen offset:1088 lds
  buffer_load_dwordx4 v22, s[52:55], s64 offen offset:2176 lds
  buffer_load_dwordx4 v23, s[52:55], s64 offen offset:3264 lds
  buffer_load_dword v35, v27, s[48:51], 0 offen
  s_mov_b32 m0, 133904
  s_nop 0
  buffer_load_dwordx4 v20, s[56:59], s64 offen offset:0 lds
  buffer_load_dwordx4 v21, s[56:59], s64 offen offset:1088 lds
  buffer_load_dwordx4 v22, s[56:59], s64 offen offset:2176 lds
  buffer_load_dwordx4 v23, s[56:59], s64 offen offset:3264 lds
  buffer_load_dword v35, v27, s[48:51], 0 offen
  s_mov_b32 m0, 138272
  s_add_u32 s64, s64, 98304
  buffer_load_dwordx4 v20, s[52:55], s6 offen offset:0 lds
  buffer_load_dwordx4 v21, s[52:55], s6 offen offset:1088 lds
  buffer_load_dwordx4 v22, s[52:55], s6 offen offset:2176 lds
  buffer_load_dwordx4 v23, s[52:55], s6 offen offset:3264 lds
  buffer_load_dword v35, v27, s[48:51], 0 offen
  s_mov_b32 m0, 142640
  s_nop 0
  buffer_load_dwordx4 v20, s[56:59], s6 offen offset:0 lds
  buffer_load_dwordx4 v21, s[56:59], s6 offen offset:1088 lds
  buffer_load_dwordx4 v22, s[56:59], s6 offen offset:2176 lds
  buffer_load_dwordx4 v23, s[56:59], s6 offen offset:3264 lds
  buffer_load_dword v35, v27, s[48:51], 0 offen
  s_mov_b32 m0, 1156
  s_nop 0
  buffer_load_dword v27, s[48:51], 0 offen lds
  s_mov_b32 m0, 34816
  s_add_u32 s7, s65, 0
  buffer_load_dwordx4 v28, s[12:15], s7 offen offset:0 lds
  buffer_load_dwordx4 v29, s[12:15], s7 offen offset:1024 lds
  buffer_load_dwordx4 v30, s[12:15], s7 offen offset:2048 lds
  buffer_load_dwordx4 v31, s[12:15], s7 offen offset:3072 lds
  buffer_load_dword v35, v27, s[48:51], 0 offen
  s_mov_b32 m0, 38912
  s_add_u32 s7, s65, 40960
  buffer_load_dwordx4 v28, s[12:15], s7 offen offset:0 lds
  buffer_load_dwordx4 v29, s[12:15], s7 offen offset:1024 lds
  buffer_load_dwordx4 v30, s[12:15], s7 offen offset:2048 lds
  buffer_load_dwordx4 v31, s[12:15], s7 offen offset:3072 lds
  buffer_load_dword v35, v27, s[48:51], 0 offen
  s_mov_b32 m0, 51200
  s_add_u32 s6, s64, 49152
  buffer_load_dwordx4 v20, s[52:55], s64 offen offset:0 lds
  buffer_load_dwordx4 v21, s[52:55], s64 offen offset:1088 lds
  buffer_load_dwordx4 v22, s[52:55], s64 offen offset:2176 lds
  buffer_load_dwordx4 v23, s[52:55], s64 offen offset:3264 lds
  buffer_load_dword v35, v27, s[48:51], 0 offen
  s_mov_b32 m0, 55568
  s_nop 0
  buffer_load_dwordx4 v20, s[56:59], s64 offen offset:0 lds
  buffer_load_dwordx4 v21, s[56:59], s64 offen offset:1088 lds
  buffer_load_dwordx4 v22, s[56:59], s64 offen offset:2176 lds
  buffer_load_dwordx4 v23, s[56:59], s64 offen offset:3264 lds
  buffer_load_dword v35, v27, s[48:51], 0 offen
  s_mov_b32 m0, 59936
  s_add_u32 s64, s64, 98304
  buffer_load_dwordx4 v20, s[52:55], s6 offen offset:0 lds
  buffer_load_dwordx4 v21, s[52:55], s6 offen offset:1088 lds
  buffer_load_dwordx4 v22, s[52:55], s6 offen offset:2176 lds
  buffer_load_dwordx4 v23, s[52:55], s6 offen offset:3264 lds
  buffer_load_dword v35, v27, s[48:51], 0 offen
  s_mov_b32 m0, 64304
  s_cmp_ge_u32 s64, s69
  s_cselect_b32 s64, s66, s64
  buffer_load_dwordx4 v20, s[56:59], s6 offen offset:0 lds
  buffer_load_dwordx4 v21, s[56:59], s6 offen offset:1088 lds
  buffer_load_dwordx4 v22, s[56:59], s6 offen offset:2176 lds
  buffer_load_dwordx4 v23, s[56:59], s6 offen offset:3264 lds
  buffer_load_dword v35, v27, s[48:51], 0 offen
  s_mov_b32 m0, 1160
  s_nop 0
  buffer_load_dword v27, s[48:51], 0 offen lds
  s_mov_b32 m0, 43008
  s_add_u32 s7, s65, 81920
  buffer_load_dwordx4 v28, s[12:15], s7 offen offset:0 lds
  buffer_load_dwordx4 v29, s[12:15], s7 offen offset:1024 lds
  buffer_load_dwordx4 v30, s[12:15], s7 offen offset:2048 lds
  buffer_load_dwordx4 v31, s[12:15], s7 offen offset:3072 lds
  buffer_load_dword v35, v27, s[48:51], 0 offen
  s_mov_b32 m0, 47104
  s_add_u32 s7, s65, 122880
  buffer_load_dwordx4 v28, s[12:15], s7 offen offset:0 lds
  buffer_load_dwordx4 v29, s[12:15], s7 offen offset:1024 lds
  buffer_load_dwordx4 v30, s[12:15], s7 offen offset:2048 lds
  buffer_load_dwordx4 v31, s[12:15], s7 offen offset:3072 lds
  buffer_load_dword v35, v27, s[48:51], 0 offen
  s_add_u32 s65, s65, 128
  s_cmp_ge_u32 s65, s11
  s_cselect_b32 s65, s10, s65
  s_mov_b32 m0, 68672
  s_add_u32 s6, s64, 49152
  buffer_load_dwordx4 v20, s[52:55], s64 offen offset:0 lds
  buffer_load_dwordx4 v21, s[52:55], s64 offen offset:1088 lds
  buffer_load_dwordx4 v22, s[52:55], s64 offen offset:2176 lds
  buffer_load_dwordx4 v23, s[52:55], s64 offen offset:3264 lds
  buffer_load_dword v35, v27, s[48:51], 0 offen
  s_mov_b32 m0, 73040
  s_nop 0
  buffer_load_dwordx4 v20, s[56:59], s64 offen offset:0 lds
  buffer_load_dwordx4 v21, s[56:59], s64 offen offset:1088 lds
  buffer_load_dwordx4 v22, s[56:59], s64 offen offset:2176 lds
  buffer_load_dwordx4 v23, s[56:59], s64 offen offset:3264 lds
  buffer_load_dword v35, v27, s[48:51], 0 offen
  s_mov_b32 m0, 77408
  s_add_u32 s64, s64, 98304
  buffer_load_dwordx4 v20, s[52:55], s6 offen offset:0 lds
  buffer_load_dwordx4 v21, s[52:55], s6 offen offset:1088 lds
  buffer_load_dwordx4 v22, s[52:55], s6 offen offset:2176 lds
  buffer_load_dwordx4 v23, s[52:55], s6 offen offset:3264 lds
  buffer_load_dword v35, v27, s[48:51], 0 offen
  s_mov_b32 m0, 81776
  s_nop 0
  buffer_load_dwordx4 v20, s[56:59], s6 offen offset:0 lds
  buffer_load_dwordx4 v21, s[56:59], s6 offen offset:1088 lds
  buffer_load_dwordx4 v22, s[56:59], s6 offen offset:2176 lds
  buffer_load_dwordx4 v23, s[56:59], s6 offen offset:3264 lds
  buffer_load_dword v35, v27, s[48:51], 0 offen
  s_mov_b32 m0, 1164
  s_nop 0
  buffer_load_dword v27, s[48:51], 0 offen lds
  s_mov_b32 m0, 18432
  s_add_u32 s7, s65, 0
  buffer_load_dwordx4 v28, s[12:15], s7 offen offset:0 lds
  buffer_load_dwordx4 v29, s[12:15], s7 offen offset:1024 lds
  buffer_load_dwordx4 v30, s[12:15], s7 offen offset:2048 lds
  buffer_load_dwordx4 v31, s[12:15], s7 offen offset:3072 lds
  buffer_load_dword v35, v27, s[48:51], 0 offen
  s_mov_b32 m0, 22528
  s_add_u32 s7, s65, 40960
  buffer_load_dwordx4 v28, s[12:15], s7 offen offset:0 lds
  buffer_load_dwordx4 v29, s[12:15], s7 offen offset:1024 lds
  buffer_load_dwordx4 v30, s[12:15], s7 offen offset:2048 lds
  buffer_load_dwordx4 v31, s[12:15], s7 offen offset:3072 lds
  buffer_load_dword v35, v27, s[48:51], 0 offen
  s_mov_b32 m0, 86144
  s_add_u32 s6, s64, 49152
  buffer_load_dwordx4 v20, s[52:55], s64 offen offset:0 lds
  buffer_load_dwordx4 v21, s[52:55], s64 offen offset:1088 lds
  buffer_load_dwordx4 v22, s[52:55], s64 offen offset:2176 lds
  buffer_load_dwordx4 v23, s[52:55], s64 offen offset:3264 lds
  buffer_load_dword v35, v27, s[48:51], 0 offen
  s_mov_b32 m0, 90512
  s_nop 0
  buffer_load_dwordx4 v20, s[56:59], s64 offen offset:0 lds
  buffer_load_dwordx4 v21, s[56:59], s64 offen offset:1088 lds
  buffer_load_dwordx4 v22, s[56:59], s64 offen offset:2176 lds
  buffer_load_dwordx4 v23, s[56:59], s64 offen offset:3264 lds
  buffer_load_dword v35, v27, s[48:51], 0 offen
  s_mov_b32 m0, 94880
  s_add_u32 s64, s64, 98304
  buffer_load_dwordx4 v20, s[52:55], s6 offen offset:0 lds
  buffer_load_dwordx4 v21, s[52:55], s6 offen offset:1088 lds
  buffer_load_dwordx4 v22, s[52:55], s6 offen offset:2176 lds
  buffer_load_dwordx4 v23, s[52:55], s6 offen offset:3264 lds
  buffer_load_dword v35, v27, s[48:51], 0 offen
  s_mov_b32 m0, 99248
  s_cmp_ge_u32 s64, s69
  s_cselect_b32 s64, s66, s64
  buffer_load_dwordx4 v20, s[56:59], s6 offen offset:0 lds
  buffer_load_dwordx4 v21, s[56:59], s6 offen offset:1088 lds
  buffer_load_dwordx4 v22, s[56:59], s6 offen offset:2176 lds
  buffer_load_dwordx4 v23, s[56:59], s6 offen offset:3264 lds
  buffer_load_dword v35, v27, s[48:51], 0 offen
  s_mov_b32 m0, 1168
  s_nop 0
  buffer_load_dword v27, s[48:51], 0 offen lds
  s_mov_b32 m0, 26624
  s_add_u32 s7, s65, 81920
  buffer_load_dwordx4 v28, s[12:15], s7 offen offset:0 lds
  buffer_load_dwordx4 v29, s[12:15], s7 offen offset:1024 lds
  buffer_load_dword v35, v27, s[48:51], 0 offen
  buffer_load_dwordx4 v30, s[12:15], s7 offen offset:2048 lds
  buffer_load_dwordx4 v31, s[12:15], s7 offen offset:3072 lds
  buffer_load_dword v35, v27, s[48:51], 0 offen
  s_mov_b32 m0, 30720
  s_add_u32 s7, s65, 122880
  buffer_load_dwordx4 v28, s[12:15], s7 offen offset:0 lds
  buffer_load_dwordx4 v29, s[12:15], s7 offen offset:1024 lds
  buffer_load_dword v35, v27, s[48:51], 0 offen
  buffer_load_dwordx4 v30, s[12:15], s7 offen offset:2048 lds
  buffer_load_dwordx4 v31, s[12:15], s7 offen offset:3072 lds
  buffer_load_dword v35, v27, s[48:51], 0 offen
  s_add_u32 s65, s65, 128
  s_cmp_ge_u32 s65, s11
  s_cselect_b32 s65, s10, s65
  s_mov_b32 m0, 103616
  s_add_u32 s6, s64, 49152
  buffer_load_dwordx4 v20, s[52:55], s64 offen offset:0 lds
  buffer_load_dwordx4 v21, s[52:55], s64 offen offset:1088 lds
  buffer_load_dword v35, v27, s[48:51], 0 offen
  buffer_load_dwordx4 v22, s[52:55], s64 offen offset:2176 lds
  buffer_load_dwordx4 v23, s[52:55], s64 offen offset:3264 lds
  buffer_load_dword v35, v27, s[48:51], 0 offen
  s_mov_b32 m0, 107984
  s_nop 0
  buffer_load_dwordx4 v20, s[56:59], s64 offen offset:0 lds
  buffer_load_dwordx4 v21, s[56:59], s64 offen offset:1088 lds
  buffer_load_dword v35, v27, s[48:51], 0 offen
  buffer_load_dwordx4 v22, s[56:59], s64 offen offset:2176 lds
  buffer_load_dwordx4 v23, s[56:59], s64 offen offset:3264 lds
  buffer_load_dword v35, v27, s[48:51], 0 offen
  s_mov_b32 m0, 112352
  s_add_u32 s64, s64, 98304
  ds_read_b128 v[40:43], v36 offset:1696
  buffer_load_dwordx4 v20, s[52:55], s6 offen offset:0 lds
  buffer_load_dwordx4 v21, s[52:55], s6 offen offset:1088 lds
  buffer_load_dword v35, v27, s[48:51], 0 offen
  buffer_load_dwordx4 v22, s[52:55], s6 offen offset:2176 lds
  buffer_load_dwordx4 v23, s[52:55], s6 offen offset:3264 lds
  buffer_load_dword v35, v27, s[48:51], 0 offen
  s_mov_b32 m0, 116720
  s_nop 0
  buffer_load_dwordx4 v20, s[56:59], s6 offen offset:0 lds
  buffer_load_dwordx4 v21, s[56:59], s6 offen offset:1088 lds
  buffer_load_dword v35, v27, s[48:51], 0 offen
  buffer_load_dwordx4 v22, s[56:59], s6 offen offset:2176 lds
  buffer_load_dwordx4 v23, s[56:59], s6 offen offset:3264 lds
  buffer_load_dword v35, v27, s[48:51], 0 offen
  s_mov_b32 m0, 1172
  s_nop 0
  buffer_load_dword v27, s[48:51], 0 offen lds
  s_waitcnt lgkmcnt(0)
  v_or_b32 v39, v40, v41
  v_or3_b32 v39, v39, v42, v43
  s_nop 0
  v_readfirstlane_b32 s67, v39
  s_cmp_eq_u32 s67, 0
  s_cbranch_scc1 Llg_13
  v_mov_b32 v38, 1696
  s_call_b64 s[34:35], Llw_12
Llg_13:
  s_mov_b32 m0, 129536
  s_add_u32 s6, s64, 49152
  buffer_load_dwordx4 v20, s[52:55], s64 offen offset:0 lds
  buffer_load_dwordx4 v21, s[52:55], s64 offen offset:1088 lds
  buffer_load_dword v35, v27, s[48:51], 0 offen
  buffer_load_dwordx4 v22, s[52:55], s64 offen offset:2176 lds
  buffer_load_dwordx4 v23, s[52:55], s64 offen offset:3264 lds
  buffer_load_dword v35, v27, s[48:51], 0 offen
  s_mov_b32 m0, 133904
  s_nop 0
  buffer_load_dwordx4 v20, s[56:59], s64 offen offset:0 lds
  buffer_load_dwordx4 v21, s[56:59], s64 offen offset:1088 lds
  buffer_load_dword v35, v27, s[48:51], 0 offen
  buffer_load_dwordx4 v22, s[56:59], s64 offen offset:2176 lds
  buffer_load_dwordx4 v23, s[56:59], s64 offen offset:3264 lds
  buffer_load_dword v35, v27, s[48:51], 0 offen
  s_mov_b32 m0, 138272
  s_add_u32 s64, s64, 98304
  ds_read_b128 v[40:43], v36 offset:1712
  buffer_load_dwordx4 v20, s[52:55], s6 offen offset:0 lds
  buffer_load_dwordx4 v21, s[52:55], s6 offen offset:1088 lds
  buffer_load_dword v35, v27, s[48:51], 0 offen
  buffer_load_dwordx4 v22, s[52:55], s6 offen offset:2176 lds
  buffer_load_dwordx4 v23, s[52:55], s6 offen offset:3264 lds
  buffer_load_dword v35, v27, s[48:51], 0 offen
  s_mov_b32 m0, 142640
  s_cmp_ge_u32 s64, s69
  s_cselect_b32 s64, s66, s64
  buffer_load_dwordx4 v20, s[56:59], s6 offen offset:0 lds
  buffer_load_dwordx4 v21, s[56:59], s6 offen offset:1088 lds
  buffer_load_dword v35, v27, s[48:51], 0 offen
  buffer_load_dwordx4 v22, s[56:59], s6 offen offset:2176 lds
  buffer_load_dwordx4 v23, s[56:59], s6 offen offset:3264 lds
  buffer_load_dword v35, v27, s[48:51], 0 offen
  s_mov_b32 m0, 1176
  s_nop 0
  buffer_load_dword v27, s[48:51], 0 offen lds
  s_waitcnt lgkmcnt(0)
  v_or_b32 v39, v40, v41
  v_or3_b32 v39, v39, v42, v43
  s_nop 0
  v_readfirstlane_b32 s67, v39
  s_cmp_eq_u32 s67, 0
  s_cbranch_scc1 Llg_14
  v_mov_b32 v38, 1712
  s_call_b64 s[34:35], Llw_12
Llg_14:
  s_mov_b32 m0, 2048
  s_add_u32 s7, s65, 0
  buffer_load_dwordx4 v28, s[12:15], s7 offen offset:0 lds
  buffer_load_dwordx4 v29, s[12:15], s7 offen offset:1024 lds
  buffer_load_dword v35, v27, s[48:51], 0 offen
  buffer_load_dwordx4 v30, s[12:15], s7 offen offset:2048 lds
  buffer_load_dwordx4 v31, s[12:15], s7 offen offset:3072 lds
  buffer_load_dword v35, v27, s[48:51], 0 offen
  s_mov_b32 m0, 6144
  s_add_u32 s7, s65, 40960
  buffer_load_dwordx4 v28, s[12:15], s7 offen offset:0 lds
  buffer_load_dwordx4 v29, s[12:15], s7 offen offset:1024 lds
  buffer_load_dword v35, v27, s[48:51], 0 offen
  buffer_load_dwordx4 v30, s[12:15], s7 offen offset:2048 lds
  buffer_load_dwordx4 v31, s[12:15], s7 offen offset:3072 lds
  buffer_load_dword v35, v27, s[48:51], 0 offen
  s_mov_b32 m0, 10240
  s_add_u32 s7, s65, 81920
  buffer_load_dwordx4 v28, s[12:15], s7 offen offset:0 lds
  buffer_load_dwordx4 v29, s[12:15], s7 offen offset:1024 lds
  buffer_load_dword v35, v27, s[48:51], 0 offen
  buffer_load_dwordx4 v30, s[12:15], s7 offen offset:2048 lds
  buffer_load_dwordx4 v31, s[12:15], s7 offen offset:3072 lds
  buffer_load_dword v35, v27, s[48:51], 0 offen
  s_mov_b32 m0, 14336
  s_add_u32 s7, s65, 122880
  buffer_load_dwordx4 v28, s[12:15], s7 offen offset:0 lds
  buffer_load_dwordx4 v29, s[12:15], s7 offen offset:1024 lds
  buffer_load_dword v35, v27, s[48:51], 0 offen
  buffer_load_dwordx4 v30, s[12:15], s7 offen offset:2048 lds
  buffer_load_dwordx4 v31, s[12:15], s7 offen offset:3072 lds
  buffer_load_dword v35, v27, s[48:51], 0 offen
  s_add_u32 s65, s65, 128
  s_cmp_ge_u32 s65, s11
  s_cselect_b32 s65, s10, s65
  s_mov_b32 m0, 51200
  s_add_u32 s6, s64, 49152
  buffer_load_dwordx4 v20, s[52:55], s64 offen offset:0 lds
  buffer_load_dwordx4 v21, s[52:55], s64 offen offset:1088 lds
  buffer_load_dword v35, v27, s[48:51], 0 offen
  buffer_load_dwordx4 v22, s[52:55], s64 offen offset:2176 lds
  buffer_load_dwordx4 v23, s[52:55], s64 offen offset:3264 lds
  buffer_load_dword v35, v27, s[48:51], 0 offen
  s_mov_b32 m0, 55568
  s_nop 0
  buffer_load_dwordx4 v20, s[56:59], s64 offen offset:0 lds
  buffer_load_dwordx4 v21, s[56:59], s64 offen offset:1088 lds
  buffer_load_dword v35, v27, s[48:51], 0 offen
  buffer_load_dwordx4 v22, s[56:59], s64 offen offset:2176 lds
  buffer_load_dwordx4 v23, s[56:59], s64 offen offset:3264 lds
  buffer_load_dword v35, v27, s[48:51], 0 offen
  s_mov_b32 m0, 59936
  s_add_u32 s64, s64, 98304
  ds_read_b128 v[40:43], v36 offset:1728
  buffer_load_dwordx4 v20, s[52:55], s6 offen offset:0 lds
  buffer_load_dwordx4 v21, s[52:55], s6 offen offset:1088 lds
  buffer_load_dword v35, v27, s[48:51], 0 offen
  buffer_load_dwordx4 v22, s[52:55], s6 offen offset:2176 lds
  buffer_load_dwordx4 v23, s[52:55], s6 offen offset:3264 lds
  buffer_load_dword v35, v27, s[48:51], 0 offen
  s_mov_b32 m0, 64304
  s_nop 0
  buffer_load_dwordx4 v20, s[56:59], s6 offen offset:0 lds
  buffer_load_dwordx4 v21, s[56:59], s6 offen offset:1088 lds
  buffer_load_dword v35, v27, s[48:51], 0 offen
  buffer_load_dwordx4 v22, s[56:59], s6 offen offset:2176 lds
  buffer_load_dwordx4 v23, s[56:59], s6 offen offset:3264 lds
  buffer_load_dword v35, v27, s[48:51], 0 offen
  s_mov_b32 m0, 1180
  s_nop 0
  buffer_load_dword v27, s[48:51], 0 offen lds
  s_waitcnt lgkmcnt(0)
  v_or_b32 v39, v40, v41
  v_or3_b32 v39, v39, v42, v43
  s_nop 0
  v_readfirstlane_b32 s67, v39
  s_cmp_eq_u32 s67, 0
  s_cbranch_scc1 Llg_15
  v_mov_b32 v38, 1728
  s_call_b64 s[34:35], Llw_12
Llg_15:
  s_mov_b32 m0, 68672
  s_add_u32 s6, s64, 49152
  buffer_load_dwordx4 v20, s[52:55], s64 offen offset:0 lds
  buffer_load_dwordx4 v21, s[52:55], s64 offen offset:1088 lds
  buffer_load_dword v35, v27, s[48:51], 0 offen
  buffer_load_dwordx4 v22, s[52:55], s64 offen offset:2176 lds
  buffer_load_dwordx4 v23, s[52:55], s64 offen offset:3264 lds
  buffer_load_dword v35, v27, s[48:51], 0 offen
  s_mov_b32 m0, 73040
  s_nop 0
  buffer_load_dwordx4 v20, s[56:59], s64 offen offset:0 lds
  buffer_load_dwordx4 v21, s[56:59], s64 offen offset:1088 lds
  buffer_load_dword v35, v27, s[48:51], 0 offen
  buffer_load_dwordx4 v22, s[56:59], s64 offen offset:2176 lds
  buffer_load_dwordx4 v23, s[56:59], s64 offen offset:3264 lds
  buffer_load_dword v35, v27, s[48:51], 0 offen
  s_mov_b32 m0, 77408
  s_add_u32 s64, s64, 98304
  ds_read_b128 v[40:43], v36 offset:1744
  buffer_load_dwordx4 v20, s[52:55], s6 offen offset:0 lds
  buffer_load_dwordx4 v21, s[52:55], s6 offen offset:1088 lds
  buffer_load_dword v35, v27, s[48:51], 0 offen
  buffer_load_dwordx4 v22, s[52:55], s6 offen offset:2176 lds
  buffer_load_dwordx4 v23, s[52:55], s6 offen offset:3264 lds
  buffer_load_dword v35, v27, s[48:51], 0 offen
  s_mov_b32 m0, 81776
  s_cmp_ge_u32 s64, s69
  s_cselect_b32 s64, s66, s64
  buffer_load_dwordx4 v20, s[56:59], s6 offen offset:0 lds
  buffer_load_dwordx4 v21, s[56:59], s6 offen offset:1088 lds
  buffer_load_dword v35, v27, s[48:51], 0 offen
  buffer_load_dwordx4 v22, s[56:59], s6 offen offset:2176 lds
  buffer_load_dwordx4 v23, s[56:59], s6 offen offset:3264 lds
  buffer_load_dword v35, v27, s[48:51], 0 offen
  s_mov_b32 m0, 1184
  s_nop 0
  buffer_load_dword v27, s[48:51], 0 offen lds
  s_waitcnt lgkmcnt(0)
  v_or_b32 v39, v40, v41
  v_or3_b32 v39, v39, v42, v43
  s_nop 0
  v_readfirstlane_b32 s67, v39
  s_cmp_eq_u32 s67, 0
  s_cbranch_scc1 Llg_16
  v_mov_b32 v38, 1744
  s_call_b64 s[34:35], Llw_12
Llg_16:
  s_mov_b32 m0, 34816
  s_add_u32 s7, s65, 0
  buffer_load_dwordx4 v28, s[12:15], s7 offen offset:0 lds
  buffer_load_dwordx4 v29, s[12:15], s7 offen offset:1024 lds
  buffer_load_dword v35, v27, s[48:51], 0 offen
  buffer_load_dwordx4 v30, s[12:15], s7 offen offset:2048 lds
  buffer_load_dwordx4 v31, s[12:15], s7 offen offset:3072 lds
  buffer_load_dword v35, v27, s[48:51], 0 offen
  s_mov_b32 m0, 38912
  s_add_u32 s7, s65, 40960
  buffer_load_dwordx4 v28, s[12:15], s7 offen offset:0 lds
  buffer_load_dwordx4 v29, s[12:15], s7 offen offset:1024 lds
  buffer_load_dword v35, v27, s[48:51], 0 offen
  buffer_load_dwordx4 v30, s[12:15], s7 offen offset:2048 lds
  buffer_load_dwordx4 v31, s[12:15], s7 offen offset:3072 lds
  buffer_load_dword v35, v27, s[48:51], 0 offen
  s_mov_b32 m0, 43008
  s_add_u32 s7, s65, 81920
  buffer_load_dwordx4 v28, s[12:15], s7 offen offset:0 lds
  buffer_load_dwordx4 v29, s[12:15], s7 offen offset:1024 lds
  buffer_load_dword v35, v27, s[48:51], 0 offen
  buffer_load_dwordx4 v30, s[12:15], s7 offen offset:2048 lds
  buffer_load_dwordx4 v31, s[12:15], s7 offen offset:3072 lds
  buffer_load_dword v35, v27, s[48:51], 0 offen
  s_mov_b32 m0, 47104
  s_add_u32 s7, s65, 122880
  buffer_load_dwordx4 v28, s[12:15], s7 offen offset:0 lds
  buffer_load_dwordx4 v29, s[12:15], s7 offen offset:1024 lds
  buffer_load_dword v35, v27, s[48:51], 0 offen
  buffer_load_dwordx4 v30, s[12:15], s7 offen offset:2048 lds
  buffer_load_dwordx4 v31, s[12:15], s7 offen offset:3072 lds
  buffer_load_dword v35, v27, s[48:51], 0 offen
  s_add_u32 s65, s65, 128
  s_cmp_ge_u32 s65, s11
  s_cselect_b32 s65, s10, s65
  s_mov_b32 m0, 86144
  s_add_u32 s6, s64, 49152
  buffer_load_dwordx4 v20, s[52:55], s64 offen offset:0 lds
  buffer_load_dwordx4 v21, s[52:55], s64 offen offset:1088 lds
  buffer_load_dword v35, v27, s[48:51], 0 offen
  buffer_load_dwordx4 v22, s[52:55], s64 offen offset:2176 lds
  buffer_load_dwordx4 v23, s[52:55], s64 offen offset:3264 lds
  buffer_load_dword v35, v27, s[48:51], 0 offen
  s_mov_b32 m0, 90512
  s_nop 0
  buffer_load_dwordx4 v20, s[56:59], s64 offen offset:0 lds
  buffer_load_dwordx4 v21, s[56:59], s64 offen offset:1088 lds
  buffer_load_dword v35, v27, s[48:51], 0 offen
  buffer_load_dwordx4 v22, s[56:59], s64 offen offset:2176 lds
  buffer_load_dwordx4 v23, s[56:59], s64 offen offset:3264 lds
  buffer_load_dword v35, v27, s[48:51], 0 offen
  s_mov_b32 m0, 94880
  s_add_u32 s64, s64, 98304
  ds_read_b128 v[40:43], v36 offset:1760
  buffer_load_dwordx4 v20, s[52:55], s6 offen offset:0 lds
  buffer_load_dwordx4 v21, s[52:55], s6 offen offset:1088 lds
  buffer_load_dword v35, v27, s[48:51], 0 offen
  buffer_load_dwordx4 v22, s[52:55], s6 offen offset:2176 lds
  buffer_load_dwordx4 v23, s[52:55], s6 offen offset:3264 lds
  buffer_load_dword v35, v27, s[48:51], 0 offen
  s_mov_b32 m0, 99248
  s_nop 0
  buffer_load_dwordx4 v20, s[56:59], s6 offen offset:0 lds
  buffer_load_dwordx4 v21, s[56:59], s6 offen offset:1088 lds
  buffer_load_dword v35, v27, s[48:51], 0 offen
  buffer_load_dwordx4 v22, s[56:59], s6 offen offset:2176 lds
  buffer_load_dwordx4 v23, s[56:59], s6 offen offset:3264 lds
  buffer_load_dword v35, v27, s[48:51], 0 offen
  s_mov_b32 m0, 1188
  s_nop 0
  buffer_load_dword v27, s[48:51], 0 offen lds
  s_waitcnt lgkmcnt(0)
  v_or_b32 v39, v40, v41
  v_or3_b32 v39, v39, v42, v43
  s_nop 0
  v_readfirstlane_b32 s67, v39
  s_cmp_eq_u32 s67, 0
  s_cbranch_scc1 Llg_17
  v_mov_b32 v38, 1760
  s_call_b64 s[34:35], Llw_12
Llg_17:
  s_mov_b32 m0, 103616
  s_add_u32 s6, s64, 49152
  buffer_load_dwordx4 v20, s[52:55], s64 offen offset:0 lds
  buffer_load_dwordx4 v21, s[52:55], s64 offen offset:1088 lds
  buffer_load_dword v35, v27, s[48:51], 0 offen
  buffer_load_dwordx4 v22, s[52:55], s64 offen offset:2176 lds
  buffer_load_dwordx4 v23, s[52:55], s64 offen offset:3264 lds
  buffer_load_dword v35, v27, s[48:51], 0 offen
  s_mov_b32 m0, 107984
  s_nop 0
  buffer_load_dwordx4 v20, s[56:59], s64 offen offset:0 lds
  buffer_load_dwordx4 v21, s[56:59], s64 offen offset:1088 lds
  buffer_load_dword v35, v27, s[48:51], 0 offen
  buffer_load_dwordx4 v22, s[56:59], s64 offen offset:2176 lds
  buffer_load_dwordx4 v23, s[56:59], s64 offen offset:3264 lds
  buffer_load_dword v35, v27, s[48:51], 0 offen
  s_mov_b32 m0, 112352
  s_add_u32 s64, s64, 98304
  ds_read_b128 v[40:43], v36 offset:1776
  buffer_load_dwordx4 v20, s[52:55], s6 offen offset:0 lds
  buffer_load_dwordx4 v21, s[52:55], s6 offen offset:1088 lds
  buffer_load_dword v35, v27, s[48:51], 0 offen
  buffer_load_dwordx4 v22, s[52:55], s6 offen offset:2176 lds
  buffer_load_dwordx4 v23, s[52:55], s6 offen offset:3264 lds
  buffer_load_dword v35, v27, s[48:51], 0 offen
  s_mov_b32 m0, 116720
  s_cmp_ge_u32 s64, s69
  s_cselect_b32 s64, s66, s64
  buffer_load_dwordx4 v20, s[56:59], s6 offen offset:0 lds
  buffer_load_dwordx4 v21, s[56:59], s6 offen offset:1088 lds
  buffer_load_dword v35, v27, s[48:51], 0 offen
  buffer_load_dwordx4 v22, s[56:59], s6 offen offset:2176 lds
  buffer_load_dwordx4 v23, s[56:59], s6 offen offset:3264 lds
  buffer_load_dword v35, v27, s[48:51], 0 offen
  s_mov_b32 m0, 1192
  s_nop 0
  buffer_load_dword v27, s[48:51], 0 offen lds
  s_waitcnt lgkmcnt(0)
  v_or_b32 v39, v40, v41
  v_or3_b32 v39, v39, v42, v43
  s_nop 0
  v_readfirstlane_b32 s67, v39
  s_cmp_eq_u32 s67, 0
  s_cbranch_scc1 Llg_18
  v_mov_b32 v38, 1776
  s_call_b64 s[34:35], Llw_12
Llg_18:
  s_mov_b32 m0, 18432
  s_add_u32 s7, s65, 0
  buffer_load_dwordx4 v28, s[12:15], s7 offen offset:0 lds
  buffer_load_dwordx4 v29, s[12:15], s7 offen offset:1024 lds
  buffer_load_dword v35, v27, s[48:51], 0 offen
  buffer_load_dwordx4 v30, s[12:15], s7 offen offset:2048 lds
  buffer_load_dwordx4 v31, s[12:15], s7 offen offset:3072 lds
  buffer_load_dword v35, v27, s[48:51], 0 offen
  s_mov_b32 m0, 22528
  s_add_u32 s7, s65, 40960
  buffer_load_dwordx4 v28, s[12:15], s7 offen offset:0 lds
  buffer_load_dwordx4 v29, s[12:15], s7 offen offset:1024 lds
  buffer_load_dword v35, v27, s[48:51], 0 offen
  buffer_load_dwordx4 v30, s[12:15], s7 offen offset:2048 lds
  buffer_load_dwordx4 v31, s[12:15], s7 offen offset:3072 lds
  buffer_load_dword v35, v27, s[48:51], 0 offen
  s_mov_b32 m0, 26624
  s_add_u32 s7, s65, 81920
  buffer_load_dwordx4 v28, s[12:15], s7 offen offset:0 lds
  buffer_load_dwordx4 v29, s[12:15], s7 offen offset:1024 lds
  buffer_load_dword v35, v27, s[48:51], 0 offen
  buffer_load_dwordx4 v30, s[12:15], s7 offen offset:2048 lds
  buffer_load_dwordx4 v31, s[12:15], s7 offen offset:3072 lds
  buffer_load_dword v35, v27, s[48:51], 0 offen
  s_mov_b32 m0, 30720
  s_add_u32 s7, s65, 122880
  buffer_load_dwordx4 v28, s[12:15], s7 offen offset:0 lds
  buffer_load_dwordx4 v29, s[12:15], s7 offen offset:1024 lds
  buffer_load_dword v35, v27, s[48:51], 0 offen
  buffer_load_dwordx4 v30, s[12:15], s7 offen offset:2048 lds
  buffer_load_dwordx4 v31, s[12:15], s7 offen offset:3072 lds
  buffer_load_dword v35, v27, s[48:51], 0 offen
  s_add_u32 s65, s65, 128
  s_cmp_ge_u32 s65, s11
  s_cselect_b32 s65, s10, s65
  s_mov_b32 m0, 129536
  s_add_u32 s6, s64, 49152
  buffer_load_dwordx4 v20, s[52:55], s64 offen offset:0 lds
  buffer_load_dwordx4 v21, s[52:55], s64 offen offset:1088 lds
  buffer_load_dword v35, v27, s[48:51], 0 offen
  buffer_load_dwordx4 v22, s[52:55], s64 offen offset:2176 lds
  buffer_load_dwordx4 v23, s[52:55], s64 offen offset:3264 lds
  buffer_load_dword v35, v27, s[48:51], 0 offen
  s_mov_b32 m0, 133904
  s_nop 0
  buffer_load_dwordx4 v20, s[56:59], s64 offen offset:0 lds
  buffer_load_dwordx4 v21, s[56:59], s64 offen offset:1088 lds
  buffer_load_dword v35, v27, s[48:51], 0 offen
  buffer_load_dwordx4 v22, s[56:59], s64 offen offset:2176 lds
  buffer_load_dwordx4 v23, s[56:59], s64 offen offset:3264 lds
  buffer_load_dword v35, v27, s[48:51], 0 offen
  s_mov_b32 m0, 138272
  s_add_u32 s64, s64, 98304
  ds_read_b128 v[40:43], v36 offset:1792
  buffer_load_dwordx4 v20, s[52:55], s6 offen offset:0 lds
  buffer_load_dwordx4 v21, s[52:55], s6 offen offset:1088 lds
  buffer_load_dword v35, v27, s[48:51], 0 offen
  buffer_load_dwordx4 v22, s[52:55], s6 offen offset:2176 lds
  buffer_load_dwordx4 v23, s[52:55], s6 offen offset:3264 lds
  buffer_load_dword v35, v27, s[48:51], 0 offen
  s_mov_b32 m0, 142640
  s_nop 0
  buffer_load_dwordx4 v20, s[56:59], s6 offen offset:0 lds
  buffer_load_dwordx4 v21, s[56:59], s6 offen offset:1088 lds
  buffer_load_dword v35, v27, s[48:51], 0 offen
  buffer_load_dwordx4 v22, s[56:59], s6 offen offset:2176 lds
  buffer_load_dwordx4 v23, s[56:59], s6 offen offset:3264 lds
  buffer_load_dword v35, v27, s[48:51], 0 offen
  s_mov_b32 m0, 1196
  s_nop 0
  buffer_load_dword v27, s[48:51], 0 offen lds
  s_waitcnt lgkmcnt(0)
  v_or_b32 v39, v40, v41
  v_or3_b32 v39, v39, v42, v43
  s_nop 0
  v_readfirstlane_b32 s67, v39
  s_cmp_eq_u32 s67, 0
  s_cbranch_scc1 Llg_19
  v_mov_b32 v38, 1792
  s_call_b64 s[34:35], Llw_12
Llg_19:
  s_mov_b32 m0, 51200
  s_add_u32 s6, s64, 49152
  buffer_load_dwordx4 v20, s[52:55], s64 offen offset:0 lds
  buffer_load_dwordx4 v21, s[52:55], s64 offen offset:1088 lds
  buffer_load_dword v35, v27, s[48:51], 0 offen
  buffer_load_dwordx4 v22, s[52:55], s64 offen offset:2176 lds
  buffer_load_dwordx4 v23, s[52:55], s64 offen offset:3264 lds
  buffer_load_dword v35, v27, s[48:51], 0 offen
  s_mov_b32 m0, 55568
  s_nop 0
  buffer_load_dwordx4 v20, s[56:59], s64 offen offset:0 lds
  buffer_load_dwordx4 v21, s[56:59], s64 offen offset:1088 lds
  buffer_load_dword v35, v27, s[48:51], 0 offen
  buffer_load_dwordx4 v22, s[56:59], s64 offen offset:2176 lds
  buffer_load_dwordx4 v23, s[56:59], s64 offen offset:3264 lds
  buffer_load_dword v35, v27, s[48:51], 0 offen
  s_mov_b32 m0, 59936
  s_add_u32 s64, s64, 98304
  ds_read_b128 v[40:43], v36 offset:1808
  buffer_load_dwordx4 v20, s[52:55], s6 offen offset:0 lds
  buffer_load_dwordx4 v21, s[52:55], s6 offen offset:1088 lds
  buffer_load_dword v35, v27, s[48:51], 0 offen
  buffer_load_dwordx4 v22, s[52:55], s6 offen offset:2176 lds
  buffer_load_dwordx4 v23, s[52:55], s6 offen offset:3264 lds
  buffer_load_dword v35, v27, s[48:51], 0 offen
  s_mov_b32 m0, 64304
  s_cmp_ge_u32 s64, s69
  s_cselect_b32 s64, s66, s64
  buffer_load_dwordx4 v20, s[56:59], s6 offen offset:0 lds
  buffer_load_dwordx4 v21, s[56:59], s6 offen offset:1088 lds
  buffer_load_dword v35, v27, s[48:51], 0 offen
  buffer_load_dwordx4 v22, s[56:59], s6 offen offset:2176 lds
  buffer_load_dwordx4 v23, s[56:59], s6 offen offset:3264 lds
  buffer_load_dword v35, v27, s[48:51], 0 offen
  s_mov_b32 m0, 1200
  s_nop 0
  buffer_load_dword v27, s[48:51], 0 offen lds
  s_waitcnt lgkmcnt(0)
  v_or_b32 v39, v40, v41
  v_or3_b32 v39, v39, v42, v43
  s_nop 0
  v_readfirstlane_b32 s67, v39
  s_cmp_eq_u32 s67, 0
  s_cbranch_scc1 Llg_20
  v_mov_b32 v38, 1808
  s_call_b64 s[34:35], Llw_12
Llg_20:
  s_mov_b32 m0, 2048
  s_add_u32 s7, s65, 0
  buffer_load_dwordx4 v28, s[12:15], s7 offen offset:0 lds
  buffer_load_dwordx4 v29, s[12:15], s7 offen offset:1024 lds
  buffer_load_dword v35, v27, s[48:51], 0 offen
  buffer_load_dwordx4 v30, s[12:15], s7 offen offset:2048 lds
  buffer_load_dwordx4 v31, s[12:15], s7 offen offset:3072 lds
  buffer_load_dword v35, v27, s[48:51], 0 offen
  s_mov_b32 m0, 6144
  s_add_u32 s7, s65, 40960
  buffer_load_dwordx4 v28, s[12:15], s7 offen offset:0 lds
  buffer_load_dwordx4 v29, s[12:15], s7 offen offset:1024 lds
  buffer_load_dword v35, v27, s[48:51], 0 offen
  buffer_load_dwordx4 v30, s[12:15], s7 offen offset:2048 lds
  buffer_load_dwordx4 v31, s[12:15], s7 offen offset:3072 lds
  buffer_load_dword v35, v27, s[48:51], 0 offen
  s_mov_b32 m0, 10240
  s_add_u32 s7, s65, 81920
  buffer_load_dwordx4 v28, s[12:15], s7 offen offset:0 lds
  buffer_load_dwordx4 v29, s[12:15], s7 offen offset:1024 lds
  buffer_load_dword v35, v27, s[48:51], 0 offen
  buffer_load_dwordx4 v30, s[12:15], s7 offen offset:2048 lds
  buffer_load_dwordx4 v31, s[12:15], s7 offen offset:3072 lds
  buffer_load_dword v35, v27, s[48:51], 0 offen
  s_mov_b32 m0, 14336
  s_add_u32 s7, s65, 122880
  buffer_load_dwordx4 v28, s[12:15], s7 offen offset:0 lds
  buffer_load_dwordx4 v29, s[12:15], s7 offen offset:1024 lds
  buffer_load_dword v35, v27, s[48:51], 0 offen
  buffer_load_dwordx4 v30, s[12:15], s7 offen offset:2048 lds
  buffer_load_dwordx4 v31, s[12:15], s7 offen offset:3072 lds
  buffer_load_dword v35, v27, s[48:51], 0 offen
  s_add_u32 s65, s65, 128
  s_cmp_ge_u32 s65, s11
  s_cselect_b32 s65, s10, s65
  s_mov_b32 m0, 68672
  s_add_u32 s6, s64, 49152
  buffer_load_dwordx4 v20, s[52:55], s64 offen offset:0 lds
  buffer_load_dwordx4 v21, s[52:55], s64 offen offset:1088 lds
  buffer_load_dword v35, v27, s[48:51], 0 offen
  buffer_load_dwordx4 v22, s[52:55], s64 offen offset:2176 lds
  buffer_load_dwordx4 v23, s[52:55], s64 offen offset:3264 lds
  buffer_load_dword v35, v27, s[48:51], 0 offen
  s_mov_b32 m0, 73040
  s_nop 0
  buffer_load_dwordx4 v20, s[56:59], s64 offen offset:0 lds
  buffer_load_dwordx4 v21, s[56:59], s64 offen offset:1088 lds
  buffer_load_dword v35, v27, s[48:51], 0 offen
  buffer_load_dwordx4 v22, s[56:59], s64 offen offset:2176 lds
  buffer_load_dwordx4 v23, s[56:59], s64 offen offset:3264 lds
  buffer_load_dword v35, v27, s[48:51], 0 offen
  s_mov_b32 m0, 77408
  s_add_u32 s64, s64, 98304
  ds_read_b128 v[40:43], v36 offset:1824
  buffer_load_dwordx4 v20, s[52:55], s6 offen offset:0 lds
  buffer_load_dwordx4 v21, s[52:55], s6 offen offset:1088 lds
  buffer_load_dword v35, v27, s[48:51], 0 offen
  buffer_load_dwordx4 v22, s[52:55], s6 offen offset:2176 lds
  buffer_load_dwordx4 v23, s[52:55], s6 offen offset:3264 lds
  buffer_load_dword v35, v27, s[48:51], 0 offen
  s_mov_b32 m0, 81776
  s_nop 0
  buffer_load_dwordx4 v20, s[56:59], s6 offen offset:0 lds
  buffer_load_dwordx4 v21, s[56:59], s6 offen offset:1088 lds
  buffer_load_dword v35, v27, s[48:51], 0 offen
  buffer_load_dwordx4 v22, s[56:59], s6 offen offset:2176 lds
  buffer_load_dwordx4 v23, s[56:59], s6 offen offset:3264 lds
  buffer_load_dword v35, v27, s[48:51], 0 offen
  s_mov_b32 m0, 1204
  s_nop 0
  buffer_load_dword v27, s[48:51], 0 offen lds
  s_waitcnt lgkmcnt(0)
  v_or_b32 v39, v40, v41
  v_or3_b32 v39, v39, v42, v43
  s_nop 0
  v_readfirstlane_b32 s67, v39
  s_cmp_eq_u32 s67, 0
  s_cbranch_scc1 Llg_21
  v_mov_b32 v38, 1824
  s_call_b64 s[34:35], Llw_12
Llg_21:
  s_mov_b32 m0, 86144
  s_add_u32 s6, s64, 49152
  buffer_load_dwordx4 v20, s[52:55], s64 offen offset:0 lds
  buffer_load_dwordx4 v21, s[52:55], s64 offen offset:1088 lds
  buffer_load_dword v35, v27, s[48:51], 0 offen
  buffer_load_dwordx4 v22, s[52:55], s64 offen offset:2176 lds
  buffer_load_dwordx4 v23, s[52:55], s64 offen offset:3264 lds
  buffer_load_dword v35, v27, s[48:51], 0 offen
  s_mov_b32 m0, 90512
  s_nop 0
  buffer_load_dwordx4 v20, s[56:59], s64 offen offset:0 lds
  buffer_load_dwordx4 v21, s[56:59], s64 offen offset:1088 lds
  buffer_load_dword v35, v27, s[48:51], 0 offen
  buffer_load_dwordx4 v22, s[56:59], s64 offen offset:2176 lds
  buffer_load_dwordx4 v23, s[56:59], s64 offen offset:3264 lds
  buffer_load_dword v35, v27, s[48:51], 0 offen
  s_mov_b32 m0, 94880
  s_add_u32 s64, s64, 98304
  ds_read_b128 v[40:43], v36 offset:1840
  buffer_load_dwordx4 v20, s[52:55], s6 offen offset:0 lds
  buffer_load_dwordx4 v21, s[52:55], s6 offen offset:1088 lds
  buffer_load_dword v35, v27, s[48:51], 0 offen
  buffer_load_dwordx4 v22, s[52:55], s6 offen offset:2176 lds
  buffer_load_dwordx4 v23, s[52:55], s6 offen offset:3264 lds
  buffer_load_dword v35, v27, s[48:51], 0 offen
  s_mov_b32 m0, 99248
  s_cmp_ge_u32 s64, s69
  s_cselect_b32 s64, s66, s64
  buffer_load_dwordx4 v20, s[56:59], s6 offen offset:0 lds
  buffer_load_dwordx4 v21, s[56:59], s6 offen offset:1088 lds
  buffer_load_dword v35, v27, s[48:51], 0 offen
  buffer_load_dwordx4 v22, s[56:59], s6 offen offset:2176 lds
  buffer_load_dwordx4 v23, s[56:59], s6 offen offset:3264 lds
  buffer_load_dword v35, v27, s[48:51], 0 offen
  s_mov_b32 m0, 1208
  s_nop 0
  buffer_load_dword v27, s[48:51], 0 offen lds
  s_waitcnt lgkmcnt(0)
  v_or_b32 v39, v40, v41
  v_or3_b32 v39, v39, v42, v43
  s_nop 0
  v_readfirstlane_b32 s67, v39
  s_cmp_eq_u32 s67, 0
  s_cbranch_scc1 Llg_22
  v_mov_b32 v38, 1840
  s_call_b64 s[34:35], Llw_12
Llg_22:
  s_mov_b32 m0, 34816
  s_add_u32 s7, s65, 0
  buffer_load_dwordx4 v28, s[12:15], s7 offen offset:0 lds
  buffer_load_dwordx4 v29, s[12:15], s7 offen offset:1024 lds
  buffer_load_dword v35, v27, s[48:51], 0 offen
  buffer_load_dwordx4 v30, s[12:15], s7 offen offset:2048 lds
  buffer_load_dwordx4 v31, s[12:15], s7 offen offset:3072 lds
  buffer_load_dword v35, v27, s[48:51], 0 offen
  s_mov_b32 m0, 38912
  s_add_u32 s7, s65, 40960
  buffer_load_dwordx4 v28, s[12:15], s7 offen offset:0 lds
  buffer_load_dwordx4 v29, s[12:15], s7 offen offset:1024 lds
  buffer_load_dword v35, v27, s[48:51], 0 offen
  buffer_load_dwordx4 v30, s[12:15], s7 offen offset:2048 lds
  buffer_load_dwordx4 v31, s[12:15], s7 offen offset:3072 lds
  buffer_load_dword v35, v27, s[48:51], 0 offen
  s_mov_b32 m0, 43008
  s_add_u32 s7, s65, 81920
  buffer_load_dwordx4 v28, s[12:15], s7 offen offset:0 lds
  buffer_load_dwordx4 v29, s[12:15], s7 offen offset:1024 lds
  buffer_load_dword v35, v27, s[48:51], 0 offen
  buffer_load_dwordx4 v30, s[12:15], s7 offen offset:2048 lds
  buffer_load_dwordx4 v31, s[12:15], s7 offen offset:3072 lds
  buffer_load_dword v35, v27, s[48:51], 0 offen
  s_mov_b32 m0, 47104
  s_add_u32 s7, s65, 122880
  buffer_load_dwordx4 v28, s[12:15], s7 offen offset:0 lds
  buffer_load_dwordx4 v29, s[12:15], s7 offen offset:1024 lds
  buffer_load_dword v35, v27, s[48:51], 0 offen
  buffer_load_dwordx4 v30, s[12:15], s7 offen offset:2048 lds
  buffer_load_dwordx4 v31, s[12:15], s7 offen offset:3072 lds
  buffer_load_dword v35, v27, s[48:51], 0 offen
  s_add_u32 s65, s65, 128
  s_cmp_ge_u32 s65, s11
  s_cselect_b32 s65, s10, s65
  s_mov_b32 m0, 103616
  s_add_u32 s6, s64, 49152
  buffer_load_dwordx4 v20, s[52:55], s64 offen offset:0 lds
  buffer_load_dwordx4 v21, s[52:55], s64 offen offset:1088 lds
  buffer_load_dword v35, v27, s[48:51], 0 offen
  buffer_load_dwordx4 v22, s[52:55], s64 offen offset:2176 lds
  buffer_load_dwordx4 v23, s[52:55], s64 offen offset:3264 lds
  buffer_load_dword v35, v27, s[48:51], 0 offen
  s_mov_b32 m0, 107984
  s_nop 0
  buffer_load_dwordx4 v20, s[56:59], s64 offen offset:0 lds
  buffer_load_dwordx4 v21, s[56:59], s64 offen offset:1088 lds
  buffer_load_dword v35, v27, s[48:51], 0 offen
  buffer_load_dwordx4 v22, s[56:59], s64 offen offset:2176 lds
  buffer_load_dwordx4 v23, s[56:59], s64 offen offset:3264 lds
  buffer_load_dword v35, v27, s[48:51], 0 offen
  s_mov_b32 m0, 112352
  s_add_u32 s64, s64, 98304
  ds_read_b128 v[40:43], v36 offset:1856
  buffer_load_dwordx4 v20, s[52:55], s6 offen offset:0 lds
  buffer_load_dwordx4 v21, s[52:55], s6 offen offset:1088 lds
  buffer_load_dword v35, v27, s[48:51], 0 offen
  buffer_load_dwordx4 v22, s[52:55], s6 offen offset:2176 lds
  buffer_load_dwordx4 v23, s[52:55], s6 offen offset:3264 lds
  buffer_load_dword v35, v27, s[48:51], 0 offen
  s_mov_b32 m0, 116720
  s_nop 0
  buffer_load_dwordx4 v20, s[56:59], s6 offen offset:0 lds
  buffer_load_dwordx4 v21, s[56:59], s6 offen offset:1088 lds
  buffer_load_dword v35, v27, s[48:51], 0 offen
  buffer_load_dwordx4 v22, s[56:59], s6 offen offset:2176 lds
  buffer_load_dwordx4 v23, s[56:59], s6 offen offset:3264 lds
  buffer_load_dword v35, v27, s[48:51], 0 offen
  s_mov_b32 m0, 1212
  s_nop 0
  buffer_load_dword v27, s[48:51], 0 offen lds
  s_waitcnt lgkmcnt(0)
  v_or_b32 v39, v40, v41
  v_or3_b32 v39, v39, v42, v43
  s_nop 0
  v_readfirstlane_b32 s67, v39
  s_cmp_eq_u32 s67, 0
  s_cbranch_scc1 Llg_23
  v_mov_b32 v38, 1856
  s_call_b64 s[34:35], Llw_12
Llg_23:
  s_mov_b32 m0, 129536
  s_add_u32 s6, s64, 49152
  buffer_load_dwordx4 v20, s[52:55], s64 offen offset:0 lds
  buffer_load_dwordx4 v21, s[52:55], s64 offen offset:1088 lds
  buffer_load_dword v35, v27, s[48:51], 0 offen
  buffer_load_dwordx4 v22, s[52:55], s64 offen offset:2176 lds
  buffer_load_dwordx4 v23, s[52:55], s64 offen offset:3264 lds
  buffer_load_dword v35, v27, s[48:51], 0 offen
  s_mov_b32 m0, 133904
  s_nop 0
  buffer_load_dwordx4 v20, s[56:59], s64 offen offset:0 lds
  buffer_load_dwordx4 v21, s[56:59], s64 offen offset:1088 lds
  buffer_load_dword v35, v27, s[48:51], 0 offen
  buffer_load_dwordx4 v22, s[56:59], s64 offen offset:2176 lds
  buffer_load_dwordx4 v23, s[56:59], s64 offen offset:3264 lds
  buffer_load_dword v35, v27, s[48:51], 0 offen
  s_mov_b32 m0, 138272
  s_add_u32 s64, s64, 98304
  ds_read_b128 v[40:43], v36 offset:1872
  buffer_load_dwordx4 v20, s[52:55], s6 offen offset:0 lds
  buffer_load_dwordx4 v21, s[52:55], s6 offen offset:1088 lds
  buffer_load_dword v35, v27, s[48:51], 0 offen
  buffer_load_dwordx4 v22, s[52:55], s6 offen offset:2176 lds
  buffer_load_dwordx4 v23, s[52:55], s6 offen offset:3264 lds
  buffer_load_dword v35, v27, s[48:51], 0 offen
  s_mov_b32 m0, 142640
  s_cmp_ge_u32 s64, s69
  s_cselect_b32 s64, s66, s64
  buffer_load_dwordx4 v20, s[56:59], s6 offen offset:0 lds
  buffer_load_dwordx4 v21, s[56:59], s6 offen offset:1088 lds
  buffer_load_dword v35, v27, s[48:51], 0 offen
  buffer_load_dwordx4 v22, s[56:59], s6 offen offset:2176 lds
  buffer_load_dwordx4 v23, s[56:59], s6 offen offset:3264 lds
  buffer_load_dword v35, v27, s[48:51], 0 offen
  s_mov_b32 m0, 1216
  s_nop 0
  buffer_load_dword v27, s[48:51], 0 offen lds
  s_waitcnt lgkmcnt(0)
  v_or_b32 v39, v40, v41
  v_or3_b32 v39, v39, v42, v43
  s_nop 0
  v_readfirstlane_b32 s67, v39
  s_cmp_eq_u32 s67, 0
  s_cbranch_scc1 Llg_24
  v_mov_b32 v38, 1872
  s_call_b64 s[34:35], Llw_12
Llg_24:
  s_mov_b32 m0, 18432
  s_add_u32 s7, s65, 0
  buffer_load_dwordx4 v28, s[12:15], s7 offen offset:0 lds
  buffer_load_dwordx4 v29, s[12:15], s7 offen offset:1024 lds
  buffer_load_dword v35, v27, s[48:51], 0 offen
  buffer_load_dwordx4 v30, s[12:15], s7 offen offset:2048 lds
  buffer_load_dwordx4 v31, s[12:15], s7 offen offset:3072 lds
  buffer_load_dword v35, v27, s[48:51], 0 offen
  s_mov_b32 m0, 22528
  s_add_u32 s7, s65, 40960
  buffer_load_dwordx4 v28, s[12:15], s7 offen offset:0 lds
  buffer_load_dwordx4 v29, s[12:15], s7 offen offset:1024 lds
  buffer_load_dword v35, v27, s[48:51], 0 offen
  buffer_load_dwordx4 v30, s[12:15], s7 offen offset:2048 lds
  buffer_load_dwordx4 v31, s[12:15], s7 offen offset:3072 lds
  buffer_load_dword v35, v27, s[48:51], 0 offen
  s_mov_b32 m0, 26624
  s_add_u32 s7, s65, 81920
  buffer_load_dwordx4 v28, s[12:15], s7 offen offset:0 lds
  buffer_load_dwordx4 v29, s[12:15], s7 offen offset:1024 lds
  buffer_load_dword v35, v27, s[48:51], 0 offen
  buffer_load_dwordx4 v30, s[12:15], s7 offen offset:2048 lds
  buffer_load_dwordx4 v31, s[12:15], s7 offen offset:3072 lds
  buffer_load_dword v35, v27, s[48:51], 0 offen
  s_mov_b32 m0, 30720
  s_add_u32 s7, s65, 122880
  buffer_load_dwordx4 v28, s[12:15], s7 offen offset:0 lds
  buffer_load_dwordx4 v29, s[12:15], s7 offen offset:1024 lds
  buffer_load_dword v35, v27, s[48:51], 0 offen
  buffer_load_dwordx4 v30, s[12:15], s7 offen offset:2048 lds
  buffer_load_dwordx4 v31, s[12:15], s7 offen offset:3072 lds
  buffer_load_dword v35, v27, s[48:51], 0 offen
  s_add_u32 s65, s65, 128
  s_cmp_ge_u32 s65, s11
  s_cselect_b32 s65, s10, s65
  s_mov_b32 m0, 51200
  s_add_u32 s6, s64, 49152
  buffer_load_dwordx4 v20, s[52:55], s64 offen offset:0 lds
  buffer_load_dwordx4 v21, s[52:55], s64 offen offset:1088 lds
  buffer_load_dword v35, v27, s[48:51], 0 offen
  buffer_load_dwordx4 v22, s[52:55], s64 offen offset:2176 lds
  buffer_load_dwordx4 v23, s[52:55], s64 offen offset:3264 lds
  buffer_load_dword v35, v27, s[48:51], 0 offen
  s_mov_b32 m0, 55568
  s_nop 0
  buffer_load_dwordx4 v20, s[56:59], s64 offen offset:0 lds
  buffer_load_dwordx4 v21, s[56:59], s64 offen offset:1088 lds
  buffer_load_dword v35, v27, s[48:51], 0 offen
  buffer_load_dwordx4 v22, s[56:59], s64 offen offset:2176 lds
  buffer_load_dwordx4 v23, s[56:59], s64 offen offset:3264 lds
  buffer_load_dword v35, v27, s[48:51], 0 offen
  s_mov_b32 m0, 59936
  s_add_u32 s64, s64, 98304
  ds_read_b128 v[40:43], v36 offset:1888
  buffer_load_dwordx4 v20, s[52:55], s6 offen offset:0 lds
  buffer_load_dwordx4 v21, s[52:55], s6 offen offset:1088 lds
  buffer_load_dword v35, v27, s[48:51], 0 offen
  buffer_load_dwordx4 v22, s[52:55], s6 offen offset:2176 lds
  buffer_load_dwordx4 v23, s[52:55], s6 offen offset:3264 lds
  buffer_load_dword v35, v27, s[48:51], 0 offen
  s_mov_b32 m0, 64304
  s_nop 0
  buffer_load_dwordx4 v20, s[56:59], s6 offen offset:0 lds
  buffer_load_dwordx4 v21, s[56:59], s6 offen offset:1088 lds
  buffer_load_dword v35, v27, s[48:51], 0 offen
  buffer_load_dwordx4 v22, s[56:59], s6 offen offset:2176 lds
  buffer_load_dwordx4 v23, s[56:59], s6 offen offset:3264 lds
  buffer_load_dword v35, v27, s[48:51], 0 offen
  s_mov_b32 m0, 1220
  s_nop 0
  buffer_load_dword v27, s[48:51], 0 offen lds
  s_waitcnt lgkmcnt(0)
  v_or_b32 v39, v40, v41
  v_or3_b32 v39, v39, v42, v43
  s_nop 0
  v_readfirstlane_b32 s67, v39
  s_cmp_eq_u32 s67, 0
  s_cbranch_scc1 Llg_25
  v_mov_b32 v38, 1888
  s_call_b64 s[34:35], Llw_12
Llg_25:
  s_mov_b32 m0, 68672
  s_add_u32 s6, s64, 49152
  buffer_load_dwordx4 v20, s[52:55], s64 offen offset:0 lds
  buffer_load_dwordx4 v21, s[52:55], s64 offen offset:1088 lds
  buffer_load_dword v35, v27, s[48:51], 0 offen
  buffer_load_dwordx4 v22, s[52:55], s64 offen offset:2176 lds
  buffer_load_dwordx4 v23, s[52:55], s64 offen offset:3264 lds
  buffer_load_dword v35, v27, s[48:51], 0 offen
  s_mov_b32 m0, 73040
  s_nop 0
  buffer_load_dwordx4 v20, s[56:59], s64 offen offset:0 lds
  buffer_load_dwordx4 v21, s[56:59], s64 offen offset:1088 lds
  buffer_load_dword v35, v27, s[48:51], 0 offen
  buffer_load_dwordx4 v22, s[56:59], s64 offen offset:2176 lds
  buffer_load_dwordx4 v23, s[56:59], s64 offen offset:3264 lds
  buffer_load_dword v35, v27, s[48:51], 0 offen
  s_mov_b32 m0, 77408
  s_add_u32 s64, s64, 98304
  ds_read_b128 v[40:43], v36 offset:1904
  buffer_load_dwordx4 v20, s[52:55], s6 offen offset:0 lds
  buffer_load_dwordx4 v21, s[52:55], s6 offen offset:1088 lds
  buffer_load_dword v35, v27, s[48:51], 0 offen
  buffer_load_dwordx4 v22, s[52:55], s6 offen offset:2176 lds
  buffer_load_dwordx4 v23, s[52:55], s6 offen offset:3264 lds
  buffer_load_dword v35, v27, s[48:51], 0 offen
  s_mov_b32 m0, 81776
  s_cmp_ge_u32 s64, s69
  s_cselect_b32 s64, s66, s64
  buffer_load_dwordx4 v20, s[56:59], s6 offen offset:0 lds
  buffer_load_dwordx4 v21, s[56:59], s6 offen offset:1088 lds
  buffer_load_dword v35, v27, s[48:51], 0 offen
  buffer_load_dwordx4 v22, s[56:59], s6 offen offset:2176 lds
  buffer_load_dwordx4 v23, s[56:59], s6 offen offset:3264 lds
  buffer_load_dword v35, v27, s[48:51], 0 offen
  s_mov_b32 m0, 1224
  s_nop 0
  buffer_load_dword v27, s[48:51], 0 offen lds
  s_waitcnt lgkmcnt(0)
  v_or_b32 v39, v40, v41
  v_or3_b32 v39, v39, v42, v43
  s_nop 0
  v_readfirstlane_b32 s67, v39
  s_cmp_eq_u32 s67, 0
  s_cbranch_scc1 Llg_26
  v_mov_b32 v38, 1904
  s_call_b64 s[34:35], Llw_12
Llg_26:
  s_mov_b32 m0, 2048
  s_add_u32 s7, s65, 0
  buffer_load_dwordx4 v28, s[12:15], s7 offen offset:0 lds
  buffer_load_dwordx4 v29, s[12:15], s7 offen offset:1024 lds
  buffer_load_dword v35, v27, s[48:51], 0 offen
  buffer_load_dwordx4 v30, s[12:15], s7 offen offset:2048 lds
  buffer_load_dwordx4 v31, s[12:15], s7 offen offset:3072 lds
  buffer_load_dword v35, v27, s[48:51], 0 offen
  s_mov_b32 m0, 6144
  s_add_u32 s7, s65, 40960
  buffer_load_dwordx4 v28, s[12:15], s7 offen offset:0 lds
  buffer_load_dwordx4 v29, s[12:15], s7 offen offset:1024 lds
  buffer_load_dword v35, v27, s[48:51], 0 offen
  buffer_load_dwordx4 v30, s[12:15], s7 offen offset:2048 lds
  buffer_load_dwordx4 v31, s[12:15], s7 offen offset:3072 lds
  buffer_load_dword v35, v27, s[48:51], 0 offen
  s_mov_b32 m0, 10240
  s_add_u32 s7, s65, 81920
  buffer_load_dwordx4 v28, s[12:15], s7 offen offset:0 lds
  buffer_load_dwordx4 v29, s[12:15], s7 offen offset:1024 lds
  buffer_load_dword v35, v27, s[48:51], 0 offen
  buffer_load_dwordx4 v30, s[12:15], s7 offen offset:2048 lds
  buffer_load_dwordx4 v31, s[12:15], s7 offen offset:3072 lds
  buffer_load_dword v35, v27, s[48:51], 0 offen
  s_mov_b32 m0, 14336
  s_add_u32 s7, s65, 122880
  buffer_load_dwordx4 v28, s[12:15], s7 offen offset:0 lds
  buffer_load_dwordx4 v29, s[12:15], s7 offen offset:1024 lds
  buffer_load_dword v35, v27, s[48:51], 0 offen
  buffer_load_dwordx4 v30, s[12:15], s7 offen offset:2048 lds
  buffer_load_dwordx4 v31, s[12:15], s7 offen offset:3072 lds
  buffer_load_dword v35, v27, s[48:51], 0 offen
  s_add_u32 s65, s65, 128
  s_cmp_ge_u32 s65, s11
  s_cselect_b32 s65, s10, s65
  s_mov_b32 m0, 86144
  s_add_u32 s6, s64, 49152
  buffer_load_dwordx4 v20, s[52:55], s64 offen offset:0 lds
  buffer_load_dwordx4 v21, s[52:55], s64 offen offset:1088 lds
  buffer_load_dword v35, v27, s[48:51], 0 offen
  buffer_load_dwordx4 v22, s[52:55], s64 offen offset:2176 lds
  buffer_load_dwordx4 v23, s[52:55], s64 offen offset:3264 lds
  buffer_load_dword v35, v27, s[48:51], 0 offen
  s_mov_b32 m0, 90512
  s_nop 0
  buffer_load_dwordx4 v20, s[56:59], s64 offen offset:0 lds
  buffer_load_dwordx4 v21, s[56:59], s64 offen offset:1088 lds
  buffer_load_dword v35, v27, s[48:51], 0 offen
  buffer_load_dwordx4 v22, s[56:59], s64 offen offset:2176 lds
  buffer_load_dwordx4 v23, s[56:59], s64 offen offset:3264 lds
  buffer_load_dword v35, v27, s[48:51], 0 offen
  s_mov_b32 m0, 94880
  s_add_u32 s64, s64, 98304
  ds_read_b128 v[40:43], v36 offset:1920
  buffer_load_dwordx4 v20, s[52:55], s6 offen offset:0 lds
  buffer_load_dwordx4 v21, s[52:55], s6 offen offset:1088 lds
  buffer_load_dword v35, v27, s[48:51], 0 offen
  buffer_load_dwordx4 v22, s[52:55], s6 offen offset:2176 lds
  buffer_load_dwordx4 v23, s[52:55], s6 offen offset:3264 lds
  buffer_load_dword v35, v27, s[48:51], 0 offen
  s_mov_b32 m0, 99248
  s_nop 0
  buffer_load_dwordx4 v20, s[56:59], s6 offen offset:0 lds
  buffer_load_dwordx4 v21, s[56:59], s6 offen offset:1088 lds
  buffer_load_dword v35, v27, s[48:51], 0 offen
  buffer_load_dwordx4 v22, s[56:59], s6 offen offset:2176 lds
  buffer_load_dwordx4 v23, s[56:59], s6 offen offset:3264 lds
  buffer_load_dword v35, v27, s[48:51], 0 offen
  s_mov_b32 m0, 1228
  s_nop 0
  buffer_load_dword v27, s[48:51], 0 offen lds
  s_waitcnt lgkmcnt(0)
  v_or_b32 v39, v40, v41
  v_or3_b32 v39, v39, v42, v43
  s_nop 0
  v_readfirstlane_b32 s67, v39
  s_cmp_eq_u32 s67, 0
  s_cbranch_scc1 Llg_27
  v_mov_b32 v38, 1920
  s_call_b64 s[34:35], Llw_12
Llg_27:
  s_mov_b32 m0, 103616
  s_add_u32 s6, s64, 49152
  buffer_load_dwordx4 v20, s[52:55], s64 offen offset:0 lds
  buffer_load_dwordx4 v21, s[52:55], s64 offen offset:1088 lds
  buffer_load_dword v35, v27, s[48:51], 0 offen
  buffer_load_dwordx4 v22, s[52:55], s64 offen offset:2176 lds
  buffer_load_dwordx4 v23, s[52:55], s64 offen offset:3264 lds
  buffer_load_dword v35, v27, s[48:51], 0 offen
  s_mov_b32 m0, 107984
  s_nop 0
  buffer_load_dwordx4 v20, s[56:59], s64 offen offset:0 lds
  buffer_load_dwordx4 v21, s[56:59], s64 offen offset:1088 lds
  buffer_load_dword v35, v27, s[48:51], 0 offen
  buffer_load_dwordx4 v22, s[56:59], s64 offen offset:2176 lds
  buffer_load_dwordx4 v23, s[56:59], s64 offen offset:3264 lds
  buffer_load_dword v35, v27, s[48:51], 0 offen
  s_mov_b32 m0, 112352
  s_add_u32 s64, s64, 98304
  ds_read_b128 v[40:43], v36 offset:1936
  buffer_load_dwordx4 v20, s[52:55], s6 offen offset:0 lds
  buffer_load_dwordx4 v21, s[52:55], s6 offen offset:1088 lds
  buffer_load_dword v35, v27, s[48:51], 0 offen
  buffer_load_dwordx4 v22, s[52:55], s6 offen offset:2176 lds
  buffer_load_dwordx4 v23, s[52:55], s6 offen offset:3264 lds
  buffer_load_dword v35, v27, s[48:51], 0 offen
  s_mov_b32 m0, 116720
  s_cmp_ge_u32 s64, s69
  s_cselect_b32 s64, s66, s64
  buffer_load_dwordx4 v20, s[56:59], s6 offen offset:0 lds
  buffer_load_dwordx4 v21, s[56:59], s6 offen offset:1088 lds
  buffer_load_dword v35, v27, s[48:51], 0 offen
  buffer_load_dwordx4 v22, s[56:59], s6 offen offset:2176 lds
  buffer_load_dwordx4 v23, s[56:59], s6 offen offset:3264 lds
  buffer_load_dword v35, v27, s[48:51], 0 offen
  s_mov_b32 m0, 1232
  s_nop 0
  buffer_load_dword v27, s[48:51], 0 offen lds
Lload_g2:
  ds_read_b128 v[40:43], v36 offset:1936
  s_waitcnt lgkmcnt(0)
  v_or_b32 v39, v40, v41
  v_or3_b32 v39, v39, v42, v43
  s_nop 0
  v_readfirstlane_b32 s67, v39
  s_cmp_eq_u32 s67, 0
  s_cbranch_scc1 Llg_28
  v_mov_b32 v38, 1936
  s_call_b64 s[34:35], Llw_12
Llg_28:
  v_add_u32 v50, 0, v1
  v_mul_u32_u24 v51, 52429, v50
  v_lshrrev_b32 v51, 19, v51
  v_mul_u32_u24 v51, 1120, v51
  v_lshl_add_u32 v44, v50, 4, v51
  v_add_u32 v50, 64, v1
  v_mul_u32_u24 v51, 52429, v50
  v_lshrrev_b32 v51, 19, v51
  v_mul_u32_u24 v51, 1120, v51
  v_lshl_add_u32 v45, v50, 4, v51
  v_add_u32 v50, 128, v1
  v_mul_u32_u24 v51, 52429, v50
  v_lshrrev_b32 v51, 19, v51
  v_mul_u32_u24 v51, 1120, v51
  v_lshl_add_u32 v46, v50, 4, v51
  v_add_u32 v50, 192, v1
  v_mul_u32_u24 v51, 52429, v50
  v_lshrrev_b32 v51, 19, v51
  v_mul_u32_u24 v51, 1120, v51
  v_lshl_add_u32 v47, v50, 4, v51
  v_add_u32 v50, 256, v1
  v_mul_u32_u24 v51, 52429, v50
  v_lshrrev_b32 v51, 19, v51
  v_mul_u32_u24 v51, 1120, v51
  v_lshl_add_u32 v48, v50, 4, v51
  ds_read_b128 v[40:43], v36 offset:1952
  s_mul_i32 s6, s62, 81920
  s_mul_i32 s7, s63, 160
  s_add_u32 s6, s6, s7
  s_mov_b32 m0, 39424
  s_nop 0
  buffer_load_dwordx4 v44, s[12:15], s6 offen lds
  s_mov_b32 m0, 40448
  s_nop 0
  buffer_load_dwordx4 v45, s[12:15], s6 offen lds
  buffer_load_dword v35, v27, s[48:51], 0 offen
  s_mov_b32 m0, 41472
  s_nop 0
  buffer_load_dwordx4 v46, s[12:15], s6 offen lds
  s_mov_b32 m0, 42496
  s_nop 0
  buffer_load_dwordx4 v47, s[12:15], s6 offen lds
  buffer_load_dword v35, v27, s[48:51], 0 offen
  s_mov_b32 m0, 43520
  s_nop 0
  buffer_load_dwordx4 v48, s[12:15], s6 offen lds
  s_add_u32 s6, s6, 40960
  s_mov_b32 m0, 44544
  s_nop 0
  buffer_load_dwordx4 v44, s[12:15], s6 offen lds
  buffer_load_dword v35, v27, s[48:51], 0 offen
  s_mov_b32 m0, 45568
  s_nop 0
  buffer_load_dwordx4 v45, s[12:15], s6 offen lds
  s_mov_b32 m0, 46592
  s_nop 0
  buffer_load_dwordx4 v46, s[12:15], s6 offen lds
  buffer_load_dword v35, v27, s[48:51], 0 offen
  s_mov_b32 m0, 47616
  s_nop 0
  buffer_load_dwordx4 v47, s[12:15], s6 offen lds
  s_mov_b32 m0, 48640
  s_nop 0
  buffer_load_dwordx4 v48, s[12:15], s6 offen lds
  buffer_load_dword v35, v27, s[48:51], 0 offen
  s_add_u32 s6, s6, 40960
  s_mov_b32 m0, 1236
  s_nop 0
  buffer_load_dword v27, s[48:51], 0 offen lds
  s_waitcnt lgkmcnt(0)
  v_or_b32 v39, v40, v41
  v_or3_b32 v39, v39, v42, v43
  s_nop 0
  v_readfirstlane_b32 s67, v39
  s_cmp_eq_u32 s67, 0
  s_cbranch_scc1 Llg_29
  v_mov_b32 v38, 1952
  s_call_b64 s[34:35], Llw_12
Llg_29:
  s_and_b32 s4, s62, 7
  s_mul_i32 s4, s4, 3
  s_lshr_b32 s4, s4, 1
  s_add_u32 s4, s4, 4
  s_cmp_ge_u32 s4, 12
  s_cselect_b32 s5, 12, 0
  s_sub_u32 s4, s4, s5
  s_mul_i32 s66, s63, 245760
  s_add_u32 s66, s66, 0x1000000
  s_add_u32 s69, s66, 61440
  s_mul_i32 s4, s4, 5120
  s_add_u32 s64, s66, s4
  v_lshlrev_b32 v32, 4, v1
  v_add_u32 v33, 4096, v32
Lpoll_31:
  s_sub_u32 s0, s0, 1
  s_cbranch_scc1 Lexit_2
  ds_read_b32 v38, v36 offset:116
  s_waitcnt lgkmcnt(0)
  v_readfirstlane_b32 s4, v38
  s_cmp_lg_u32 s4, 0
  s_cbranch_scc1 Lok_30
  s_sleep 1
  s_branch Lpoll_31
Lok_30:
  s_mov_b32 m0, 49664
  s_add_u32 s6, s64, 0
  buffer_load_dwordx4 v32, s[48:51], s6 offen offset:0 sc1 lds
  buffer_load_dwordx4 v32, s[48:51], s6 offen offset:1024 sc1 lds
  buffer_load_dword v35, v27, s[48:51], 0 offen
  buffer_load_dwordx4 v32, s[48:51], s6 offen offset:2048 sc1 lds
  buffer_load_dwordx4 v32, s[48:51], s6 offen offset:3072 sc1 lds
  buffer_load_dword v35, v27, s[48:51], 0 offen
  s_mov_b32 m0, 53760
  s_nop 0
  buffer_load_dwordx4 v33, s[48:51], s6 offen sc1 lds
  s_mov_b32 m0, 54784
  s_add_u32 s6, s64, 61440
  ds_read_b128 v[40:43], v36 offset:1968
  buffer_load_dwordx4 v32, s[48:51], s6 offen offset:0 sc1 lds
  buffer_load_dword v35, v27, s[48:51], 0 offen
  buffer_load_dwordx4 v32, s[48:51], s6 offen offset:1024 sc1 lds
  buffer_load_dwordx4 v32, s[48:51], s6 offen offset:2048 sc1 lds
  buffer_load_dword v35, v27, s[48:51], 0 offen
  buffer_load_dwordx4 v32, s[48:51], s6 offen offset:3072 sc1 lds
  s_mov_b32 m0, 58880
  s_nop 0
  buffer_load_dwordx4 v33, s[48:51], s6 offen sc1 lds
  buffer_load_dword v35, v27, s[48:51], 0 offen
  s_mov_b32 m0, 1240
  s_nop 0
  buffer_load_dword v27, s[48:51], 0 offen lds
  s_waitcnt lgkmcnt(0)
  v_or_b32 v39, v40, v41
  v_or3_b32 v39, v39, v42, v43
  s_nop 0
  v_readfirstlane_b32 s67, v39
  s_cmp_eq_u32 s67, 0
  s_cbranch_scc1 Llg_32
  v_mov_b32 v38, 1968
  s_call_b64 s[34:35], Llw_12
Llg_32:
  s_mov_b32 m0, 18944
  s_add_u32 s6, s64, 122880
  buffer_load_dwordx4 v32, s[48:51], s6 offen offset:0 sc1 lds
  buffer_load_dwordx4 v32, s[48:51], s6 offen offset:1024 sc1 lds
  buffer_load_dword v35, v27, s[48:51], 0 offen
  buffer_load_dwordx4 v32, s[48:51], s6 offen offset:2048 sc1 lds
  buffer_load_dwordx4 v32, s[48:51], s6 offen offset:3072 sc1 lds
  buffer_load_dword v35, v27, s[48:51], 0 offen
  s_mov_b32 m0, 23040
  s_nop 0
  buffer_load_dwordx4 v33, s[48:51], s6 offen sc1 lds
  s_mov_b32 m0, 24064
  s_add_u32 s6, s64, 184320
  buffer_load_dwordx4 v32, s[48:51], s6 offen offset:0 sc1 lds
  buffer_load_dword v35, v27, s[48:51], 0 offen
  buffer_load_dwordx4 v32, s[48:51], s6 offen offset:1024 sc1 lds
  buffer_load_dwordx4 v32, s[48:51], s6 offen offset:2048 sc1 lds
  buffer_load_dword v35, v27, s[48:51], 0 offen
  buffer_load_dwordx4 v32, s[48:51], s6 offen offset:3072 sc1 lds
  s_mov_b32 m0, 28160
  s_nop 0
  buffer_load_dwordx4 v33, s[48:51], s6 offen sc1 lds
  buffer_load_dword v35, v27, s[48:51], 0 offen
  s_add_u32 s64, s64, 5120
  s_cmp_ge_u32 s64, s69
  s_cselect_b32 s64, s66, s64
  s_mov_b32 m0, 1244
  s_nop 0
  buffer_load_dword v27, s[48:51], 0 offen lds
  s_mov_b32 m0, 29184
  s_add_u32 s6, s64, 0
  buffer_load_dwordx4 v32, s[48:51], s6 offen offset:0 sc1 lds
  buffer_load_dwordx4 v32, s[48:51], s6 offen offset:1024 sc1 lds
  buffer_load_dword v35, v27, s[48:51], 0 offen
  buffer_load_dwordx4 v32, s[48:51], s6 offen offset:2048 sc1 lds
  buffer_load_dwordx4 v32, s[48:51], s6 offen offset:3072 sc1 lds
  buffer_load_dword v35, v27, s[48:51], 0 offen
  s_mov_b32 m0, 33280
  s_nop 0
  buffer_load_dwordx4 v33, s[48:51], s6 offen sc1 lds
  s_mov_b32 m0, 34304
  s_add_u32 s6, s64, 61440
  buffer_load_dwordx4 v32, s[48:51], s6 offen offset:0 sc1 lds
  buffer_load_dword v35, v27, s[48:51], 0 offen
  buffer_load_dwordx4 v32, s[48:51], s6 offen offset:1024 sc1 lds
  buffer_load_dwordx4 v32, s[48:51], s6 offen offset:2048 sc1 lds
  buffer_load_dword v35, v27, s[48:51], 0 offen
  buffer_load_dwordx4 v32, s[48:51], s6 offen offset:3072 sc1 lds
  s_mov_b32 m0, 38400
  s_nop 0
  buffer_load_dwordx4 v33, s[48:51], s6 offen sc1 lds
  buffer_load_dword v35, v27, s[48:51], 0 offen
  s_mov_b32 m0, 1248
  s_nop 0
  buffer_load_dword v27, s[48:51], 0 offen lds
  s_mov_b32 m0, 59904
  s_add_u32 s6, s64, 122880
  buffer_load_dwordx4 v32, s[48:51], s6 offen offset:0 sc1 lds
  buffer_load_dwordx4 v32, s[48:51], s6 offen offset:1024 sc1 lds
  buffer_load_dword v35, v27, s[48:51], 0 offen
  buffer_load_dwordx4 v32, s[48:51], s6 offen offset:2048 sc1 lds
  buffer_load_dwordx4 v32, s[48:51], s6 offen offset:3072 sc1 lds
  buffer_load_dword v35, v27, s[48:51], 0 offen
  s_mov_b32 m0, 64000
  s_nop 0
  buffer_load_dwordx4 v33, s[48:51], s6 offen sc1 lds
  s_mov_b32 m0, 65024
  s_add_u32 s6, s64, 184320
  ds_read_b128 v[40:43], v36 offset:1984
  buffer_load_dwordx4 v32, s[48:51], s6 offen offset:0 sc1 lds
  buffer_load_dword v35, v27, s[48:51], 0 offen
  buffer_load_dwordx4 v32, s[48:51], s6 offen offset:1024 sc1 lds
  buffer_load_dwordx4 v32, s[48:51], s6 offen offset:2048 sc1 lds
  buffer_load_dword v35, v27, s[48:51], 0 offen
  buffer_load_dwordx4 v32, s[48:51], s6 offen offset:3072 sc1 lds
  s_mov_b32 m0, 69120
  s_nop 0
  buffer_load_dwordx4 v33, s[48:51], s6 offen sc1 lds
  buffer_load_dword v35, v27, s[48:51], 0 offen
  s_add_u32 s64, s64, 5120
  s_cmp_ge_u32 s64, s69
  s_cselect_b32 s64, s66, s64
  s_mov_b32 m0, 1252
  s_nop 0
  buffer_load_dword v27, s[48:51], 0 offen lds
  s_cmp_ge_u32 s2, 192
  s_cbranch_scc1 Ls_join
Lload_g2b:
  ds_read_b128 v[40:43], v36 offset:1984
  s_waitcnt lgkmcnt(0)
  v_or_b32 v39, v40, v41
  v_or3_b32 v39, v39, v42, v43
  s_nop 0
  v_readfirstlane_b32 s67, v39
  s_cmp_eq_u32 s67, 0
  s_cbranch_scc1 Llg_33
  v_mov_b32 v38, 1984
  s_call_b64 s[34:35], Llw_12
Llg_33:
  s_mov_b32 m0, 70144
  s_add_u32 s6, s64, 0
  buffer_load_dwordx4 v32, s[48:51], s6 offen offset:0 sc1 lds
  buffer_load_dwordx4 v32, s[48:51], s6 offen offset:1024 sc1 lds
  buffer_load_dword v35, v27, s[48:51], 0 offen
  buffer_load_dwordx4 v32, s[48:51], s6 offen offset:2048 sc1 lds
  buffer_load_dwordx4 v32, s[48:51], s6 offen offset:3072 sc1 lds
  buffer_load_dword v35, v27, s[48:51], 0 offen
  s_mov_b32 m0, 74240
  s_nop 0
  buffer_load_dwordx4 v33, s[48:51], s6 offen sc1 lds
  s_mov_b32 m0, 75264
  s_add_u32 s6, s64, 61440
  buffer_load_dwordx4 v32, s[48:51], s6 offen offset:0 sc1 lds
  buffer_load_dword v35, v27, s[48:51], 0 offen
  buffer_load_dwordx4 v32, s[48:51], s6 offen offset:1024 sc1 lds
  buffer_load_dwordx4 v32, s[48:51], s6 offen offset:2048 sc1 lds
  buffer_load_dword v35, v27, s[48:51], 0 offen
  buffer_load_dwordx4 v32, s[48:51], s6 offen offset:3072 sc1 lds
  s_mov_b32 m0, 79360
  s_nop 0
  buffer_load_dwordx4 v33, s[48:51], s6 offen sc1 lds
  buffer_load_dword v35, v27, s[48:51], 0 offen
  s_mov_b32 m0, 1256
  s_nop 0
  buffer_load_dword v27, s[48:51], 0 offen lds
  s_mov_b32 m0, 80384
  s_add_u32 s6, s64, 122880
  buffer_load_dwordx4 v32, s[48:51], s6 offen offset:0 sc1 lds
  buffer_load_dwordx4 v32, s[48:51], s6 offen offset:1024 sc1 lds
  buffer_load_dword v35, v27, s[48:51], 0 offen
  buffer_load_dwordx4 v32, s[48:51], s6 offen offset:2048 sc1 lds
  buffer_load_dwordx4 v32, s[48:51], s6 offen offset:3072 sc1 lds
  buffer_load_dword v35, v27, s[48:51], 0 offen
  s_mov_b32 m0, 84480
  s_nop 0
  buffer_load_dwordx4 v33, s[48:51], s6 offen sc1 lds
  s_mov_b32 m0, 85504
  s_add_u32 s6, s64, 184320
  buffer_load_dwordx4 v32, s[48:51], s6 offen offset:0 sc1 lds
  buffer_load_dword v35, v27, s[48:51], 0 offen
  buffer_load_dwordx4 v32, s[48:51], s6 offen offset:1024 sc1 lds
  buffer_load_dwordx4 v32, s[48:51], s6 offen offset:2048 sc1 lds
  buffer_load_dword v35, v27, s[48:51], 0 offen
  buffer_load_dwordx4 v32, s[48:51], s6 offen offset:3072 sc1 lds
  s_mov_b32 m0, 89600
  s_nop 0
  buffer_load_dwordx4 v33, s[48:51], s6 offen sc1 lds
  buffer_load_dword v35, v27, s[48:51], 0 offen
  s_add_u32 s64, s64, 5120
  s_cmp_ge_u32 s64, s69
  s_cselect_b32 s64, s66, s64
  s_mov_b32 m0, 1260
  s_nop 0
  buffer_load_dword v27, s[48:51], 0 offen lds
  s_mov_b32 m0, 90624
  s_add_u32 s6, s64, 0
  buffer_load_dwordx4 v32, s[48:51], s6 offen offset:0 sc1 lds
  buffer_load_dwordx4 v32, s[48:51], s6 offen offset:1024 sc1 lds
  buffer_load_dword v35, v27, s[48:51], 0 offen
  buffer_load_dwordx4 v32, s[48:51], s6 offen offset:2048 sc1 lds
  buffer_load_dwordx4 v32, s[48:51], s6 offen offset:3072 sc1 lds
  buffer_load_dword v35, v27, s[48:51], 0 offen
  s_mov_b32 m0, 94720
  s_nop 0
  buffer_load_dwordx4 v33, s[48:51], s6 offen sc1 lds
  s_mov_b32 m0, 95744
  s_add_u32 s6, s64, 61440
  ds_read_b128 v[40:43], v36 offset:2000
  buffer_load_dwordx4 v32, s[48:51], s6 offen offset:0 sc1 lds
  buffer_load_dword v35, v27, s[48:51], 0 offen
  buffer_load_dwordx4 v32, s[48:51], s6 offen offset:1024 sc1 lds
  buffer_load_dwordx4 v32, s[48:51], s6 offen offset:2048 sc1 lds
  buffer_load_dword v35, v27, s[48:51], 0 offen
  buffer_load_dwordx4 v32, s[48:51], s6 offen offset:3072 sc1 lds
  s_mov_b32 m0, 99840
  s_nop 0
  buffer_load_dwordx4 v33, s[48:51], s6 offen sc1 lds
  buffer_load_dword v35, v27, s[48:51], 0 offen
  s_mov_b32 m0, 1264
  s_nop 0
  buffer_load_dword v27, s[48:51], 0 offen lds
  s_waitcnt lgkmcnt(0)
  v_or_b32 v39, v40, v41
  v_or3_b32 v39, v39, v42, v43
  s_nop 0
  v_readfirstlane_b32 s67, v39
  s_cmp_eq_u32 s67, 0
  s_cbranch_scc1 Llg_34
  v_mov_b32 v38, 2000
  s_call_b64 s[34:35], Llw_12
Llg_34:
  s_mov_b32 m0, 8704
  s_add_u32 s6, s64, 122880
  buffer_load_dwordx4 v32, s[48:51], s6 offen offset:0 sc1 lds
  buffer_load_dwordx4 v32, s[48:51], s6 offen offset:1024 sc1 lds
  buffer_load_dword v35, v27, s[48:51], 0 offen
  buffer_load_dwordx4 v32, s[48:51], s6 offen offset:2048 sc1 lds
  buffer_load_dwordx4 v32, s[48:51], s6 offen offset:3072 sc1 lds
  buffer_load_dword v35, v27, s[48:51], 0 offen
  s_mov_b32 m0, 12800
  s_nop 0
  buffer_load_dwordx4 v33, s[48:51], s6 offen sc1 lds
  s_mov_b32 m0, 13824
  s_add_u32 s6, s64, 184320
  buffer_load_dwordx4 v32, s[48:51], s6 offen offset:0 sc1 lds
  buffer_load_dword v35, v27, s[48:51], 0 offen
  buffer_load_dwordx4 v32, s[48:51], s6 offen offset:1024 sc1 lds
  buffer_load_dwordx4 v32, s[48:51], s6 offen offset:2048 sc1 lds
  buffer_load_dword v35, v27, s[48:51], 0 offen
  buffer_load_dwordx4 v32, s[48:51], s6 offen offset:3072 sc1 lds
  s_mov_b32 m0, 17920
  s_nop 0
  buffer_load_dwordx4 v33, s[48:51], s6 offen sc1 lds
  buffer_load_dword v35, v27, s[48:51], 0 offen
  s_add_u32 s64, s64, 5120
  s_cmp_ge_u32 s64, s69
  s_cselect_b32 s64, s66, s64
  s_mov_b32 m0, 1268
  s_nop 0
  buffer_load_dword v27, s[48:51], 0 offen lds
  s_mov_b32 m0, 100864
  s_add_u32 s6, s64, 0
  buffer_load_dwordx4 v32, s[48:51], s6 offen offset:0 sc1 lds
  buffer_load_dwordx4 v32, s[48:51], s6 offen offset:1024 sc1 lds
  buffer_load_dword v35, v27, s[48:51], 0 offen
  buffer_load_dwordx4 v32, s[48:51], s6 offen offset:2048 sc1 lds
  buffer_load_dwordx4 v32, s[48:51], s6 offen offset:3072 sc1 lds
  buffer_load_dword v35, v27, s[48:51], 0 offen
  s_mov_b32 m0, 104960
  s_nop 0
  buffer_load_dwordx4 v33, s[48:51], s6 offen sc1 lds
  s_mov_b32 m0, 105984
  s_add_u32 s6, s64, 61440
  buffer_load_dwordx4 v32, s[48:51], s6 offen offset:0 sc1 lds
  buffer_load_dword v35, v27, s[48:51], 0 offen
  buffer_load_dwordx4 v32, s[48:51], s6 offen offset:1024 sc1 lds
  buffer_load_dwordx4 v32, s[48:51], s6 offen offset:2048 sc1 lds
  buffer_load_dword v35, v27, s[48:51], 0 offen
  buffer_load_dwordx4 v32, s[48:51], s6 offen offset:3072 sc1 lds
  s_mov_b32 m0, 110080
  s_nop 0
  buffer_load_dwordx4 v33, s[48:51], s6 offen sc1 lds
  buffer_load_dword v35, v27, s[48:51], 0 offen
  s_mov_b32 m0, 1272
  s_nop 0
  buffer_load_dword v27, s[48:51], 0 offen lds
  s_mov_b32 m0, 111104
  s_add_u32 s6, s64, 122880
  buffer_load_dwordx4 v32, s[48:51], s6 offen offset:0 sc1 lds
  buffer_load_dwordx4 v32, s[48:51], s6 offen offset:1024 sc1 lds
  buffer_load_dword v35, v27, s[48:51], 0 offen
  buffer_load_dwordx4 v32, s[48:51], s6 offen offset:2048 sc1 lds
  buffer_load_dwordx4 v32, s[48:51], s6 offen offset:3072 sc1 lds
  buffer_load_dword v35, v27, s[48:51], 0 offen
  s_mov_b32 m0, 115200
  s_nop 0
  buffer_load_dwordx4 v33, s[48:51], s6 offen sc1 lds
  s_mov_b32 m0, 116224
  s_add_u32 s6, s64, 184320
  buffer_load_dwordx4 v32, s[48:51], s6 offen offset:0 sc1 lds
  buffer_load_dword v35, v27, s[48:51], 0 offen
  buffer_load_dwordx4 v32, s[48:51], s6 offen offset:1024 sc1 lds
  buffer_load_dwordx4 v32, s[48:51], s6 offen offset:2048 sc1 lds
  buffer_load_dword v35, v27, s[48:51], 0 offen
  buffer_load_dwordx4 v32, s[48:51], s6 offen offset:3072 sc1 lds
  s_mov_b32 m0, 120320
  s_nop 0
  buffer_load_dwordx4 v33, s[48:51], s6 offen sc1 lds
  buffer_load_dword v35, v27, s[48:51], 0 offen
  s_add_u32 s64, s64, 5120
  s_cmp_ge_u32 s64, s69
  s_cselect_b32 s64, s66, s64
  s_mov_b32 m0, 1276
  s_nop 0
  buffer_load_dword v27, s[48:51], 0 offen lds
Lload_end:
  s_cmp_ge_u32 s2, 192
  s_cbranch_scc1 Llf_36
  s_sub_u32 s12, s3, 6
  s_add_u32 s4, s12, 1
  s_mul_i32 s4, s4, 21248
  s_sub_u32 s69, 163840, s4
  s_lshl_b32 s4, s12, 2
  v_mov_b32 v12, s4
  v_and_b32 v50, 15, v1
  v_lshrrev_b32 v51, 4, v1
  v_add_u32 v46, 1, v50
  v_and_b32 v47, 3, v46
  v_mul_u32_u24 v48, 4160, v47
  v_lshrrev_b32 v46, 2, v46
  v_lshlrev_b32 v46, 3, v46
  v_sub_u32 v48, v48, v46
  v_lshl_add_u32 v48, v51, 4, v48
  s_sub_u32 s5, s69, 256
  s_add_u32 s4, s5, 288
  v_add_u32 v48, s4, v48
  v_lshlrev_b32 v49, 5, v50
  v_lshl_add_u32 v49, v51, 4, v49
  v_add_u32 v49, s5, v49
  v_mov_b32 v192, 0
  v_mov_b32 v193, 0
  v_mov_b32 v194, 0
  v_mov_b32 v195, 0
  v_mov_b32 v196, 0
  v_mov_b32 v197, 0
  v_mov_b32 v198, 0
  v_mov_b32 v199, 0
  v_mov_b32 v200, 0
  v_mov_b32 v201, 0
  v_mov_b32 v202, 0
  v_mov_b32 v203, 0
  v_mov_b32 v204, 0
  v_mov_b32 v205, 0
  v_mov_b32 v206, 0
  v_mov_b32 v207, 0
  v_mov_b32 v208, 0
  v_mov_b32 v209, 0
  v_mov_b32 v210, 0
  v_mov_b32 v211, 0
  v_mov_b32 v212, 0
  v_mov_b32 v213, 0
  v_mov_b32 v214, 0
  v_mov_b32 v215, 0
  v_mov_b32 v216, 0
  v_mov_b32 v217, 0
  v_mov_b32 v218, 0
  v_mov_b32 v219, 0
  v_mov_b32 v220, 0
  v_mov_b32 v221, 0
  v_mov_b32 v222, 0
  v_mov_b32 v223, 0
  s_mov_b32 s14, 1
  s_call_b64 s[34:35], Lconv
Lpoll_38:
  s_sub_u32 s0, s0, 1
  s_cbranch_scc1 Lexit_2
  ds_read_b32 v13, v12 offset:88
  s_waitcnt lgkmcnt(0)
  v_readfirstlane_b32 s10, v13
  s_cmp_lg_u32 s10, 0
  s_cbranch_scc1 Lok_37
  s_sleep 0
  s_branch Lpoll_38
Lok_37:
  v_lshlrev_b32 v5, 4, v1
  v_add_u32 v5, s69, v5
  s_nop 4
  ds_write_b128 v5, v[192:195] offset:0
  ds_write_b128 v5, v[196:199] offset:1024
  ds_write_b128 v5, v[200:203] offset:2048
  ds_write_b128 v5, v[204:207] offset:3072
  ds_write_b128 v5, v[208:211] offset:4096
  ds_write_b128 v5, v[212:215] offset:5120
  ds_write_b128 v5, v[216:219] offset:6144
  ds_write_b128 v5, v[220:223] offset:7168
  v_mov_b32 v13, 1
  ds_write_b32 v12, v13 offset:104
  s_waitcnt lgkmcnt(0)
  s_branch Lle_35
Llf_36:
  s_lshl_b32 s6, s68, 7
  s_add_u32 s6, s6, 0xdc0000
  s_waitcnt vmcnt(0)
  v_mov_b32 v10, 0
  v_mov_b32 v11, s1
  s_mov_b64 exec, 1
  buffer_store_dword v11, v10, s[48:51], s6 offen sc1
  s_mov_b64 exec, -1
Lle_35:
  s_waitcnt vmcnt(0) lgkmcnt(0)
  s_endpgm
Llw_12:
  s_sub_u32 s0, s0, 1
  s_cbranch_scc1 Lexit_2
  ds_read_b128 v[40:43], v38
  s_waitcnt lgkmcnt(0)
  v_or_b32 v39, v40, v41
  v_or3_b32 v39, v39, v42, v43
  s_nop 0
  v_readfirstlane_b32 s67, v39
  s_cmp_eq_u32 s67, 0
  s_cbranch_scc0 Llw_12
  s_setpc_b64 s[34:35]
Lrest_11:
  s_setprio 2
  s_and_b32 s4, s2, 7
  s_lshr_b32 s5, s2, 3
  s_and_b32 s60, s4, 1
  s_lshl_b32 s60, s60, 3
  s_and_b32 s6, s5, 7
  s_add_u32 s60, s60, s6
  s_lshr_b32 s61, s4, 1
  s_mul_i32 s61, s61, 3
  s_lshr_b32 s6, s5, 3
  s_add_u32 s61, s61, s6
  s_lshr_b32 s5, s2, 3
  s_and_b32 s62, s2, 1
  s_lshl_b32 s62, s62, 4
  s_bfe_u32 s4, s2, 0x10001
  s_lshl_b32 s4, s4, 3
  s_add_u32 s62, s62, s4
  s_and_b32 s6, s5, 7
  s_add_u32 s62, s62, s6
  s_and_b32 s63, s2, 4
  s_lshr_b32 s6, s5, 3
  s_add_u32 s63, s63, s6
  s_and_b32 s11, s3, 1
  s_lshr_b32 s12, s3, 1
  s_lshl_b32 s8, s60, 1
  s_add_u32 s8, s8, s11
  v_bfe_u32 v9, v1, 2, 2
  v_mul_u32_u24 v2, 1088, v9
  v_lshrrev_b32 v9, 5, v1
  v_lshl_add_u32 v2, v9, 9, v2
  v_bfe_u32 v9, v1, 4, 1
  v_lshl_add_u32 v2, v9, 5, v2
  v_and_b32 v9, 1, v1
  v_lshl_add_u32 v2, v9, 3, v2
  v_bfe_u32 v9, v1, 1, 1
  v_mul_u32_u24 v9, 4368, v9
  v_add_u32 v2, v9, v2
  s_lshl_b32 s4, s12, 4
  s_add_u32 s4, s4, 51200
  v_add_u32 v2, s4, v2
  v_add_u32 v3, 52416, v2
  v_and_b32 v9, 31, v1
  v_bfe_u32 v10, v1, 1, 3
  v_lshrrev_b32 v11, 5, v1
  v_xor_b32 v10, v10, v11
  v_lshlrev_b32 v10, 4, v10
  v_lshl_add_u32 v10, v9, 7, v10
  s_lshl_b32 s4, s11, 13
  s_add_u32 s4, s4, 2048
  v_xor_b32 v12, 0, v10
  v_add_u32 v12, s4, v12
  v_xor_b32 v13, 32, v10
  v_add_u32 v13, s4, v13
  v_xor_b32 v14, 64, v10
  v_add_u32 v14, s4, v14
  v_xor_b32 v15, 96, v10
  v_add_u32 v15, s4, v15
  v_mov_b32 v4, 0
  s_lshl_b32 s4, s3, 2
  v_mov_b32 v8, s4
  s_add_u32 s13, s4, 1664
  v_mov_b32 v6, 0x7ffffff0
  s_waitcnt lgkmcnt(0)
  s_barrier
  s_mov_b32 s0, 0x40000
  s_mov_b32 s48, s46
  s_mov_b32 s49, s47
  s_mov_b32 s50, 0x1200000
  s_mov_b32 s51, 0x20000
  v_and_b32 v9, 31, v1
  s_lshl_b32 s4, s12, 2
  v_subrev_u32 v9, s4, v9
  v_mov_b32 v10, 0x3f803f80
  v_cmp_eq_u32 vcc, 0, v9
  s_nop 1
  v_cndmask_b32 v24, 0, v10, vcc
  v_cndmask_b32 v25, 0, v10, vcc
  v_cndmask_b32 v26, 0, v10, vcc
  v_cndmask_b32 v27, 0, v10, vcc
  v_cmp_eq_u32 vcc, 1, v9
  s_nop 1
  v_cndmask_b32 v28, 0, v10, vcc
  v_cndmask_b32 v29, 0, v10, vcc
  v_cndmask_b32 v30, 0, v10, vcc
  v_cndmask_b32 v31, 0, v10, vcc
  v_cmp_eq_u32 vcc, 2, v9
  s_nop 1
  v_cndmask_b32 v32, 0, v10, vcc
  v_cndmask_b32 v33, 0, v10, vcc
  v_cndmask_b32 v34, 0, v10, vcc
  v_cndmask_b32 v35, 0, v10, vcc
  v_cmp_eq_u32 vcc, 8, v9
  s_nop 1
  v_cndmask_b32 v36, 0, v10, vcc
  v_cndmask_b32 v37, 0, v10, vcc
  v_cndmask_b32 v38, 0, v10, vcc
  v_cndmask_b32 v39, 0, v10, vcc
  s_and_b32 s4, s62, 7
  s_mul_i32 s4, s4, 3
  s_lshr_b32 s4, s4, 1
  s_mul_i32 s53, s63, 48
  s_mul_i32 s5, s3, 12
  s_add_u32 s53, s53, s5
  s_mul_i32 s53, s53, 5120
  s_add_u32 s53, s53, 0x1000000
  s_mul_i32 s5, s4, 5120
  s_add_u32 s52, s53, s5
  s_add_u32 s53, s53, 61440
  s_mul_i32 s55, s62, 196608
  s_mul_i32 s5, s3, 24576
  s_add_u32 s55, s55, s5
  s_add_u32 s55, s55, 0x500000
  s_add_u32 s56, s55, 24576
  s_lshl_b32 s5, s4, 11
  s_add_u32 s54, s55, s5
  v_lshlrev_b32 v7, 4, v1
  v_add_u32 v22, 4096, v7
  v_mov_b32 v10, 0
  ds_write_b32 v8, v10 offset:1680
  s_waitcnt vmcnt(0)
  v_mov_b32 v11, 1408
  s_call_b64 s[34:35], Lfw_39
Lok_40:
  ds_read_b128 v[96:99], v12 offset:0
  ds_read_b64_tr_b16 v[80:81], v3 offset:25920
  ds_read_b64_tr_b16 v[82:83], v3 offset:26176
  ds_read_b128 v[100:103], v12 offset:4096
  ds_read_b64_tr_b16 v[84:85], v3 offset:25984
  ds_read_b64_tr_b16 v[86:87], v3 offset:26240
  ds_read_b64_tr_b16 v[88:89], v3 offset:26048
  ds_read_b64_tr_b16 v[90:91], v3 offset:26304
  ds_read_b64_tr_b16 v[92:93], v3 offset:26112
  ds_read_b64_tr_b16 v[94:95], v3 offset:26368
  s_waitcnt lgkmcnt(7)
  v_mfma_f32_32x32x16_bf16 v[128:143], v[80:83], v[96:99], 0
  ds_read_b128 v[120:123], v13 offset:0
  s_waitcnt lgkmcnt(7)
  v_mfma_f32_32x32x16_bf16 v[192:207], v[80:83], v[100:103], 0
  ds_read_b64_tr_b16 v[104:105], v3 offset:34656
  ds_read_b64_tr_b16 v[106:107], v3 offset:34912
  v_mfma_f32_32x32x16_bf16 v[40:55], v[24:27], v[80:83], 0
  s_waitcnt lgkmcnt(7)
  v_mfma_f32_32x32x16_bf16 v[144:159], v[84:87], v[96:99], 0
  ds_read_b128 v[124:127], v13 offset:4096
  ds_read_b32 v5, v4 offset:1412
  v_mfma_f32_32x32x16_bf16 v[208:223], v[84:87], v[100:103], 0
  ds_read_b64_tr_b16 v[108:109], v3 offset:34720
  ds_read_b64_tr_b16 v[110:111], v3 offset:34976
  v_mfma_f32_32x32x16_bf16 v[40:55], v[28:31], v[84:87], v[40:55]
  s_waitcnt lgkmcnt(9)
  v_mfma_f32_32x32x16_bf16 v[160:175], v[88:91], v[96:99], 0
  ds_read_b64_tr_b16 v[112:113], v3 offset:34784
  ds_read_b64_tr_b16 v[114:115], v3 offset:35040
  v_mfma_f32_32x32x16_bf16 v[224:239], v[88:91], v[100:103], 0
  ds_read_b64_tr_b16 v[116:117], v3 offset:34848
  ds_read_b64_tr_b16 v[118:119], v3 offset:35104
  v_mfma_f32_32x32x16_bf16 v[40:55], v[32:35], v[88:91], v[40:55]
  s_waitcnt lgkmcnt(11)
  v_mfma_f32_32x32x16_bf16 v[176:191], v[92:95], v[96:99], 0
  v_mfma_f32_32x32x16_bf16 v[240:255], v[92:95], v[100:103], 0
  s_waitcnt lgkmcnt(6)
  v_readfirstlane_b32 s15, v5
  v_mfma_f32_32x32x16_bf16 v[40:55], v[36:39], v[92:95], v[40:55]
  v_mfma_f32_32x32x16_bf16 v[128:143], v[104:107], v[120:123], v[128:143]
  s_mov_b32 s10, s15
  s_cmp_eq_u32 s10, 0
  s_cbranch_scc1 Lok_41
  v_mov_b32 v11, 1412
  s_call_b64 s[34:35], Lfw_39
Lok_41:
  ds_read_b128 v[96:99], v14 offset:0
  v_mfma_f32_32x32x16_bf16 v[192:207], v[104:107], v[124:127], v[192:207]
  ds_read_b64_tr_b16 v[80:81], v2 offset:0
  ds_read_b64_tr_b16 v[82:83], v2 offset:256
  v_mfma_f32_32x32x16_bf16 v[40:55], v[24:27], v[104:107], v[40:55]
  s_waitcnt lgkmcnt(7)
  v_mfma_f32_32x32x16_bf16 v[144:159], v[108:111], v[120:123], v[144:159]
  ds_read_b128 v[100:103], v14 offset:4096
  v_mfma_f32_32x32x16_bf16 v[208:223], v[108:111], v[124:127], v[208:223]
  ds_read_b64_tr_b16 v[84:85], v2 offset:64
  ds_read_b64_tr_b16 v[86:87], v2 offset:320
  v_mfma_f32_32x32x16_bf16 v[40:55], v[28:31], v[108:111], v[40:55]
  s_waitcnt lgkmcnt(8)
  v_mfma_f32_32x32x16_bf16 v[160:175], v[112:115], v[120:123], v[160:175]
  ds_read_b64_tr_b16 v[88:89], v2 offset:128
  ds_read_b64_tr_b16 v[90:91], v2 offset:384
  v_mfma_f32_32x32x16_bf16 v[224:239], v[112:115], v[124:127], v[224:239]
  ds_read_b64_tr_b16 v[92:93], v2 offset:192
  ds_read_b64_tr_b16 v[94:95], v2 offset:448
  v_mfma_f32_32x32x16_bf16 v[40:55], v[32:35], v[112:115], v[40:55]
  s_waitcnt lgkmcnt(10)
  v_mfma_f32_32x32x16_bf16 v[176:191], v[116:119], v[120:123], v[176:191]
  v_mov_b32 v10, 0
  ds_write_b32 v8, v10 offset:1696
  v_mfma_f32_32x32x16_bf16 v[240:255], v[116:119], v[124:127], v[240:255]
  v_mfma_f32_32x32x16_bf16 v[40:55], v[36:39], v[116:119], v[40:55]
  s_waitcnt lgkmcnt(8)
  v_mfma_f32_32x32x16_bf16 v[128:143], v[80:83], v[96:99], v[128:143]
  ds_read_b128 v[120:123], v15 offset:0
  s_waitcnt lgkmcnt(8)
  v_mfma_f32_32x32x16_bf16 v[192:207], v[80:83], v[100:103], v[192:207]
  ds_read_b64_tr_b16 v[104:105], v2 offset:8736
  ds_read_b64_tr_b16 v[106:107], v2 offset:8992
  v_mfma_f32_32x32x16_bf16 v[40:55], v[24:27], v[80:83], v[40:55]
  s_waitcnt lgkmcnt(8)
  v_mfma_f32_32x32x16_bf16 v[144:159], v[84:87], v[96:99], v[144:159]
  ds_read_b128 v[124:127], v15 offset:4096
  ds_read_b32 v5, v4 offset:1416
  v_mfma_f32_32x32x16_bf16 v[208:223], v[84:87], v[100:103], v[208:223]
  ds_read_b64_tr_b16 v[108:109], v2 offset:8800
  ds_read_b64_tr_b16 v[110:111], v2 offset:9056
  v_mfma_f32_32x32x16_bf16 v[40:55], v[28:31], v[84:87], v[40:55]
  s_waitcnt lgkmcnt(10)
  v_mfma_f32_32x32x16_bf16 v[160:175], v[88:91], v[96:99], v[160:175]
  ds_read_b64_tr_b16 v[112:113], v2 offset:8864
  ds_read_b64_tr_b16 v[114:115], v2 offset:9120
  v_mfma_f32_32x32x16_bf16 v[224:239], v[88:91], v[100:103], v[224:239]
  ds_read_b64_tr_b16 v[116:117], v2 offset:8928
  ds_read_b64_tr_b16 v[118:119], v2 offset:9184
  v_mfma_f32_32x32x16_bf16 v[40:55], v[32:35], v[88:91], v[40:55]
  s_waitcnt lgkmcnt(12)
  v_mfma_f32_32x32x16_bf16 v[176:191], v[92:95], v[96:99], v[176:191]
  v_mfma_f32_32x32x16_bf16 v[240:255], v[92:95], v[100:103], v[240:255]
  s_waitcnt lgkmcnt(6)
  v_readfirstlane_b32 s15, v5
  v_mfma_f32_32x32x16_bf16 v[40:55], v[36:39], v[92:95], v[40:55]
  v_mfma_f32_32x32x16_bf16 v[128:143], v[104:107], v[120:123], v[128:143]
  s_mov_b32 s10, s15
  s_cmp_eq_u32 s10, 0
  s_cbranch_scc1 Lok_42
  v_mov_b32 v11, 1416
  s_call_b64 s[34:35], Lfw_39
Lok_42:
  ds_read_b128 v[96:99], v12 offset:32768
  v_mfma_f32_32x32x16_bf16 v[192:207], v[104:107], v[124:127], v[192:207]
  ds_read_b64_tr_b16 v[80:81], v2 offset:17472
  ds_read_b64_tr_b16 v[82:83], v2 offset:17728
  v_mfma_f32_32x32x16_bf16 v[40:55], v[24:27], v[104:107], v[40:55]
  s_waitcnt lgkmcnt(7)
  v_mfma_f32_32x32x16_bf16 v[144:159], v[108:111], v[120:123], v[144:159]
  ds_read_b128 v[100:103], v12 offset:36864
  v_mfma_f32_32x32x16_bf16 v[208:223], v[108:111], v[124:127], v[208:223]
  ds_read_b64_tr_b16 v[84:85], v2 offset:17536
  ds_read_b64_tr_b16 v[86:87], v2 offset:17792
  v_mfma_f32_32x32x16_bf16 v[40:55], v[28:31], v[108:111], v[40:55]
  s_waitcnt lgkmcnt(8)
  v_mfma_f32_32x32x16_bf16 v[160:175], v[112:115], v[120:123], v[160:175]
  ds_read_b64_tr_b16 v[88:89], v2 offset:17600
  ds_read_b64_tr_b16 v[90:91], v2 offset:17856
  v_mfma_f32_32x32x16_bf16 v[224:239], v[112:115], v[124:127], v[224:239]
  ds_read_b64_tr_b16 v[92:93], v2 offset:17664
  ds_read_b64_tr_b16 v[94:95], v2 offset:17920
  v_mfma_f32_32x32x16_bf16 v[40:55], v[32:35], v[112:115], v[40:55]
  s_waitcnt lgkmcnt(10)
  v_mfma_f32_32x32x16_bf16 v[176:191], v[116:119], v[120:123], v[176:191]
  v_mov_b32 v10, 0
  ds_write_b32 v8, v10 offset:1712
  v_mfma_f32_32x32x16_bf16 v[240:255], v[116:119], v[124:127], v[240:255]
  v_mfma_f32_32x32x16_bf16 v[40:55], v[36:39], v[116:119], v[40:55]
  s_waitcnt lgkmcnt(8)
  v_mfma_f32_32x32x16_bf16 v[128:143], v[80:83], v[96:99], v[128:143]
  ds_read_b128 v[120:123], v13 offset:32768
  s_waitcnt lgkmcnt(8)
  v_mfma_f32_32x32x16_bf16 v[192:207], v[80:83], v[100:103], v[192:207]
  ds_read_b64_tr_b16 v[104:105], v2 offset:26208
  ds_read_b64_tr_b16 v[106:107], v2 offset:26464
  s_waitcnt lgkmcnt(8)
  v_mfma_f32_32x32x16_bf16 v[144:159], v[84:87], v[96:99], v[144:159]
  ds_read_b128 v[124:127], v13 offset:36864
  ds_read_b32 v5, v4 offset:1420
  v_mfma_f32_32x32x16_bf16 v[208:223], v[84:87], v[100:103], v[208:223]
  ds_read_b64_tr_b16 v[108:109], v2 offset:26272
  ds_read_b64_tr_b16 v[110:111], v2 offset:26528
  s_waitcnt lgkmcnt(10)
  v_mfma_f32_32x32x16_bf16 v[160:175], v[88:91], v[96:99], v[160:175]
  ds_read_b64_tr_b16 v[112:113], v2 offset:26336
  ds_read_b64_tr_b16 v[114:115], v2 offset:26592
  v_mfma_f32_32x32x16_bf16 v[224:239], v[88:91], v[100:103], v[224:239]
  ds_read_b64_tr_b16 v[116:117], v2 offset:26400
  ds_read_b64_tr_b16 v[118:119], v2 offset:26656
  s_waitcnt lgkmcnt(12)
  v_mfma_f32_32x32x16_bf16 v[176:191], v[92:95], v[96:99], v[176:191]
  v_mfma_f32_32x32x16_bf16 v[240:255], v[92:95], v[100:103], v[240:255]
  s_waitcnt lgkmcnt(6)
  v_readfirstlane_b32 s15, v5
  v_mfma_f32_32x32x16_bf16 v[128:143], v[104:107], v[120:123], v[128:143]
  s_mov_b32 s10, s15
  s_cmp_eq_u32 s10, 0
  s_cbranch_scc1 Lok_43
  v_mov_b32 v11, 1420
  s_call_b64 s[34:35], Lfw_39
Lok_43:
  ds_read_b128 v[96:99], v14 offset:32768
  v_mfma_f32_32x32x16_bf16 v[192:207], v[104:107], v[124:127], v[192:207]
  ds_read_b64_tr_b16 v[80:81], v2 offset:34944
  ds_read_b64_tr_b16 v[82:83], v2 offset:35200
  s_waitcnt lgkmcnt(7)
  v_mfma_f32_32x32x16_bf16 v[144:159], v[108:111], v[120:123], v[144:159]
  ds_read_b128 v[100:103], v14 offset:36864
  v_mfma_f32_32x32x16_bf16 v[208:223], v[108:111], v[124:127], v[208:223]
  ds_read_b64_tr_b16 v[84:85], v2 offset:35008
  ds_read_b64_tr_b16 v[86:87], v2 offset:35264
  s_waitcnt lgkmcnt(8)
  v_mfma_f32_32x32x16_bf16 v[160:175], v[112:115], v[120:123], v[160:175]
  ds_read_b64_tr_b16 v[88:89], v2 offset:35072
  ds_read_b64_tr_b16 v[90:91], v2 offset:35328
  v_mfma_f32_32x32x16_bf16 v[224:239], v[112:115], v[124:127], v[224:239]
  ds_read_b64_tr_b16 v[92:93], v2 offset:35136
  ds_read_b64_tr_b16 v[94:95], v2 offset:35392
  s_waitcnt lgkmcnt(10)
  v_mfma_f32_32x32x16_bf16 v[176:191], v[116:119], v[120:123], v[176:191]
  v_mov_b32 v10, 0
  ds_write_b32 v8, v10 offset:1728
  v_mfma_f32_32x32x16_bf16 v[240:255], v[116:119], v[124:127], v[240:255]
  ds_read_b32 v20, v4 offset:4
  s_waitcnt lgkmcnt(9)
  v_mfma_f32_32x32x16_bf16 v[128:143], v[80:83], v[96:99], v[128:143]
  ds_read_b128 v[120:123], v15 offset:32768
  s_waitcnt lgkmcnt(9)
  v_mfma_f32_32x32x16_bf16 v[192:207], v[80:83], v[100:103], v[192:207]
  ds_read_b64_tr_b16 v[104:105], v2 offset:43680
  ds_read_b64_tr_b16 v[106:107], v2 offset:43936
  s_waitcnt lgkmcnt(9)
  v_mfma_f32_32x32x16_bf16 v[144:159], v[84:87], v[96:99], v[144:159]
  ds_read_b128 v[124:127], v15 offset:36864
  ds_read_b32 v5, v4 offset:1424
  v_mfma_f32_32x32x16_bf16 v[208:223], v[84:87], v[100:103], v[208:223]
  ds_read_b64_tr_b16 v[108:109], v2 offset:43744
  ds_read_b64_tr_b16 v[110:111], v2 offset:44000
  s_waitcnt lgkmcnt(11)
  v_mfma_f32_32x32x16_bf16 v[160:175], v[88:91], v[96:99], v[160:175]
  ds_read_b64_tr_b16 v[112:113], v2 offset:43808
  ds_read_b64_tr_b16 v[114:115], v2 offset:44064
  v_mfma_f32_32x32x16_bf16 v[224:239], v[88:91], v[100:103], v[224:239]
  ds_read_b64_tr_b16 v[116:117], v2 offset:43872
  ds_read_b64_tr_b16 v[118:119], v2 offset:44128
  s_waitcnt lgkmcnt(13)
  v_mfma_f32_32x32x16_bf16 v[176:191], v[92:95], v[96:99], v[176:191]
  v_mfma_f32_32x32x16_bf16 v[240:255], v[92:95], v[100:103], v[240:255]
  s_waitcnt lgkmcnt(6)
  v_readfirstlane_b32 s15, v5
  v_readfirstlane_b32 s1, v20
  s_cmp_lg_u32 s1, 0
  s_cbranch_scc0 Lpoll_46
Lok_45:
  s_cmp_ge_u32 s60, 10
  s_cbranch_scc1 Lcs_44
  s_cmp_lg_u32 s11, 0
  s_cbranch_scc1 Lcs_44
  v_mov_b32 v43, s1
  v_mov_b32 v45, s1
  v_lshlrev_b32 v9, 4, v1
  v_lshlrev_b32 v10, 3, v1
  s_mul_i32 s6, s61, 10
  s_add_u32 s6, s6, s60
  s_lshl_b32 s6, s6, 11
  s_add_u32 s6, s6, 0x10000
  s_sub_u32 exec_lo, s12, 1
  s_not_b32 exec_hi, exec_lo
  buffer_store_dwordx4 v[40:43], v9, s[48:51], s6 offen sc1
  buffer_store_dwordx2 v[44:45], v10, s[48:51], s6 offen offset:1024 sc1
  s_mov_b64 exec, -1
Lcs_44:
  v_mfma_f32_32x32x16_bf16 v[128:143], v[104:107], v[120:123], v[128:143]
  s_mov_b32 s10, s15
  s_cmp_eq_u32 s10, 0
  s_cbranch_scc1 Lok_47
  v_mov_b32 v11, 1424
  s_call_b64 s[34:35], Lfw_39
Lok_47:
  ds_read_b128 v[96:99], v12 offset:16384
  v_mfma_f32_32x32x16_bf16 v[192:207], v[104:107], v[124:127], v[192:207]
  ds_read_b64_tr_b16 v[80:81], v3 offset:0
  ds_read_b64_tr_b16 v[82:83], v3 offset:256
  s_waitcnt lgkmcnt(7)
  v_mfma_f32_32x32x16_bf16 v[144:159], v[108:111], v[120:123], v[144:159]
  ds_read_b128 v[100:103], v12 offset:20480
  v_mfma_f32_32x32x16_bf16 v[208:223], v[108:111], v[124:127], v[208:223]
  ds_read_b64_tr_b16 v[84:85], v3 offset:64
  ds_read_b64_tr_b16 v[86:87], v3 offset:320
  s_waitcnt lgkmcnt(8)
  v_mfma_f32_32x32x16_bf16 v[160:175], v[112:115], v[120:123], v[160:175]
  ds_read_b64_tr_b16 v[88:89], v3 offset:128
  ds_read_b64_tr_b16 v[90:91], v3 offset:384
  v_mfma_f32_32x32x16_bf16 v[224:239], v[112:115], v[124:127], v[224:239]
  ds_read_b64_tr_b16 v[92:93], v3 offset:192
  ds_read_b64_tr_b16 v[94:95], v3 offset:448
  s_waitcnt lgkmcnt(10)
  v_mfma_f32_32x32x16_bf16 v[176:191], v[116:119], v[120:123], v[176:191]
  v_mov_b32 v10, 0
  ds_write_b32 v8, v10 offset:1744
  v_mfma_f32_32x32x16_bf16 v[240:255], v[116:119], v[124:127], v[240:255]
  s_waitcnt lgkmcnt(8)
  v_mfma_f32_32x32x16_bf16 v[128:143], v[80:83], v[96:99], v[128:143]
  ds_read_b128 v[120:123], v13 offset:16384
  s_waitcnt lgkmcnt(8)
  v_mfma_f32_32x32x16_bf16 v[192:207], v[80:83], v[100:103], v[192:207]
  ds_read_b64_tr_b16 v[104:105], v3 offset:8736
  ds_read_b64_tr_b16 v[106:107], v3 offset:8992
  s_waitcnt lgkmcnt(8)
  v_mfma_f32_32x32x16_bf16 v[144:159], v[84:87], v[96:99], v[144:159]
  ds_read_b128 v[124:127], v13 offset:20480
  ds_read_b32 v5, v4 offset:1428
  v_mfma_f32_32x32x16_bf16 v[208:223], v[84:87], v[100:103], v[208:223]
  ds_read_b64_tr_b16 v[108:109], v3 offset:8800
  ds_read_b64_tr_b16 v[110:111], v3 offset:9056
  s_waitcnt lgkmcnt(10)
  v_mfma_f32_32x32x16_bf16 v[160:175], v[88:91], v[96:99], v[160:175]
  ds_read_b64_tr_b16 v[112:113], v3 offset:8864
  ds_read_b64_tr_b16 v[114:115], v3 offset:9120
  v_mfma_f32_32x32x16_bf16 v[224:239], v[88:91], v[100:103], v[224:239]
  ds_read_b64_tr_b16 v[116:117], v3 offset:8928
  ds_read_b64_tr_b16 v[118:119], v3 offset:9184
  s_waitcnt lgkmcnt(12)
  v_mfma_f32_32x32x16_bf16 v[176:191], v[92:95], v[96:99], v[176:191]
  v_mfma_f32_32x32x16_bf16 v[240:255], v[92:95], v[100:103], v[240:255]
  s_waitcnt lgkmcnt(6)
  v_readfirstlane_b32 s15, v5
  v_mfma_f32_32x32x16_bf16 v[128:143], v[104:107], v[120:123], v[128:143]
  s_mov_b32 s10, s15
  s_cmp_eq_u32 s10, 0
  s_cbranch_scc1 Lok_48
  v_mov_b32 v11, 1428
  s_call_b64 s[34:35], Lfw_39
Lok_48:
  ds_read_b128 v[96:99], v14 offset:16384
  v_mfma_f32_32x32x16_bf16 v[192:207], v[104:107], v[124:127], v[192:207]
  ds_read_b64_tr_b16 v[80:81], v3 offset:25920
  ds_read_b64_tr_b16 v[82:83], v3 offset:26176
  s_waitcnt lgkmcnt(7)
  v_mfma_f32_32x32x16_bf16 v[144:159], v[108:111], v[120:123], v[144:159]
  ds_read_b128 v[100:103], v14 offset:20480
  v_mfma_f32_32x32x16_bf16 v[208:223], v[108:111], v[124:127], v[208:223]
  ds_read_b64_tr_b16 v[84:85], v3 offset:25984
  ds_read_b64_tr_b16 v[86:87], v3 offset:26240
  s_waitcnt lgkmcnt(8)
  v_mfma_f32_32x32x16_bf16 v[160:175], v[112:115], v[120:123], v[160:175]
  ds_read_b64_tr_b16 v[88:89], v3 offset:26048
  ds_read_b64_tr_b16 v[90:91], v3 offset:26304
  v_mfma_f32_32x32x16_bf16 v[224:239], v[112:115], v[124:127], v[224:239]
  ds_read_b64_tr_b16 v[92:93], v3 offset:26112
  ds_read_b64_tr_b16 v[94:95], v3 offset:26368
  s_waitcnt lgkmcnt(10)
  v_mfma_f32_32x32x16_bf16 v[176:191], v[116:119], v[120:123], v[176:191]
  v_mov_b32 v10, 0
  ds_write_b32 v8, v10 offset:1760
  v_mfma_f32_32x32x16_bf16 v[240:255], v[116:119], v[124:127], v[240:255]
  s_waitcnt lgkmcnt(8)
  v_mfma_f32_32x32x16_bf16 v[128:143], v[80:83], v[96:99], v[128:143]
  ds_read_b128 v[120:123], v15 offset:16384
  s_waitcnt lgkmcnt(8)
  v_mfma_f32_32x32x16_bf16 v[192:207], v[80:83], v[100:103], v[192:207]
  ds_read_b64_tr_b16 v[104:105], v3 offset:34656
  ds_read_b64_tr_b16 v[106:107], v3 offset:34912
  s_waitcnt lgkmcnt(8)
  v_mfma_f32_32x32x16_bf16 v[144:159], v[84:87], v[96:99], v[144:159]
  ds_read_b128 v[124:127], v15 offset:20480
  ds_read_b32 v5, v4 offset:1432
  v_mfma_f32_32x32x16_bf16 v[208:223], v[84:87], v[100:103], v[208:223]
  ds_read_b64_tr_b16 v[108:109], v3 offset:34720
  ds_read_b64_tr_b16 v[110:111], v3 offset:34976
  s_waitcnt lgkmcnt(10)
  v_mfma_f32_32x32x16_bf16 v[160:175], v[88:91], v[96:99], v[160:175]
  ds_read_b64_tr_b16 v[112:113], v3 offset:34784
  ds_read_b64_tr_b16 v[114:115], v3 offset:35040
  v_mfma_f32_32x32x16_bf16 v[224:239], v[88:91], v[100:103], v[224:239]
  ds_read_b64_tr_b16 v[116:117], v3 offset:34848
  ds_read_b64_tr_b16 v[118:119], v3 offset:35104
  s_waitcnt lgkmcnt(12)
  v_mfma_f32_32x32x16_bf16 v[176:191], v[92:95], v[96:99], v[176:191]
  v_mfma_f32_32x32x16_bf16 v[240:255], v[92:95], v[100:103], v[240:255]
  s_waitcnt lgkmcnt(6)
  v_readfirstlane_b32 s15, v5
  v_mfma_f32_32x32x16_bf16 v[128:143], v[104:107], v[120:123], v[128:143]
  s_mov_b32 s10, s15
  s_cmp_eq_u32 s10, 0
  s_cbranch_scc0 Lfs_50
Lok_49:
  ds_read_b128 v[96:99], v12 offset:0
  v_mfma_f32_32x32x16_bf16 v[192:207], v[104:107], v[124:127], v[192:207]
  ds_read_b64_tr_b16 v[80:81], v2 offset:0
  ds_read_b64_tr_b16 v[82:83], v2 offset:256
  s_waitcnt lgkmcnt(7)
  v_mfma_f32_32x32x16_bf16 v[144:159], v[108:111], v[120:123], v[144:159]
  ds_read_b128 v[100:103], v12 offset:4096
  v_mfma_f32_32x32x16_bf16 v[208:223], v[108:111], v[124:127], v[208:223]
  ds_read_b64_tr_b16 v[84:85], v2 offset:64
  ds_read_b64_tr_b16 v[86:87], v2 offset:320
  s_waitcnt lgkmcnt(8)
  v_mfma_f32_32x32x16_bf16 v[160:175], v[112:115], v[120:123], v[160:175]
  ds_read_b64_tr_b16 v[88:89], v2 offset:128
  ds_read_b64_tr_b16 v[90:91], v2 offset:384
  v_mfma_f32_32x32x16_bf16 v[224:239], v[112:115], v[124:127], v[224:239]
  ds_read_b64_tr_b16 v[92:93], v2 offset:192
  ds_read_b64_tr_b16 v[94:95], v2 offset:448
  s_waitcnt lgkmcnt(10)
  v_mfma_f32_32x32x16_bf16 v[176:191], v[116:119], v[120:123], v[176:191]
  v_mov_b32 v10, 0
  ds_write_b32 v8, v10 offset:1776
  v_mfma_f32_32x32x16_bf16 v[240:255], v[116:119], v[124:127], v[240:255]
  s_waitcnt lgkmcnt(8)
  v_mfma_f32_32x32x16_bf16 v[128:143], v[80:83], v[96:99], v[128:143]
  ds_read_b128 v[120:123], v13 offset:0
  s_waitcnt lgkmcnt(8)
  v_mfma_f32_32x32x16_bf16 v[192:207], v[80:83], v[100:103], v[192:207]
  ds_read_b64_tr_b16 v[104:105], v2 offset:8736
  ds_read_b64_tr_b16 v[106:107], v2 offset:8992
  s_waitcnt lgkmcnt(8)
  v_mfma_f32_32x32x16_bf16 v[144:159], v[84:87], v[96:99], v[144:159]
  ds_read_b128 v[124:127], v13 offset:4096
  ds_read_b32 v5, v4 offset:1436
  v_mfma_f32_32x32x16_bf16 v[208:223], v[84:87], v[100:103], v[208:223]
  ds_read_b64_tr_b16 v[108:109], v2 offset:8800
  ds_read_b64_tr_b16 v[110:111], v2 offset:9056
  s_waitcnt lgkmcnt(10)
  v_mfma_f32_32x32x16_bf16 v[160:175], v[88:91], v[96:99], v[160:175]
  ds_read_b64_tr_b16 v[112:113], v2 offset:8864
  ds_read_b64_tr_b16 v[114:115], v2 offset:9120
  v_mfma_f32_32x32x16_bf16 v[224:239], v[88:91], v[100:103], v[224:239]
  ds_read_b64_tr_b16 v[116:117], v2 offset:8928
  ds_read_b64_tr_b16 v[118:119], v2 offset:9184
  s_waitcnt lgkmcnt(12)
  v_mfma_f32_32x32x16_bf16 v[176:191], v[92:95], v[96:99], v[176:191]
  v_mfma_f32_32x32x16_bf16 v[240:255], v[92:95], v[100:103], v[240:255]
  s_waitcnt lgkmcnt(6)
  v_readfirstlane_b32 s15, v5
  v_mfma_f32_32x32x16_bf16 v[128:143], v[104:107], v[120:123], v[128:143]
  s_mov_b32 s10, s15
  s_cmp_eq_u32 s10, 0
  s_cbranch_scc0 Lfs_52
Lok_51:
  ds_read_b128 v[96:99], v14 offset:0
  v_mfma_f32_32x32x16_bf16 v[192:207], v[104:107], v[124:127], v[192:207]
  ds_read_b64_tr_b16 v[80:81], v2 offset:17472
  ds_read_b64_tr_b16 v[82:83], v2 offset:17728
  s_waitcnt lgkmcnt(7)
  v_mfma_f32_32x32x16_bf16 v[144:159], v[108:111], v[120:123], v[144:159]
  ds_read_b128 v[100:103], v14 offset:4096
  v_mfma_f32_32x32x16_bf16 v[208:223], v[108:111], v[124:127], v[208:223]
  ds_read_b64_tr_b16 v[84:85], v2 offset:17536
  ds_read_b64_tr_b16 v[86:87], v2 offset:17792
  s_waitcnt lgkmcnt(8)
  v_mfma_f32_32x32x16_bf16 v[160:175], v[112:115], v[120:123], v[160:175]
  ds_read_b64_tr_b16 v[88:89], v2 offset:17600
  ds_read_b64_tr_b16 v[90:91], v2 offset:17856
  v_mfma_f32_32x32x16_bf16 v[224:239], v[112:115], v[124:127], v[224:239]
  ds_read_b64_tr_b16 v[92:93], v2 offset:17664
  ds_read_b64_tr_b16 v[94:95], v2 offset:17920
  s_waitcnt lgkmcnt(10)
  v_mfma_f32_32x32x16_bf16 v[176:191], v[116:119], v[120:123], v[176:191]
  v_mov_b32 v10, 0
  ds_write_b32 v8, v10 offset:1792
  v_mfma_f32_32x32x16_bf16 v[240:255], v[116:119], v[124:127], v[240:255]
  s_waitcnt lgkmcnt(8)
  v_mfma_f32_32x32x16_bf16 v[128:143], v[80:83], v[96:99], v[128:143]
  ds_read_b128 v[120:123], v15 offset:0
  s_waitcnt lgkmcnt(8)
  v_mfma_f32_32x32x16_bf16 v[192:207], v[80:83], v[100:103], v[192:207]
  ds_read_b64_tr_b16 v[104:105], v2 offset:26208
  ds_read_b64_tr_b16 v[106:107], v2 offset:26464
  s_waitcnt lgkmcnt(8)
  v_mfma_f32_32x32x16_bf16 v[144:159], v[84:87], v[96:99], v[144:159]
  ds_read_b128 v[124:127], v15 offset:4096
  ds_read_b32 v5, v4 offset:1440
  v_mfma_f32_32x32x16_bf16 v[208:223], v[84:87], v[100:103], v[208:223]
  ds_read_b64_tr_b16 v[108:109], v2 offset:26272
  ds_read_b64_tr_b16 v[110:111], v2 offset:26528
  s_waitcnt lgkmcnt(10)
  v_mfma_f32_32x32x16_bf16 v[160:175], v[88:91], v[96:99], v[160:175]
  ds_read_b64_tr_b16 v[112:113], v2 offset:26336
  ds_read_b64_tr_b16 v[114:115], v2 offset:26592
  v_mfma_f32_32x32x16_bf16 v[224:239], v[88:91], v[100:103], v[224:239]
  ds_read_b64_tr_b16 v[116:117], v2 offset:26400
  ds_read_b64_tr_b16 v[118:119], v2 offset:26656
  s_waitcnt lgkmcnt(12)
  v_mfma_f32_32x32x16_bf16 v[176:191], v[92:95], v[96:99], v[176:191]
  v_mfma_f32_32x32x16_bf16 v[240:255], v[92:95], v[100:103], v[240:255]
  s_waitcnt lgkmcnt(6)
  v_readfirstlane_b32 s15, v5
  v_mfma_f32_32x32x16_bf16 v[128:143], v[104:107], v[120:123], v[128:143]
  s_mov_b32 s10, s15
  s_cmp_eq_u32 s10, 0
  s_cbranch_scc0 Lfs_54
Lok_53:
  ds_read_b128 v[96:99], v12 offset:32768
  v_mfma_f32_32x32x16_bf16 v[192:207], v[104:107], v[124:127], v[192:207]
  ds_read_b64_tr_b16 v[80:81], v2 offset:34944
  ds_read_b64_tr_b16 v[82:83], v2 offset:35200
  s_waitcnt lgkmcnt(7)
  v_mfma_f32_32x32x16_bf16 v[144:159], v[108:111], v[120:123], v[144:159]
  ds_read_b128 v[100:103], v12 offset:36864
  v_mfma_f32_32x32x16_bf16 v[208:223], v[108:111], v[124:127], v[208:223]
  ds_read_b64_tr_b16 v[84:85], v2 offset:35008
  ds_read_b64_tr_b16 v[86:87], v2 offset:35264
  s_waitcnt lgkmcnt(8)
  v_mfma_f32_32x32x16_bf16 v[160:175], v[112:115], v[120:123], v[160:175]
  ds_read_b64_tr_b16 v[88:89], v2 offset:35072
  ds_read_b64_tr_b16 v[90:91], v2 offset:35328
  v_mfma_f32_32x32x16_bf16 v[224:239], v[112:115], v[124:127], v[224:239]
  ds_read_b64_tr_b16 v[92:93], v2 offset:35136
  ds_read_b64_tr_b16 v[94:95], v2 offset:35392
  s_waitcnt lgkmcnt(10)
  v_mfma_f32_32x32x16_bf16 v[176:191], v[116:119], v[120:123], v[176:191]
  v_mov_b32 v10, 0
  ds_write_b32 v8, v10 offset:1808
  v_mfma_f32_32x32x16_bf16 v[240:255], v[116:119], v[124:127], v[240:255]
  s_waitcnt lgkmcnt(8)
  v_mfma_f32_32x32x16_bf16 v[128:143], v[80:83], v[96:99], v[128:143]
  ds_read_b128 v[120:123], v13 offset:32768
  s_waitcnt lgkmcnt(8)
  v_mfma_f32_32x32x16_bf16 v[192:207], v[80:83], v[100:103], v[192:207]
  ds_read_b64_tr_b16 v[104:105], v2 offset:43680
  ds_read_b64_tr_b16 v[106:107], v2 offset:43936
  s_waitcnt lgkmcnt(8)
  v_mfma_f32_32x32x16_bf16 v[144:159], v[84:87], v[96:99], v[144:159]
  ds_read_b128 v[124:127], v13 offset:36864
  ds_read_b32 v5, v4 offset:1444
  v_mfma_f32_32x32x16_bf16 v[208:223], v[84:87], v[100:103], v[208:223]
  ds_read_b64_tr_b16 v[108:109], v2 offset:43744
  ds_read_b64_tr_b16 v[110:111], v2 offset:44000
  s_waitcnt lgkmcnt(10)
  v_mfma_f32_32x32x16_bf16 v[160:175], v[88:91], v[96:99], v[160:175]
  ds_read_b64_tr_b16 v[112:113], v2 offset:43808
  ds_read_b64_tr_b16 v[114:115], v2 offset:44064
  v_mfma_f32_32x32x16_bf16 v[224:239], v[88:91], v[100:103], v[224:239]
  ds_read_b64_tr_b16 v[116:117], v2 offset:43872
  ds_read_b64_tr_b16 v[118:119], v2 offset:44128
  s_waitcnt lgkmcnt(12)
  v_mfma_f32_32x32x16_bf16 v[176:191], v[92:95], v[96:99], v[176:191]
  v_mfma_f32_32x32x16_bf16 v[240:255], v[92:95], v[100:103], v[240:255]
  s_waitcnt lgkmcnt(6)
  v_readfirstlane_b32 s15, v5
  v_mfma_f32_32x32x16_bf16 v[128:143], v[104:107], v[120:123], v[128:143]
  s_mov_b32 s10, s15
  s_cmp_eq_u32 s10, 0
  s_cbranch_scc0 Lfs_56
Lok_55:
  ds_read_b128 v[96:99], v14 offset:32768
  v_mfma_f32_32x32x16_bf16 v[192:207], v[104:107], v[124:127], v[192:207]
  ds_read_b64_tr_b16 v[80:81], v3 offset:0
  ds_read_b64_tr_b16 v[82:83], v3 offset:256
  s_waitcnt lgkmcnt(7)
  v_mfma_f32_32x32x16_bf16 v[144:159], v[108:111], v[120:123], v[144:159]
  ds_read_b128 v[100:103], v14 offset:36864
  v_mfma_f32_32x32x16_bf16 v[208:223], v[108:111], v[124:127], v[208:223]
  ds_read_b64_tr_b16 v[84:85], v3 offset:64
  ds_read_b64_tr_b16 v[86:87], v3 offset:320
  s_waitcnt lgkmcnt(8)
  v_mfma_f32_32x32x16_bf16 v[160:175], v[112:115], v[120:123], v[160:175]
  ds_read_b64_tr_b16 v[88:89], v3 offset:128
  ds_read_b64_tr_b16 v[90:91], v3 offset:384
  v_mfma_f32_32x32x16_bf16 v[224:239], v[112:115], v[124:127], v[224:239]
  ds_read_b64_tr_b16 v[92:93], v3 offset:192
  ds_read_b64_tr_b16 v[94:95], v3 offset:448
  s_waitcnt lgkmcnt(10)
  v_mfma_f32_32x32x16_bf16 v[176:191], v[116:119], v[120:123], v[176:191]
  v_mov_b32 v10, 0
  ds_write_b32 v8, v10 offset:1824
  v_mfma_f32_32x32x16_bf16 v[240:255], v[116:119], v[124:127], v[240:255]
  s_waitcnt lgkmcnt(8)
  v_mfma_f32_32x32x16_bf16 v[128:143], v[80:83], v[96:99], v[128:143]
  ds_read_b128 v[120:123], v15 offset:32768
  s_waitcnt lgkmcnt(8)
  v_mfma_f32_32x32x16_bf16 v[192:207], v[80:83], v[100:103], v[192:207]
  ds_read_b64_tr_b16 v[104:105], v3 offset:8736
  ds_read_b64_tr_b16 v[106:107], v3 offset:8992
  s_waitcnt lgkmcnt(8)
  v_mfma_f32_32x32x16_bf16 v[144:159], v[84:87], v[96:99], v[144:159]
  ds_read_b128 v[124:127], v15 offset:36864
  ds_read_b32 v5, v4 offset:1448
  v_mfma_f32_32x32x16_bf16 v[208:223], v[84:87], v[100:103], v[208:223]
  ds_read_b64_tr_b16 v[108:109], v3 offset:8800
  ds_read_b64_tr_b16 v[110:111], v3 offset:9056
  s_waitcnt lgkmcnt(10)
  v_mfma_f32_32x32x16_bf16 v[160:175], v[88:91], v[96:99], v[160:175]
  ds_read_b64_tr_b16 v[112:113], v3 offset:8864
  ds_read_b64_tr_b16 v[114:115], v3 offset:9120
  v_mfma_f32_32x32x16_bf16 v[224:239], v[88:91], v[100:103], v[224:239]
  ds_read_b64_tr_b16 v[116:117], v3 offset:8928
  ds_read_b64_tr_b16 v[118:119], v3 offset:9184
  s_waitcnt lgkmcnt(12)
  v_mfma_f32_32x32x16_bf16 v[176:191], v[92:95], v[96:99], v[176:191]
  v_mfma_f32_32x32x16_bf16 v[240:255], v[92:95], v[100:103], v[240:255]
  s_waitcnt lgkmcnt(6)
  v_readfirstlane_b32 s15, v5
  v_mfma_f32_32x32x16_bf16 v[128:143], v[104:107], v[120:123], v[128:143]
  s_mov_b32 s10, s15
  s_cmp_eq_u32 s10, 0
  s_cbranch_scc0 Lfs_58
Lok_57:
  ds_read_b128 v[96:99], v12 offset:16384
  v_mfma_f32_32x32x16_bf16 v[192:207], v[104:107], v[124:127], v[192:207]
  ds_read_b64_tr_b16 v[80:81], v3 offset:25920
  ds_read_b64_tr_b16 v[82:83], v3 offset:26176
  s_waitcnt lgkmcnt(7)
  v_mfma_f32_32x32x16_bf16 v[144:159], v[108:111], v[120:123], v[144:159]
  ds_read_b128 v[100:103], v12 offset:20480
  v_mfma_f32_32x32x16_bf16 v[208:223], v[108:111], v[124:127], v[208:223]
  ds_read_b64_tr_b16 v[84:85], v3 offset:25984
  ds_read_b64_tr_b16 v[86:87], v3 offset:26240
  s_waitcnt lgkmcnt(8)
  v_mfma_f32_32x32x16_bf16 v[160:175], v[112:115], v[120:123], v[160:175]
  ds_read_b64_tr_b16 v[88:89], v3 offset:26048
  ds_read_b64_tr_b16 v[90:91], v3 offset:26304
  v_mfma_f32_32x32x16_bf16 v[224:239], v[112:115], v[124:127], v[224:239]
  ds_read_b64_tr_b16 v[92:93], v3 offset:26112
  ds_read_b64_tr_b16 v[94:95], v3 offset:26368
  s_waitcnt lgkmcnt(10)
  v_mfma_f32_32x32x16_bf16 v[176:191], v[116:119], v[120:123], v[176:191]
  v_mov_b32 v10, 0
  ds_write_b32 v8, v10 offset:1840
  v_mfma_f32_32x32x16_bf16 v[240:255], v[116:119], v[124:127], v[240:255]
  s_waitcnt lgkmcnt(8)
  v_mfma_f32_32x32x16_bf16 v[128:143], v[80:83], v[96:99], v[128:143]
  ds_read_b128 v[120:123], v13 offset:16384
  s_waitcnt lgkmcnt(8)
  v_mfma_f32_32x32x16_bf16 v[192:207], v[80:83], v[100:103], v[192:207]
  ds_read_b64_tr_b16 v[104:105], v3 offset:34656
  ds_read_b64_tr_b16 v[106:107], v3 offset:34912
  s_waitcnt lgkmcnt(8)
  v_mfma_f32_32x32x16_bf16 v[144:159], v[84:87], v[96:99], v[144:159]
  ds_read_b128 v[124:127], v13 offset:20480
  ds_read_b32 v5, v4 offset:1452
  v_mfma_f32_32x32x16_bf16 v[208:223], v[84:87], v[100:103], v[208:223]
  ds_read_b64_tr_b16 v[108:109], v3 offset:34720
  ds_read_b64_tr_b16 v[110:111], v3 offset:34976
  s_waitcnt lgkmcnt(10)
  v_mfma_f32_32x32x16_bf16 v[160:175], v[88:91], v[96:99], v[160:175]
  ds_read_b64_tr_b16 v[112:113], v3 offset:34784
  ds_read_b64_tr_b16 v[114:115], v3 offset:35040
  v_mfma_f32_32x32x16_bf16 v[224:239], v[88:91], v[100:103], v[224:239]
  ds_read_b64_tr_b16 v[116:117], v3 offset:34848
  ds_read_b64_tr_b16 v[118:119], v3 offset:35104
  s_waitcnt lgkmcnt(12)
  v_mfma_f32_32x32x16_bf16 v[176:191], v[92:95], v[96:99], v[176:191]
  v_mfma_f32_32x32x16_bf16 v[240:255], v[92:95], v[100:103], v[240:255]
  s_waitcnt lgkmcnt(6)
  v_readfirstlane_b32 s15, v5
  v_mfma_f32_32x32x16_bf16 v[128:143], v[104:107], v[120:123], v[128:143]
  s_mov_b32 s10, s15
  s_cmp_eq_u32 s10, 0
  s_cbranch_scc0 Lfs_60
Lok_59:
  ds_read_b128 v[96:99], v14 offset:16384
  v_mfma_f32_32x32x16_bf16 v[192:207], v[104:107], v[124:127], v[192:207]
  ds_read_b64_tr_b16 v[80:81], v2 offset:0
  ds_read_b64_tr_b16 v[82:83], v2 offset:256
  s_waitcnt lgkmcnt(7)
  v_mfma_f32_32x32x16_bf16 v[144:159], v[108:111], v[120:123], v[144:159]
  ds_read_b128 v[100:103], v14 offset:20480
  v_mfma_f32_32x32x16_bf16 v[208:223], v[108:111], v[124:127], v[208:223]
  ds_read_b64_tr_b16 v[84:85], v2 offset:64
  ds_read_b64_tr_b16 v[86:87], v2 offset:320
  s_waitcnt lgkmcnt(8)
  v_mfma_f32_32x32x16_bf16 v[160:175], v[112:115], v[120:123], v[160:175]
  ds_read_b64_tr_b16 v[88:89], v2 offset:128
  ds_read_b64_tr_b16 v[90:91], v2 offset:384
  v_mfma_f32_32x32x16_bf16 v[224:239], v[112:115], v[124:127], v[224:239]
  ds_read_b64_tr_b16 v[92:93], v2 offset:192
  ds_read_b64_tr_b16 v[94:95], v2 offset:448
  s_waitcnt lgkmcnt(10)
  v_mfma_f32_32x32x16_bf16 v[176:191], v[116:119], v[120:123], v[176:191]
  v_mov_b32 v10, 0
  ds_write_b32 v8, v10 offset:1856
  v_mfma_f32_32x32x16_bf16 v[240:255], v[116:119], v[124:127], v[240:255]
  s_waitcnt lgkmcnt(8)
  v_mfma_f32_32x32x16_bf16 v[128:143], v[80:83], v[96:99], v[128:143]
  ds_read_b128 v[120:123], v15 offset:16384
  s_waitcnt lgkmcnt(8)
  v_mfma_f32_32x32x16_bf16 v[192:207], v[80:83], v[100:103], v[192:207]
  ds_read_b64_tr_b16 v[104:105], v2 offset:8736
  ds_read_b64_tr_b16 v[106:107], v2 offset:8992
  s_waitcnt lgkmcnt(8)
  v_mfma_f32_32x32x16_bf16 v[144:159], v[84:87], v[96:99], v[144:159]
  ds_read_b128 v[124:127], v15 offset:20480
  ds_read_b32 v5, v4 offset:1456
  v_mfma_f32_32x32x16_bf16 v[208:223], v[84:87], v[100:103], v[208:223]
  ds_read_b64_tr_b16 v[108:109], v2 offset:8800
  ds_read_b64_tr_b16 v[110:111], v2 offset:9056
  s_waitcnt lgkmcnt(10)
  v_mfma_f32_32x32x16_bf16 v[160:175], v[88:91], v[96:99], v[160:175]
  ds_read_b64_tr_b16 v[112:113], v2 offset:8864
  ds_read_b64_tr_b16 v[114:115], v2 offset:9120
  v_mfma_f32_32x32x16_bf16 v[224:239], v[88:91], v[100:103], v[224:239]
  ds_read_b64_tr_b16 v[116:117], v2 offset:8928
  ds_read_b64_tr_b16 v[118:119], v2 offset:9184
  s_waitcnt lgkmcnt(12)
  v_mfma_f32_32x32x16_bf16 v[176:191], v[92:95], v[96:99], v[176:191]
  v_mfma_f32_32x32x16_bf16 v[240:255], v[92:95], v[100:103], v[240:255]
  s_waitcnt lgkmcnt(6)
  v_readfirstlane_b32 s15, v5
  v_mfma_f32_32x32x16_bf16 v[128:143], v[104:107], v[120:123], v[128:143]
  s_mov_b32 s10, s15
  s_cmp_eq_u32 s10, 0
  s_cbranch_scc0 Lfs_62
Lok_61:
  ds_read_b128 v[96:99], v12 offset:0
  v_mfma_f32_32x32x16_bf16 v[192:207], v[104:107], v[124:127], v[192:207]
  ds_read_b64_tr_b16 v[80:81], v2 offset:17472
  ds_read_b64_tr_b16 v[82:83], v2 offset:17728
  s_waitcnt lgkmcnt(7)
  v_mfma_f32_32x32x16_bf16 v[144:159], v[108:111], v[120:123], v[144:159]
  ds_read_b128 v[100:103], v12 offset:4096
  v_mfma_f32_32x32x16_bf16 v[208:223], v[108:111], v[124:127], v[208:223]
  ds_read_b64_tr_b16 v[84:85], v2 offset:17536
  ds_read_b64_tr_b16 v[86:87], v2 offset:17792
  s_waitcnt lgkmcnt(8)
  v_mfma_f32_32x32x16_bf16 v[160:175], v[112:115], v[120:123], v[160:175]
  ds_read_b64_tr_b16 v[88:89], v2 offset:17600
  ds_read_b64_tr_b16 v[90:91], v2 offset:17856
  v_mfma_f32_32x32x16_bf16 v[224:239], v[112:115], v[124:127], v[224:239]
  ds_read_b64_tr_b16 v[92:93], v2 offset:17664
  ds_read_b64_tr_b16 v[94:95], v2 offset:17920
  s_waitcnt lgkmcnt(10)
  v_mfma_f32_32x32x16_bf16 v[176:191], v[116:119], v[120:123], v[176:191]
  v_mov_b32 v10, 0
  ds_write_b32 v8, v10 offset:1872
  v_mfma_f32_32x32x16_bf16 v[240:255], v[116:119], v[124:127], v[240:255]
  s_waitcnt lgkmcnt(8)
  v_mfma_f32_32x32x16_bf16 v[128:143], v[80:83], v[96:99], v[128:143]
  ds_read_b128 v[120:123], v13 offset:0
  s_waitcnt lgkmcnt(8)
  v_mfma_f32_32x32x16_bf16 v[192:207], v[80:83], v[100:103], v[192:207]
  ds_read_b64_tr_b16 v[104:105], v2 offset:26208
  ds_read_b64_tr_b16 v[106:107], v2 offset:26464
  s_waitcnt lgkmcnt(8)
  v_mfma_f32_32x32x16_bf16 v[144:159], v[84:87], v[96:99], v[144:159]
  ds_read_b128 v[124:127], v13 offset:4096
  ds_read_b32 v5, v4 offset:1460
  v_mfma_f32_32x32x16_bf16 v[208:223], v[84:87], v[100:103], v[208:223]
  ds_read_b64_tr_b16 v[108:109], v2 offset:26272
  ds_read_b64_tr_b16 v[110:111], v2 offset:26528
  s_waitcnt lgkmcnt(10)
  v_mfma_f32_32x32x16_bf16 v[160:175], v[88:91], v[96:99], v[160:175]
  ds_read_b64_tr_b16 v[112:113], v2 offset:26336
  ds_read_b64_tr_b16 v[114:115], v2 offset:26592
  v_mfma_f32_32x32x16_bf16 v[224:239], v[88:91], v[100:103], v[224:239]
  ds_read_b64_tr_b16 v[116:117], v2 offset:26400
  ds_read_b64_tr_b16 v[118:119], v2 offset:26656
  s_waitcnt lgkmcnt(12)
  v_mfma_f32_32x32x16_bf16 v[176:191], v[92:95], v[96:99], v[176:191]
  v_mfma_f32_32x32x16_bf16 v[240:255], v[92:95], v[100:103], v[240:255]
  s_waitcnt lgkmcnt(6)
  v_readfirstlane_b32 s15, v5
  v_mfma_f32_32x32x16_bf16 v[128:143], v[104:107], v[120:123], v[128:143]
  s_mov_b32 s10, s15
  s_cmp_eq_u32 s10, 0
  s_cbranch_scc0 Lfs_64
Lok_63:
  ds_read_b128 v[96:99], v14 offset:0
  v_mfma_f32_32x32x16_bf16 v[192:207], v[104:107], v[124:127], v[192:207]
  ds_read_b64_tr_b16 v[80:81], v2 offset:34944
  ds_read_b64_tr_b16 v[82:83], v2 offset:35200
  s_waitcnt lgkmcnt(7)
  v_mfma_f32_32x32x16_bf16 v[144:159], v[108:111], v[120:123], v[144:159]
  ds_read_b128 v[100:103], v14 offset:4096
  v_mfma_f32_32x32x16_bf16 v[208:223], v[108:111], v[124:127], v[208:223]
  ds_read_b64_tr_b16 v[84:85], v2 offset:35008
  ds_read_b64_tr_b16 v[86:87], v2 offset:35264
  s_waitcnt lgkmcnt(8)
  v_mfma_f32_32x32x16_bf16 v[160:175], v[112:115], v[120:123], v[160:175]
  ds_read_b64_tr_b16 v[88:89], v2 offset:35072
  ds_read_b64_tr_b16 v[90:91], v2 offset:35328
  v_mfma_f32_32x32x16_bf16 v[224:239], v[112:115], v[124:127], v[224:239]
  ds_read_b64_tr_b16 v[92:93], v2 offset:35136
  ds_read_b64_tr_b16 v[94:95], v2 offset:35392
  s_waitcnt lgkmcnt(10)
  v_mfma_f32_32x32x16_bf16 v[176:191], v[116:119], v[120:123], v[176:191]
  v_mov_b32 v10, 0
  ds_write_b32 v8, v10 offset:1888
  v_mfma_f32_32x32x16_bf16 v[240:255], v[116:119], v[124:127], v[240:255]
  v_and_b32 v9, 31, v1
  v_lshlrev_b32 v9, 3, v9
  s_lshl_b32 s6, s8, 9
  s_add_u32 s6, s6, 0x0
  buffer_load_dwordx2 v[16:17], v9, s[48:51], s6 offen sc1
  buffer_load_dwordx2 v[18:19], v9, s[48:51], s6 offen offset:256 sc1
  s_waitcnt lgkmcnt(8)
  v_mfma_f32_32x32x16_bf16 v[128:143], v[80:83], v[96:99], v[128:143]
  ds_read_b128 v[120:123], v15 offset:0
  s_waitcnt lgkmcnt(8)
  v_mfma_f32_32x32x16_bf16 v[192:207], v[80:83], v[100:103], v[192:207]
  ds_read_b64_tr_b16 v[104:105], v2 offset:43680
  ds_read_b64_tr_b16 v[106:107], v2 offset:43936
  s_waitcnt lgkmcnt(8)
  v_mfma_f32_32x32x16_bf16 v[144:159], v[84:87], v[96:99], v[144:159]
  ds_read_b128 v[124:127], v15 offset:4096
  ds_read_b32 v5, v4 offset:1464
  v_mfma_f32_32x32x16_bf16 v[208:223], v[84:87], v[100:103], v[208:223]
  ds_read_b64_tr_b16 v[108:109], v2 offset:43744
  ds_read_b64_tr_b16 v[110:111], v2 offset:44000
  s_waitcnt lgkmcnt(10)
  v_mfma_f32_32x32x16_bf16 v[160:175], v[88:91], v[96:99], v[160:175]
  ds_read_b64_tr_b16 v[112:113], v2 offset:43808
  ds_read_b64_tr_b16 v[114:115], v2 offset:44064
  v_mfma_f32_32x32x16_bf16 v[224:239], v[88:91], v[100:103], v[224:239]
  ds_read_b64_tr_b16 v[116:117], v2 offset:43872
  ds_read_b64_tr_b16 v[118:119], v2 offset:44128
  s_waitcnt lgkmcnt(12)
  v_mfma_f32_32x32x16_bf16 v[176:191], v[92:95], v[96:99], v[176:191]
  v_mfma_f32_32x32x16_bf16 v[240:255], v[92:95], v[100:103], v[240:255]
  s_waitcnt lgkmcnt(6)
  v_readfirstlane_b32 s15, v5
  v_mfma_f32_32x32x16_bf16 v[128:143], v[104:107], v[120:123], v[128:143]
  s_mov_b32 s10, s15
  s_cmp_eq_u32 s10, 0
  s_cbranch_scc0 Lfs_66
Lok_65:
  ds_read_b128 v[96:99], v12 offset:32768
  v_mfma_f32_32x32x16_bf16 v[192:207], v[104:107], v[124:127], v[192:207]
  ds_read_b64_tr_b16 v[80:81], v3 offset:0
  ds_read_b64_tr_b16 v[82:83], v3 offset:256
  s_waitcnt lgkmcnt(7)
  v_mfma_f32_32x32x16_bf16 v[144:159], v[108:111], v[120:123], v[144:159]
  ds_read_b128 v[100:103], v12 offset:36864
  v_mfma_f32_32x32x16_bf16 v[208:223], v[108:111], v[124:127], v[208:223]
  ds_read_b64_tr_b16 v[84:85], v3 offset:64
  ds_read_b64_tr_b16 v[86:87], v3 offset:320
  s_waitcnt lgkmcnt(8)
  v_mfma_f32_32x32x16_bf16 v[160:175], v[112:115], v[120:123], v[160:175]
  ds_read_b64_tr_b16 v[88:89], v3 offset:128
  ds_read_b64_tr_b16 v[90:91], v3 offset:384
  v_mfma_f32_32x32x16_bf16 v[224:239], v[112:115], v[124:127], v[224:239]
  ds_read_b64_tr_b16 v[92:93], v3 offset:192
  ds_read_b64_tr_b16 v[94:95], v3 offset:448
  s_waitcnt lgkmcnt(10)
  v_mfma_f32_32x32x16_bf16 v[176:191], v[116:119], v[120:123], v[176:191]
  v_mov_b32 v10, 0
  ds_write_b32 v8, v10 offset:1904
  v_mfma_f32_32x32x16_bf16 v[240:255], v[116:119], v[124:127], v[240:255]
  s_waitcnt lgkmcnt(8)
  v_mfma_f32_32x32x16_bf16 v[128:143], v[80:83], v[96:99], v[128:143]
  ds_read_b128 v[120:123], v13 offset:32768
  s_waitcnt lgkmcnt(8)
  v_mfma_f32_32x32x16_bf16 v[192:207], v[80:83], v[100:103], v[192:207]
  ds_read_b64_tr_b16 v[104:105], v3 offset:8736
  ds_read_b64_tr_b16 v[106:107], v3 offset:8992
  s_waitcnt lgkmcnt(8)
  v_mfma_f32_32x32x16_bf16 v[144:159], v[84:87], v[96:99], v[144:159]
  ds_read_b128 v[124:127], v13 offset:36864
  ds_read_b32 v5, v4 offset:1468
  v_mfma_f32_32x32x16_bf16 v[208:223], v[84:87], v[100:103], v[208:223]
  ds_read_b64_tr_b16 v[108:109], v3 offset:8800
  ds_read_b64_tr_b16 v[110:111], v3 offset:9056
  s_waitcnt lgkmcnt(10)
  v_mfma_f32_32x32x16_bf16 v[160:175], v[88:91], v[96:99], v[160:175]
  ds_read_b64_tr_b16 v[112:113], v3 offset:8864
  ds_read_b64_tr_b16 v[114:115], v3 offset:9120
  v_mfma_f32_32x32x16_bf16 v[224:239], v[88:91], v[100:103], v[224:239]
  ds_read_b64_tr_b16 v[116:117], v3 offset:8928
  ds_read_b64_tr_b16 v[118:119], v3 offset:9184
  s_waitcnt lgkmcnt(12)
  v_mfma_f32_32x32x16_bf16 v[176:191], v[92:95], v[96:99], v[176:191]
  v_mfma_f32_32x32x16_bf16 v[240:255], v[92:95], v[100:103], v[240:255]
  s_waitcnt lgkmcnt(6)
  v_readfirstlane_b32 s15, v5
  v_mfma_f32_32x32x16_bf16 v[128:143], v[104:107], v[120:123], v[128:143]
  s_mov_b32 s10, s15
  s_cmp_eq_u32 s10, 0
  s_cbranch_scc0 Lfs_68
Lok_67:
  ds_read_b128 v[96:99], v14 offset:32768
  v_mfma_f32_32x32x16_bf16 v[192:207], v[104:107], v[124:127], v[192:207]
  ds_read_b64_tr_b16 v[80:81], v3 offset:25920
  ds_read_b64_tr_b16 v[82:83], v3 offset:26176
  s_waitcnt lgkmcnt(7)
  v_mfma_f32_32x32x16_bf16 v[144:159], v[108:111], v[120:123], v[144:159]
  ds_read_b128 v[100:103], v14 offset:36864
  v_mfma_f32_32x32x16_bf16 v[208:223], v[108:111], v[124:127], v[208:223]
  ds_read_b64_tr_b16 v[84:85], v3 offset:25984
  ds_read_b64_tr_b16 v[86:87], v3 offset:26240
  s_waitcnt lgkmcnt(8)
  v_mfma_f32_32x32x16_bf16 v[160:175], v[112:115], v[120:123], v[160:175]
  ds_read_b64_tr_b16 v[88:89], v3 offset:26048
  ds_read_b64_tr_b16 v[90:91], v3 offset:26304
  v_mfma_f32_32x32x16_bf16 v[224:239], v[112:115], v[124:127], v[224:239]
  ds_read_b64_tr_b16 v[92:93], v3 offset:26112
  ds_read_b64_tr_b16 v[94:95], v3 offset:26368
  s_waitcnt lgkmcnt(10)
  v_mfma_f32_32x32x16_bf16 v[176:191], v[116:119], v[120:123], v[176:191]
  v_mov_b32 v10, 0
  ds_write_b32 v8, v10 offset:1920
  v_mfma_f32_32x32x16_bf16 v[240:255], v[116:119], v[124:127], v[240:255]
  s_waitcnt lgkmcnt(8)
  v_mfma_f32_32x32x16_bf16 v[128:143], v[80:83], v[96:99], v[128:143]
  ds_read_b128 v[120:123], v15 offset:32768
  s_waitcnt lgkmcnt(8)
  v_mfma_f32_32x32x16_bf16 v[192:207], v[80:83], v[100:103], v[192:207]
  ds_read_b64_tr_b16 v[104:105], v3 offset:34656
  ds_read_b64_tr_b16 v[106:107], v3 offset:34912
  s_waitcnt lgkmcnt(8)
  v_mfma_f32_32x32x16_bf16 v[144:159], v[84:87], v[96:99], v[144:159]
  ds_read_b128 v[124:127], v15 offset:36864
  ds_read_b32 v5, v4 offset:1472
  v_mfma_f32_32x32x16_bf16 v[208:223], v[84:87], v[100:103], v[208:223]
  ds_read_b64_tr_b16 v[108:109], v3 offset:34720
  ds_read_b64_tr_b16 v[110:111], v3 offset:34976
  s_waitcnt lgkmcnt(10)
  v_mfma_f32_32x32x16_bf16 v[160:175], v[88:91], v[96:99], v[160:175]
  ds_read_b64_tr_b16 v[112:113], v3 offset:34784
  ds_read_b64_tr_b16 v[114:115], v3 offset:35040
  v_mfma_f32_32x32x16_bf16 v[224:239], v[88:91], v[100:103], v[224:239]
  ds_read_b64_tr_b16 v[116:117], v3 offset:34848
  ds_read_b64_tr_b16 v[118:119], v3 offset:35104
  s_waitcnt lgkmcnt(12)
  v_mfma_f32_32x32x16_bf16 v[176:191], v[92:95], v[96:99], v[176:191]
  v_mfma_f32_32x32x16_bf16 v[240:255], v[92:95], v[100:103], v[240:255]
  s_waitcnt lgkmcnt(6)
  v_readfirstlane_b32 s15, v5
  v_mfma_f32_32x32x16_bf16 v[128:143], v[104:107], v[120:123], v[128:143]
  s_mov_b32 s10, s15
  s_cmp_eq_u32 s10, 0
  s_cbranch_scc0 Lfs_70
Lok_69:
  ds_read_b128 v[96:99], v12 offset:16384
  v_mfma_f32_32x32x16_bf16 v[192:207], v[104:107], v[124:127], v[192:207]
  ds_read_b64_tr_b16 v[80:81], v2 offset:0
  ds_read_b64_tr_b16 v[82:83], v2 offset:256
  s_waitcnt lgkmcnt(7)
  v_mfma_f32_32x32x16_bf16 v[144:159], v[108:111], v[120:123], v[144:159]
  ds_read_b128 v[100:103], v12 offset:20480
  v_mfma_f32_32x32x16_bf16 v[208:223], v[108:111], v[124:127], v[208:223]
  ds_read_b64_tr_b16 v[84:85], v2 offset:64
  ds_read_b64_tr_b16 v[86:87], v2 offset:320
  s_waitcnt lgkmcnt(8)
  v_mfma_f32_32x32x16_bf16 v[160:175], v[112:115], v[120:123], v[160:175]
  ds_read_b64_tr_b16 v[88:89], v2 offset:128
  ds_read_b64_tr_b16 v[90:91], v2 offset:384
  v_mfma_f32_32x32x16_bf16 v[224:239], v[112:115], v[124:127], v[224:239]
  ds_read_b64_tr_b16 v[92:93], v2 offset:192
  ds_read_b64_tr_b16 v[94:95], v2 offset:448
  s_waitcnt lgkmcnt(10)
  v_mfma_f32_32x32x16_bf16 v[176:191], v[116:119], v[120:123], v[176:191]
  v_mov_b32 v10, 0
  ds_write_b32 v8, v10 offset:1936
  v_mfma_f32_32x32x16_bf16 v[240:255], v[116:119], v[124:127], v[240:255]
  s_waitcnt lgkmcnt(8)
  v_mfma_f32_32x32x16_bf16 v[128:143], v[80:83], v[96:99], v[128:143]
  ds_read_b128 v[120:123], v13 offset:16384
  s_waitcnt lgkmcnt(8)
  v_mfma_f32_32x32x16_bf16 v[192:207], v[80:83], v[100:103], v[192:207]
  ds_read_b64_tr_b16 v[104:105], v2 offset:8736
  ds_read_b64_tr_b16 v[106:107], v2 offset:8992
  s_waitcnt lgkmcnt(8)
  v_mfma_f32_32x32x16_bf16 v[144:159], v[84:87], v[96:99], v[144:159]
  ds_read_b128 v[124:127], v13 offset:20480
  ds_read_b32 v5, v4 offset:1476
  v_mfma_f32_32x32x16_bf16 v[208:223], v[84:87], v[100:103], v[208:223]
  ds_read_b64_tr_b16 v[108:109], v2 offset:8800
  ds_read_b64_tr_b16 v[110:111], v2 offset:9056
  s_waitcnt lgkmcnt(10)
  v_mfma_f32_32x32x16_bf16 v[160:175], v[88:91], v[96:99], v[160:175]
  ds_read_b64_tr_b16 v[112:113], v2 offset:8864
  ds_read_b64_tr_b16 v[114:115], v2 offset:9120
  v_mfma_f32_32x32x16_bf16 v[224:239], v[88:91], v[100:103], v[224:239]
  ds_read_b64_tr_b16 v[116:117], v2 offset:8928
  ds_read_b64_tr_b16 v[118:119], v2 offset:9184
  s_waitcnt lgkmcnt(12)
  v_mfma_f32_32x32x16_bf16 v[176:191], v[92:95], v[96:99], v[176:191]
  v_mfma_f32_32x32x16_bf16 v[240:255], v[92:95], v[100:103], v[240:255]
  s_waitcnt lgkmcnt(6)
  v_readfirstlane_b32 s15, v5
  v_mfma_f32_32x32x16_bf16 v[128:143], v[104:107], v[120:123], v[128:143]
  s_mov_b32 s10, s15
  s_cmp_eq_u32 s10, 0
  s_cbranch_scc0 Lfs_72
Lok_71:
  ds_read_b128 v[96:99], v14 offset:16384
  v_mfma_f32_32x32x16_bf16 v[192:207], v[104:107], v[124:127], v[192:207]
  ds_read_b64_tr_b16 v[80:81], v2 offset:17472
  ds_read_b64_tr_b16 v[82:83], v2 offset:17728
  s_waitcnt lgkmcnt(7)
  v_mfma_f32_32x32x16_bf16 v[144:159], v[108:111], v[120:123], v[144:159]
  ds_read_b128 v[100:103], v14 offset:20480
  v_mfma_f32_32x32x16_bf16 v[208:223], v[108:111], v[124:127], v[208:223]
  ds_read_b64_tr_b16 v[84:85], v2 offset:17536
  ds_read_b64_tr_b16 v[86:87], v2 offset:17792
  s_waitcnt lgkmcnt(8)
  v_mfma_f32_32x32x16_bf16 v[160:175], v[112:115], v[120:123], v[160:175]
  ds_read_b64_tr_b16 v[88:89], v2 offset:17600
  ds_read_b64_tr_b16 v[90:91], v2 offset:17856
  v_mfma_f32_32x32x16_bf16 v[224:239], v[112:115], v[124:127], v[224:239]
  ds_read_b64_tr_b16 v[92:93], v2 offset:17664
  ds_read_b64_tr_b16 v[94:95], v2 offset:17920
  s_waitcnt lgkmcnt(10)
  v_mfma_f32_32x32x16_bf16 v[176:191], v[116:119], v[120:123], v[176:191]
  v_mov_b32 v10, 0
  ds_write_b32 v8, v10 offset:1952
  v_mfma_f32_32x32x16_bf16 v[240:255], v[116:119], v[124:127], v[240:255]
  s_waitcnt lgkmcnt(8)
  v_mfma_f32_32x32x16_bf16 v[128:143], v[80:83], v[96:99], v[128:143]
  ds_read_b128 v[120:123], v15 offset:16384
  s_waitcnt lgkmcnt(8)
  v_mfma_f32_32x32x16_bf16 v[192:207], v[80:83], v[100:103], v[192:207]
  ds_read_b64_tr_b16 v[104:105], v2 offset:26208
  ds_read_b64_tr_b16 v[106:107], v2 offset:26464
  s_waitcnt lgkmcnt(8)
  v_mfma_f32_32x32x16_bf16 v[144:159], v[84:87], v[96:99], v[144:159]
  ds_read_b128 v[124:127], v15 offset:20480
  ds_read_b32 v5, v4 offset:1480
  v_mfma_f32_32x32x16_bf16 v[208:223], v[84:87], v[100:103], v[208:223]
  ds_read_b64_tr_b16 v[108:109], v2 offset:26272
  ds_read_b64_tr_b16 v[110:111], v2 offset:26528
  s_waitcnt lgkmcnt(10)
  v_mfma_f32_32x32x16_bf16 v[160:175], v[88:91], v[96:99], v[160:175]
  ds_read_b64_tr_b16 v[112:113], v2 offset:26336
  ds_read_b64_tr_b16 v[114:115], v2 offset:26592
  v_mfma_f32_32x32x16_bf16 v[224:239], v[88:91], v[100:103], v[224:239]
  ds_read_b64_tr_b16 v[116:117], v2 offset:26400
  ds_read_b64_tr_b16 v[118:119], v2 offset:26656
  s_waitcnt lgkmcnt(12)
  v_mfma_f32_32x32x16_bf16 v[176:191], v[92:95], v[96:99], v[176:191]
  ds_read_b32 v20, v4 offset:60
  v_mfma_f32_32x32x16_bf16 v[240:255], v[92:95], v[100:103], v[240:255]
  s_waitcnt lgkmcnt(7)
  v_readfirstlane_b32 s15, v5
  s_waitcnt vmcnt(0)
  v_xor_b32 v10, s1, v17
  v_xor_b32 v11, s1, v19
  v_or_b32 v10, v10, v11
  v_cmp_ne_u32 s[4:5], 0, v10
  s_cmp_eq_u64 s[4:5], 0
  s_cbranch_scc0 Lss_74
Lst_73:
  v_mfma_f32_32x32x16_bf16 v[128:143], v[104:107], v[120:123], v[128:143]
  s_mov_b32 s10, s15
  s_cmp_eq_u32 s10, 0
  s_cbranch_scc0 Lfs_76
Lok_75:
  ds_read_b128 v[96:99], v12 offset:0
  v_mfma_f32_32x32x16_bf16 v[192:207], v[104:107], v[124:127], v[192:207]
  ds_read_b64_tr_b16 v[80:81], v2 offset:34944
  ds_read_b64_tr_b16 v[82:83], v2 offset:35200
  s_waitcnt lgkmcnt(8)
  v_mfma_f32_32x32x16_bf16 v[144:159], v[108:111], v[120:123], v[144:159]
  ds_read_b128 v[100:103], v12 offset:4096
  v_mfma_f32_32x32x16_bf16 v[208:223], v[108:111], v[124:127], v[208:223]
  ds_read_b64_tr_b16 v[84:85], v2 offset:35008
  ds_read_b64_tr_b16 v[86:87], v2 offset:35264
  s_waitcnt lgkmcnt(9)
  v_mfma_f32_32x32x16_bf16 v[160:175], v[112:115], v[120:123], v[160:175]
  ds_read_b64_tr_b16 v[88:89], v2 offset:35072
  ds_read_b64_tr_b16 v[90:91], v2 offset:35328
  v_mfma_f32_32x32x16_bf16 v[224:239], v[112:115], v[124:127], v[224:239]
  ds_read_b64_tr_b16 v[92:93], v2 offset:35136
  ds_read_b64_tr_b16 v[94:95], v2 offset:35392
  s_waitcnt lgkmcnt(11)
  v_mfma_f32_32x32x16_bf16 v[176:191], v[116:119], v[120:123], v[176:191]
  v_mov_b32 v10, 0
  ds_write_b32 v8, v10 offset:1968
  v_lshlrev_b32 v56, 16, v16
  v_and_b32 v58, 0xffff0000, v16
  v_xor_b32 v56, 0x80000000, v56
  v_mul_f32 v57, v58, v58
  v_rcp_f32 v58, v58
  v_mfma_f32_32x32x16_bf16 v[240:255], v[116:119], v[124:127], v[240:255]
  v_lshlrev_b32 v60, 16, v18
  v_and_b32 v62, 0xffff0000, v18
  v_xor_b32 v60, 0x80000000, v60
  v_mul_f32 v61, v62, v62
  v_rcp_f32 v62, v62
  s_waitcnt lgkmcnt(8)
  v_mfma_f32_32x32x16_bf16 v[128:143], v[80:83], v[96:99], v[128:143]
  ds_read_b128 v[120:123], v13 offset:0
  s_waitcnt lgkmcnt(8)
  v_mfma_f32_32x32x16_bf16 v[192:207], v[80:83], v[100:103], v[192:207]
  ds_read_b64_tr_b16 v[104:105], v2 offset:43680
  ds_read_b64_tr_b16 v[106:107], v2 offset:43936
  s_waitcnt lgkmcnt(8)
  v_mfma_f32_32x32x16_bf16 v[144:159], v[84:87], v[96:99], v[144:159]
  ds_read_b128 v[124:127], v13 offset:4096
  ds_read_b32 v5, v4 offset:1484
  v_mfma_f32_32x32x16_bf16 v[208:223], v[84:87], v[100:103], v[208:223]
  ds_read_b64_tr_b16 v[108:109], v2 offset:43744
  ds_read_b64_tr_b16 v[110:111], v2 offset:44000
  s_waitcnt lgkmcnt(10)
  v_mfma_f32_32x32x16_bf16 v[160:175], v[88:91], v[96:99], v[160:175]
  ds_read_b64_tr_b16 v[112:113], v2 offset:43808
  ds_read_b64_tr_b16 v[114:115], v2 offset:44064
  v_mfma_f32_32x32x16_bf16 v[224:239], v[88:91], v[100:103], v[224:239]
  ds_read_b64_tr_b16 v[116:117], v2 offset:43872
  ds_read_b64_tr_b16 v[118:119], v2 offset:44128
  s_waitcnt lgkmcnt(12)
  v_mfma_f32_32x32x16_bf16 v[176:191], v[92:95], v[96:99], v[176:191]
  v_readfirstlane_b32 s10, v20
  s_cmp_lg_u32 s10, 0
  s_cbranch_scc0 Lpoll_78
Lok_77:
  v_lshrrev_b32 v21, 5, v1
  v_lshlrev_b32 v21, 4, v21
  s_lshl_b32 s4, s12, 7
  s_add_u32 s4, s4, 128
  v_add_u32 v21, s4, v21
  v_mfma_f32_32x32x16_bf16 v[240:255], v[92:95], v[100:103], v[240:255]
  s_waitcnt lgkmcnt(6)
  v_readfirstlane_b32 s15, v5
  v_mul_f32 v58, 0xbfb8aa3b, v58
  v_mul_f32 v62, 0xbfb8aa3b, v62
  s_mul_i32 s9, s8, 192
  s_lshl_b32 s4, s61, 3
  s_add_u32 s9, s9, s4
  s_add_u32 s9, s9, s12
  s_lshl_b32 s9, s9, 10
  s_add_u32 s9, s9, 0x500000
  v_mfma_f32_32x32x16_bf16 v[128:143], v[104:107], v[120:123], v[128:143]
  s_mov_b32 s10, s15
  s_cmp_eq_u32 s10, 0
  s_cbranch_scc0 Lfs_80
Lok_79:
  ds_read_b128 v[96:99], v14 offset:0
  v_mfma_f32_32x32x16_bf16 v[192:207], v[104:107], v[124:127], v[192:207]
  ds_read_b64_tr_b16 v[80:81], v3 offset:0
  ds_read_b64_tr_b16 v[82:83], v3 offset:256
  s_waitcnt lgkmcnt(7)
  v_mfma_f32_32x32x16_bf16 v[144:159], v[108:111], v[120:123], v[144:159]
  ds_read_b128 v[100:103], v14 offset:4096
  v_mfma_f32_32x32x16_bf16 v[208:223], v[108:111], v[124:127], v[208:223]
  ds_read_b64_tr_b16 v[84:85], v3 offset:64
  ds_read_b64_tr_b16 v[86:87], v3 offset:320
  s_waitcnt lgkmcnt(8)
  v_mfma_f32_32x32x16_bf16 v[160:175], v[112:115], v[120:123], v[160:175]
  ds_read_b64_tr_b16 v[88:89], v3 offset:128
  ds_read_b64_tr_b16 v[90:91], v3 offset:384
  v_mfma_f32_32x32x16_bf16 v[224:239], v[112:115], v[124:127], v[224:239]
  ds_read_b64_tr_b16 v[92:93], v3 offset:192
  ds_read_b64_tr_b16 v[94:95], v3 offset:448
  s_waitcnt lgkmcnt(10)
  v_mfma_f32_32x32x16_bf16 v[176:191], v[116:119], v[120:123], v[176:191]
  v_mov_b32 v10, 0
  ds_write_b32 v8, v10 offset:1984
  ds_read_b128 v[24:27], v21 offset:0
  v_mfma_f32_32x32x16_bf16 v[240:255], v[116:119], v[124:127], v[240:255]
  ds_read_b128 v[28:31], v21 offset:32
  s_waitcnt lgkmcnt(10)
  v_mfma_f32_32x32x16_bf16 v[128:143], v[80:83], v[96:99], v[128:143]
  ds_read_b128 v[120:123], v15 offset:0
  s_waitcnt lgkmcnt(10)
  v_mfma_f32_32x32x16_bf16 v[192:207], v[80:83], v[100:103], v[192:207]
  ds_read_b64_tr_b16 v[104:105], v3 offset:8736
  ds_read_b64_tr_b16 v[106:107], v3 offset:8992
  s_waitcnt lgkmcnt(10)
  v_mfma_f32_32x32x16_bf16 v[144:159], v[84:87], v[96:99], v[144:159]
  ds_read_b128 v[124:127], v15 offset:4096
  v_mfma_f32_32x32x16_bf16 v[208:223], v[84:87], v[100:103], v[208:223]
  ds_read_b64_tr_b16 v[108:109], v3 offset:8800
  ds_read_b64_tr_b16 v[110:111], v3 offset:9056
  s_waitcnt lgkmcnt(11)
  v_mfma_f32_32x32x16_bf16 v[160:175], v[88:91], v[96:99], v[160:175]
  ds_read_b64_tr_b16 v[112:113], v3 offset:8864
  ds_read_b64_tr_b16 v[114:115], v3 offset:9120
  v_mfma_f32_32x32x16_bf16 v[224:239], v[88:91], v[100:103], v[224:239]
  ds_read_b64_tr_b16 v[116:117], v3 offset:8928
  ds_read_b64_tr_b16 v[118:119], v3 offset:9184
  s_waitcnt lgkmcnt(13)
  v_mfma_f32_32x32x16_bf16 v[176:191], v[92:95], v[96:99], v[176:191]
  ds_read_b128 v[32:35], v21 offset:64
  v_mfma_f32_32x32x16_bf16 v[240:255], v[92:95], v[100:103], v[240:255]
  ds_read_b128 v[36:39], v21 offset:96
  s_waitcnt lgkmcnt(9)
  v_mfma_f32_32x32x16_bf16 v[128:143], v[104:107], v[120:123], v[128:143]
  s_mov_b32 s10, s15
  ds_read_b128 v[40:43], v21 offset:256
  s_waitcnt lgkmcnt(9)
  v_mfma_f32_32x32x16_bf16 v[192:207], v[104:107], v[124:127], v[192:207]
  ds_read_b128 v[44:47], v21 offset:288
  s_waitcnt lgkmcnt(8)
  v_mfma_f32_32x32x16_bf16 v[144:159], v[108:111], v[120:123], v[144:159]
  ds_read_b128 v[48:51], v21 offset:320
  v_mfma_f32_32x32x16_bf16 v[208:223], v[108:111], v[124:127], v[208:223]
  ds_read_b128 v[52:55], v21 offset:352
  s_waitcnt lgkmcnt(8)
  v_mfma_f32_32x32x16_bf16 v[160:175], v[112:115], v[120:123], v[160:175]
  ds_read_b128 v[64:67], v21 offset:512
  v_mfma_f32_32x32x16_bf16 v[224:239], v[112:115], v[124:127], v[224:239]
  ds_read_b128 v[68:71], v21 offset:544
  s_waitcnt lgkmcnt(8)
  v_mfma_f32_32x32x16_bf16 v[176:191], v[116:119], v[120:123], v[176:191]
  v_mov_b32 v10, 0
  ds_write_b32 v8, v10 offset:2000
  ds_read_b128 v[72:75], v21 offset:576
  v_mfma_f32_32x32x16_bf16 v[240:255], v[116:119], v[124:127], v[240:255]
  ds_read_b128 v[76:79], v21 offset:608
  ds_read_b32 v23, v4 offset:116
  ds_read_b128 v[80:83], v21 offset:768
  ds_read_b128 v[84:87], v21 offset:800
  ds_read_b128 v[88:91], v21 offset:832
  ds_read_b128 v[92:95], v21 offset:864
  s_nop 3
  s_waitcnt lgkmcnt(14)
  v_pk_fma_f32 v[128:129], v[24:25], v[56:57], v[128:129] op_sel_hi:[1,0,1]
  v_pk_fma_f32 v[130:131], v[26:27], v[56:57], v[130:131] op_sel_hi:[1,0,1]
  v_pk_fma_f32 v[132:133], v[28:29], v[56:57], v[132:133] op_sel_hi:[1,0,1]
  v_pk_fma_f32 v[134:135], v[30:31], v[56:57], v[134:135] op_sel_hi:[1,0,1]
  v_pk_fma_f32 v[136:137], v[32:33], v[56:57], v[136:137] op_sel_hi:[1,0,1]
  v_pk_fma_f32 v[138:139], v[34:35], v[56:57], v[138:139] op_sel_hi:[1,0,1]
  v_pk_fma_f32 v[140:141], v[36:37], v[56:57], v[140:141] op_sel_hi:[1,0,1]
  v_pk_fma_f32 v[142:143], v[38:39], v[56:57], v[142:143] op_sel_hi:[1,0,1]
  v_pk_mul_f32 v[96:97], v[128:129], v[58:59] op_sel_hi:[1,0]
  v_pk_mul_f32 v[98:99], v[130:131], v[58:59] op_sel_hi:[1,0]
  v_pk_mul_f32 v[100:101], v[136:137], v[58:59] op_sel_hi:[1,0]
  v_pk_mul_f32 v[102:103], v[138:139], v[58:59] op_sel_hi:[1,0]
  v_exp_f32 v96, v96
  v_exp_f32 v97, v97
  v_exp_f32 v98, v98
  v_exp_f32 v99, v99
  v_exp_f32 v100, v100
  v_exp_f32 v101, v101
  v_exp_f32 v102, v102
  v_exp_f32 v103, v103
  v_pk_mul_f32 v[128:129], v[128:129], v[132:133]
  v_pk_mul_f32 v[130:131], v[130:131], v[134:135]
  v_pk_mul_f32 v[136:137], v[136:137], v[140:141]
  v_pk_mul_f32 v[138:139], v[138:139], v[142:143]
  v_pk_fma_f32 v[96:97], v[96:97], v[56:57], v[56:57] op_sel:[0,1,1] op_sel_hi:[1,1,1]
  v_pk_fma_f32 v[98:99], v[98:99], v[56:57], v[56:57] op_sel:[0,1,1] op_sel_hi:[1,1,1]
  v_pk_fma_f32 v[100:101], v[100:101], v[56:57], v[56:57] op_sel:[0,1,1] op_sel_hi:[1,1,1]
  v_pk_fma_f32 v[102:103], v[102:103], v[56:57], v[56:57] op_sel:[0,1,1] op_sel_hi:[1,1,1]
  v_rcp_f32 v96, v96
  v_rcp_f32 v97, v97
  v_rcp_f32 v98, v98
  v_rcp_f32 v99, v99
  v_rcp_f32 v100, v100
  v_rcp_f32 v101, v101
  v_rcp_f32 v102, v102
  v_rcp_f32 v103, v103
  s_add_u32 s4, s9, 0
  v_pk_mul_f32 v[128:129], v[128:129], v[96:97]
  v_pk_mul_f32 v[130:131], v[130:131], v[98:99]
  v_pk_mul_f32 v[136:137], v[136:137], v[100:101]
  v_pk_mul_f32 v[138:139], v[138:139], v[102:103]
  v_cvt_pk_bf16_f32 v104, v128, v129
  v_cvt_pk_bf16_f32 v105, v130, v131
  v_cvt_pk_bf16_f32 v106, v136, v137
  v_cvt_pk_bf16_f32 v107, v138, v139
  buffer_store_dwordx4 v[104:107], v7, s[48:51], s4 offen sc1
  s_waitcnt lgkmcnt(4)
  v_readfirstlane_b32 s10, v23
  s_cmp_lg_u32 s10, 0
  s_cbranch_scc0 Lpoll_82
Lok_81:
  v_pk_fma_f32 v[192:193], v[24:25], v[60:61], v[192:193] op_sel_hi:[1,0,1]
  v_pk_fma_f32 v[194:195], v[26:27], v[60:61], v[194:195] op_sel_hi:[1,0,1]
  v_pk_fma_f32 v[196:197], v[28:29], v[60:61], v[196:197] op_sel_hi:[1,0,1]
  v_pk_fma_f32 v[198:199], v[30:31], v[60:61], v[198:199] op_sel_hi:[1,0,1]
  v_pk_fma_f32 v[200:201], v[32:33], v[60:61], v[200:201] op_sel_hi:[1,0,1]
  v_pk_fma_f32 v[202:203], v[34:35], v[60:61], v[202:203] op_sel_hi:[1,0,1]
  v_pk_fma_f32 v[204:205], v[36:37], v[60:61], v[204:205] op_sel_hi:[1,0,1]
  v_pk_fma_f32 v[206:207], v[38:39], v[60:61], v[206:207] op_sel_hi:[1,0,1]
  v_pk_mul_f32 v[112:113], v[192:193], v[62:63] op_sel_hi:[1,0]
  v_pk_mul_f32 v[114:115], v[194:195], v[62:63] op_sel_hi:[1,0]
  v_pk_mul_f32 v[116:117], v[200:201], v[62:63] op_sel_hi:[1,0]
  v_pk_mul_f32 v[118:119], v[202:203], v[62:63] op_sel_hi:[1,0]
  v_exp_f32 v112, v112
  v_exp_f32 v113, v113
  v_exp_f32 v114, v114
  v_exp_f32 v115, v115
  v_exp_f32 v116, v116
  v_exp_f32 v117, v117
  v_exp_f32 v118, v118
  v_exp_f32 v119, v119
  v_pk_mul_f32 v[192:193], v[192:193], v[196:197]
  v_pk_mul_f32 v[194:195], v[194:195], v[198:199]
  v_pk_mul_f32 v[200:201], v[200:201], v[204:205]
  v_pk_mul_f32 v[202:203], v[202:203], v[206:207]
  v_pk_fma_f32 v[112:113], v[112:113], v[60:61], v[60:61] op_sel:[0,1,1] op_sel_hi:[1,1,1]
  v_pk_fma_f32 v[114:115], v[114:115], v[60:61], v[60:61] op_sel:[0,1,1] op_sel_hi:[1,1,1]
  v_pk_fma_f32 v[116:117], v[116:117], v[60:61], v[60:61] op_sel:[0,1,1] op_sel_hi:[1,1,1]
  v_pk_fma_f32 v[118:119], v[118:119], v[60:61], v[60:61] op_sel:[0,1,1] op_sel_hi:[1,1,1]
  v_rcp_f32 v112, v112
  v_rcp_f32 v113, v113
  v_rcp_f32 v114, v114
  v_rcp_f32 v115, v115
  v_rcp_f32 v116, v116
  v_rcp_f32 v117, v117
  v_rcp_f32 v118, v118
  v_rcp_f32 v119, v119
  s_add_u32 s4, s9, 98304
  v_pk_mul_f32 v[192:193], v[192:193], v[112:113]
  v_pk_mul_f32 v[194:195], v[194:195], v[114:115]
  v_pk_mul_f32 v[200:201], v[200:201], v[116:117]
  v_pk_mul_f32 v[202:203], v[202:203], v[118:119]
  v_cvt_pk_bf16_f32 v120, v192, v193
  v_cvt_pk_bf16_f32 v121, v194, v195
  v_cvt_pk_bf16_f32 v122, v200, v201
  v_cvt_pk_bf16_f32 v123, v202, v203
  buffer_store_dwordx4 v[120:123], v7, s[48:51], s4 offen sc1
  v_pk_fma_f32 v[144:145], v[40:41], v[56:57], v[144:145] op_sel_hi:[1,0,1]
  v_pk_fma_f32 v[146:147], v[42:43], v[56:57], v[146:147] op_sel_hi:[1,0,1]
  v_pk_fma_f32 v[148:149], v[44:45], v[56:57], v[148:149] op_sel_hi:[1,0,1]
  v_pk_fma_f32 v[150:151], v[46:47], v[56:57], v[150:151] op_sel_hi:[1,0,1]
  v_pk_fma_f32 v[152:153], v[48:49], v[56:57], v[152:153] op_sel_hi:[1,0,1]
  v_pk_fma_f32 v[154:155], v[50:51], v[56:57], v[154:155] op_sel_hi:[1,0,1]
  v_pk_fma_f32 v[156:157], v[52:53], v[56:57], v[156:157] op_sel_hi:[1,0,1]
  v_pk_fma_f32 v[158:159], v[54:55], v[56:57], v[158:159] op_sel_hi:[1,0,1]
  v_pk_mul_f32 v[96:97], v[144:145], v[58:59] op_sel_hi:[1,0]
  v_pk_mul_f32 v[98:99], v[146:147], v[58:59] op_sel_hi:[1,0]
  v_pk_mul_f32 v[100:101], v[152:153], v[58:59] op_sel_hi:[1,0]
  v_pk_mul_f32 v[102:103], v[154:155], v[58:59] op_sel_hi:[1,0]
  v_exp_f32 v96, v96
  v_exp_f32 v97, v97
  v_exp_f32 v98, v98
  v_exp_f32 v99, v99
  v_exp_f32 v100, v100
  v_exp_f32 v101, v101
  v_exp_f32 v102, v102
  v_exp_f32 v103, v103
  v_pk_mul_f32 v[144:145], v[144:145], v[148:149]
  v_pk_mul_f32 v[146:147], v[146:147], v[150:151]
  v_pk_mul_f32 v[152:153], v[152:153], v[156:157]
  v_pk_mul_f32 v[154:155], v[154:155], v[158:159]
  v_pk_fma_f32 v[96:97], v[96:97], v[56:57], v[56:57] op_sel:[0,1,1] op_sel_hi:[1,1,1]
  v_pk_fma_f32 v[98:99], v[98:99], v[56:57], v[56:57] op_sel:[0,1,1] op_sel_hi:[1,1,1]
  v_pk_fma_f32 v[100:101], v[100:101], v[56:57], v[56:57] op_sel:[0,1,1] op_sel_hi:[1,1,1]
  v_pk_fma_f32 v[102:103], v[102:103], v[56:57], v[56:57] op_sel:[0,1,1] op_sel_hi:[1,1,1]
  v_rcp_f32 v96, v96
  v_rcp_f32 v97, v97
  v_rcp_f32 v98, v98
  v_rcp_f32 v99, v99
  v_rcp_f32 v100, v100
  v_rcp_f32 v101, v101
  v_rcp_f32 v102, v102
  v_rcp_f32 v103, v103
  s_add_u32 s4, s9, 2048
  v_pk_mul_f32 v[144:145], v[144:145], v[96:97]
  v_pk_mul_f32 v[146:147], v[146:147], v[98:99]
  v_pk_mul_f32 v[152:153], v[152:153], v[100:101]
  v_pk_mul_f32 v[154:155], v[154:155], v[102:103]
  v_cvt_pk_bf16_f32 v104, v144, v145
  v_cvt_pk_bf16_f32 v105, v146, v147
  v_cvt_pk_bf16_f32 v106, v152, v153
  v_cvt_pk_bf16_f32 v107, v154, v155
  buffer_store_dwordx4 v[104:107], v7, s[48:51], s4 offen sc1
  v_pk_fma_f32 v[208:209], v[40:41], v[60:61], v[208:209] op_sel_hi:[1,0,1]
  v_pk_fma_f32 v[210:211], v[42:43], v[60:61], v[210:211] op_sel_hi:[1,0,1]
  v_pk_fma_f32 v[212:213], v[44:45], v[60:61], v[212:213] op_sel_hi:[1,0,1]
  v_pk_fma_f32 v[214:215], v[46:47], v[60:61], v[214:215] op_sel_hi:[1,0,1]
  v_pk_fma_f32 v[216:217], v[48:49], v[60:61], v[216:217] op_sel_hi:[1,0,1]
  v_pk_fma_f32 v[218:219], v[50:51], v[60:61], v[218:219] op_sel_hi:[1,0,1]
  v_pk_fma_f32 v[220:221], v[52:53], v[60:61], v[220:221] op_sel_hi:[1,0,1]
  v_pk_fma_f32 v[222:223], v[54:55], v[60:61], v[222:223] op_sel_hi:[1,0,1]
  v_pk_mul_f32 v[112:113], v[208:209], v[62:63] op_sel_hi:[1,0]
  v_pk_mul_f32 v[114:115], v[210:211], v[62:63] op_sel_hi:[1,0]
  v_pk_mul_f32 v[116:117], v[216:217], v[62:63] op_sel_hi:[1,0]
  v_pk_mul_f32 v[118:119], v[218:219], v[62:63] op_sel_hi:[1,0]
  v_exp_f32 v112, v112
  v_exp_f32 v113, v113
  v_exp_f32 v114, v114
  v_exp_f32 v115, v115
  v_exp_f32 v116, v116
  v_exp_f32 v117, v117
  v_exp_f32 v118, v118
  v_exp_f32 v119, v119
  v_pk_mul_f32 v[208:209], v[208:209], v[212:213]
  v_pk_mul_f32 v[210:211], v[210:211], v[214:215]
  v_pk_mul_f32 v[216:217], v[216:217], v[220:221]
  v_pk_mul_f32 v[218:219], v[218:219], v[222:223]
  v_pk_fma_f32 v[112:113], v[112:113], v[60:61], v[60:61] op_sel:[0,1,1] op_sel_hi:[1,1,1]
  v_pk_fma_f32 v[114:115], v[114:115], v[60:61], v[60:61] op_sel:[0,1,1] op_sel_hi:[1,1,1]
  v_pk_fma_f32 v[116:117], v[116:117], v[60:61], v[60:61] op_sel:[0,1,1] op_sel_hi:[1,1,1]
  v_pk_fma_f32 v[118:119], v[118:119], v[60:61], v[60:61] op_sel:[0,1,1] op_sel_hi:[1,1,1]
  v_rcp_f32 v112, v112
  v_rcp_f32 v113, v113
  v_rcp_f32 v114, v114
  v_rcp_f32 v115, v115
  v_rcp_f32 v116, v116
  v_rcp_f32 v117, v117
  v_rcp_f32 v118, v118
  v_rcp_f32 v119, v119
  s_add_u32 s4, s9, 100352
  v_pk_mul_f32 v[208:209], v[208:209], v[112:113]
  v_pk_mul_f32 v[210:211], v[210:211], v[114:115]
  v_pk_mul_f32 v[216:217], v[216:217], v[116:117]
  v_pk_mul_f32 v[218:219], v[218:219], v[118:119]
  v_cvt_pk_bf16_f32 v120, v208, v209
  v_cvt_pk_bf16_f32 v121, v210, v211
  v_cvt_pk_bf16_f32 v122, v216, v217
  v_cvt_pk_bf16_f32 v123, v218, v219
  buffer_store_dwordx4 v[120:123], v7, s[48:51], s4 offen sc1
  v_pk_fma_f32 v[160:161], v[64:65], v[56:57], v[160:161] op_sel_hi:[1,0,1]
  v_pk_fma_f32 v[162:163], v[66:67], v[56:57], v[162:163] op_sel_hi:[1,0,1]
  v_pk_fma_f32 v[164:165], v[68:69], v[56:57], v[164:165] op_sel_hi:[1,0,1]
  v_pk_fma_f32 v[166:167], v[70:71], v[56:57], v[166:167] op_sel_hi:[1,0,1]
  v_pk_fma_f32 v[168:169], v[72:73], v[56:57], v[168:169] op_sel_hi:[1,0,1]
  v_pk_fma_f32 v[170:171], v[74:75], v[56:57], v[170:171] op_sel_hi:[1,0,1]
  v_pk_fma_f32 v[172:173], v[76:77], v[56:57], v[172:173] op_sel_hi:[1,0,1]
  v_pk_fma_f32 v[174:175], v[78:79], v[56:57], v[174:175] op_sel_hi:[1,0,1]
  v_pk_mul_f32 v[96:97], v[160:161], v[58:59] op_sel_hi:[1,0]
  v_pk_mul_f32 v[98:99], v[162:163], v[58:59] op_sel_hi:[1,0]
  v_pk_mul_f32 v[100:101], v[168:169], v[58:59] op_sel_hi:[1,0]
  v_pk_mul_f32 v[102:103], v[170:171], v[58:59] op_sel_hi:[1,0]
  v_exp_f32 v96, v96
  v_exp_f32 v97, v97
  v_exp_f32 v98, v98
  v_exp_f32 v99, v99
  v_exp_f32 v100, v100
  v_exp_f32 v101, v101
  v_exp_f32 v102, v102
  v_exp_f32 v103, v103
  v_pk_mul_f32 v[160:161], v[160:161], v[164:165]
  v_pk_mul_f32 v[162:163], v[162:163], v[166:167]
  v_pk_mul_f32 v[168:169], v[168:169], v[172:173]
  v_pk_mul_f32 v[170:171], v[170:171], v[174:175]
  v_pk_fma_f32 v[96:97], v[96:97], v[56:57], v[56:57] op_sel:[0,1,1] op_sel_hi:[1,1,1]
  v_pk_fma_f32 v[98:99], v[98:99], v[56:57], v[56:57] op_sel:[0,1,1] op_sel_hi:[1,1,1]
  v_pk_fma_f32 v[100:101], v[100:101], v[56:57], v[56:57] op_sel:[0,1,1] op_sel_hi:[1,1,1]
  v_pk_fma_f32 v[102:103], v[102:103], v[56:57], v[56:57] op_sel:[0,1,1] op_sel_hi:[1,1,1]
  v_rcp_f32 v96, v96
  v_rcp_f32 v97, v97
  v_rcp_f32 v98, v98
  v_rcp_f32 v99, v99
  v_rcp_f32 v100, v100
  v_rcp_f32 v101, v101
  v_rcp_f32 v102, v102
  v_rcp_f32 v103, v103
  s_add_u32 s4, s9, 4096
  v_pk_mul_f32 v[160:161], v[160:161], v[96:97]
  v_pk_mul_f32 v[162:163], v[162:163], v[98:99]
  v_pk_mul_f32 v[168:169], v[168:169], v[100:101]
  v_pk_mul_f32 v[170:171], v[170:171], v[102:103]
  v_cvt_pk_bf16_f32 v104, v160, v161
  v_cvt_pk_bf16_f32 v105, v162, v163
  v_cvt_pk_bf16_f32 v106, v168, v169
  v_cvt_pk_bf16_f32 v107, v170, v171
  buffer_store_dwordx4 v[104:107], v7, s[48:51], s4 offen sc1
  v_pk_fma_f32 v[224:225], v[64:65], v[60:61], v[224:225] op_sel_hi:[1,0,1]
  v_pk_fma_f32 v[226:227], v[66:67], v[60:61], v[226:227] op_sel_hi:[1,0,1]
  v_pk_fma_f32 v[228:229], v[68:69], v[60:61], v[228:229] op_sel_hi:[1,0,1]
  v_pk_fma_f32 v[230:231], v[70:71], v[60:61], v[230:231] op_sel_hi:[1,0,1]
  v_pk_fma_f32 v[232:233], v[72:73], v[60:61], v[232:233] op_sel_hi:[1,0,1]
  v_pk_fma_f32 v[234:235], v[74:75], v[60:61], v[234:235] op_sel_hi:[1,0,1]
  v_pk_fma_f32 v[236:237], v[76:77], v[60:61], v[236:237] op_sel_hi:[1,0,1]
  v_pk_fma_f32 v[238:239], v[78:79], v[60:61], v[238:239] op_sel_hi:[1,0,1]
  v_pk_mul_f32 v[112:113], v[224:225], v[62:63] op_sel_hi:[1,0]
  v_pk_mul_f32 v[114:115], v[226:227], v[62:63] op_sel_hi:[1,0]
  v_pk_mul_f32 v[116:117], v[232:233], v[62:63] op_sel_hi:[1,0]
  v_pk_mul_f32 v[118:119], v[234:235], v[62:63] op_sel_hi:[1,0]
  v_exp_f32 v112, v112
  v_exp_f32 v113, v113
  v_exp_f32 v114, v114
  v_exp_f32 v115, v115
  v_exp_f32 v116, v116
  v_exp_f32 v117, v117
  v_exp_f32 v118, v118
  v_exp_f32 v119, v119
  v_pk_mul_f32 v[224:225], v[224:225], v[228:229]
  v_pk_mul_f32 v[226:227], v[226:227], v[230:231]
  v_pk_mul_f32 v[232:233], v[232:233], v[236:237]
  v_pk_mul_f32 v[234:235], v[234:235], v[238:239]
  v_pk_fma_f32 v[112:113], v[112:113], v[60:61], v[60:61] op_sel:[0,1,1] op_sel_hi:[1,1,1]
  v_pk_fma_f32 v[114:115], v[114:115], v[60:61], v[60:61] op_sel:[0,1,1] op_sel_hi:[1,1,1]
  v_pk_fma_f32 v[116:117], v[116:117], v[60:61], v[60:61] op_sel:[0,1,1] op_sel_hi:[1,1,1]
  v_pk_fma_f32 v[118:119], v[118:119], v[60:61], v[60:61] op_sel:[0,1,1] op_sel_hi:[1,1,1]
  v_rcp_f32 v112, v112
  v_rcp_f32 v113, v113
  v_rcp_f32 v114, v114
  v_rcp_f32 v115, v115
  v_rcp_f32 v116, v116
  v_rcp_f32 v117, v117
  v_rcp_f32 v118, v118
  v_rcp_f32 v119, v119
  s_add_u32 s4, s9, 102400
  v_pk_mul_f32 v[224:225], v[224:225], v[112:113]
  v_pk_mul_f32 v[226:227], v[226:227], v[114:115]
  v_pk_mul_f32 v[232:233], v[232:233], v[116:117]
  v_pk_mul_f32 v[234:235], v[234:235], v[118:119]
  v_cvt_pk_bf16_f32 v120, v224, v225
  v_cvt_pk_bf16_f32 v121, v226, v227
  v_cvt_pk_bf16_f32 v122, v232, v233
  v_cvt_pk_bf16_f32 v123, v234, v235
  buffer_store_dwordx4 v[120:123], v7, s[48:51], s4 offen sc1
  s_waitcnt lgkmcnt(0)
  v_pk_fma_f32 v[176:177], v[80:81], v[56:57], v[176:177] op_sel_hi:[1,0,1]
  v_pk_fma_f32 v[178:179], v[82:83], v[56:57], v[178:179] op_sel_hi:[1,0,1]
  v_pk_fma_f32 v[180:181], v[84:85], v[56:57], v[180:181] op_sel_hi:[1,0,1]
  v_pk_fma_f32 v[182:183], v[86:87], v[56:57], v[182:183] op_sel_hi:[1,0,1]
  v_pk_fma_f32 v[184:185], v[88:89], v[56:57], v[184:185] op_sel_hi:[1,0,1]
  v_pk_fma_f32 v[186:187], v[90:91], v[56:57], v[186:187] op_sel_hi:[1,0,1]
  v_pk_fma_f32 v[188:189], v[92:93], v[56:57], v[188:189] op_sel_hi:[1,0,1]
  v_pk_fma_f32 v[190:191], v[94:95], v[56:57], v[190:191] op_sel_hi:[1,0,1]
  v_pk_mul_f32 v[96:97], v[176:177], v[58:59] op_sel_hi:[1,0]
  v_pk_mul_f32 v[98:99], v[178:179], v[58:59] op_sel_hi:[1,0]
  v_pk_mul_f32 v[100:101], v[184:185], v[58:59] op_sel_hi:[1,0]
  v_pk_mul_f32 v[102:103], v[186:187], v[58:59] op_sel_hi:[1,0]
  v_exp_f32 v96, v96
  v_exp_f32 v97, v97
  v_exp_f32 v98, v98
  v_exp_f32 v99, v99
  v_exp_f32 v100, v100
  v_exp_f32 v101, v101
  v_exp_f32 v102, v102
  v_exp_f32 v103, v103
  v_pk_mul_f32 v[176:177], v[176:177], v[180:181]
  v_pk_mul_f32 v[178:179], v[178:179], v[182:183]
  v_pk_mul_f32 v[184:185], v[184:185], v[188:189]
  v_pk_mul_f32 v[186:187], v[186:187], v[190:191]
  v_pk_fma_f32 v[96:97], v[96:97], v[56:57], v[56:57] op_sel:[0,1,1] op_sel_hi:[1,1,1]
  v_pk_fma_f32 v[98:99], v[98:99], v[56:57], v[56:57] op_sel:[0,1,1] op_sel_hi:[1,1,1]
  v_pk_fma_f32 v[100:101], v[100:101], v[56:57], v[56:57] op_sel:[0,1,1] op_sel_hi:[1,1,1]
  v_pk_fma_f32 v[102:103], v[102:103], v[56:57], v[56:57] op_sel:[0,1,1] op_sel_hi:[1,1,1]
  v_rcp_f32 v96, v96
  v_rcp_f32 v97, v97
  v_rcp_f32 v98, v98
  v_rcp_f32 v99, v99
  v_rcp_f32 v100, v100
  v_rcp_f32 v101, v101
  v_rcp_f32 v102, v102
  v_rcp_f32 v103, v103
  s_add_u32 s4, s9, 6144
  v_pk_mul_f32 v[176:177], v[176:177], v[96:97]
  v_pk_mul_f32 v[178:179], v[178:179], v[98:99]
  v_pk_mul_f32 v[184:185], v[184:185], v[100:101]
  v_pk_mul_f32 v[186:187], v[186:187], v[102:103]
  v_cvt_pk_bf16_f32 v104, v176, v177
  v_cvt_pk_bf16_f32 v105, v178, v179
  v_cvt_pk_bf16_f32 v106, v184, v185
  v_cvt_pk_bf16_f32 v107, v186, v187
  buffer_store_dwordx4 v[104:107], v7, s[48:51], s4 offen sc1
  v_pk_fma_f32 v[240:241], v[80:81], v[60:61], v[240:241] op_sel_hi:[1,0,1]
  v_pk_fma_f32 v[242:243], v[82:83], v[60:61], v[242:243] op_sel_hi:[1,0,1]
  v_pk_fma_f32 v[244:245], v[84:85], v[60:61], v[244:245] op_sel_hi:[1,0,1]
  v_pk_fma_f32 v[246:247], v[86:87], v[60:61], v[246:247] op_sel_hi:[1,0,1]
  v_pk_fma_f32 v[248:249], v[88:89], v[60:61], v[248:249] op_sel_hi:[1,0,1]
  v_pk_fma_f32 v[250:251], v[90:91], v[60:61], v[250:251] op_sel_hi:[1,0,1]
  v_pk_fma_f32 v[252:253], v[92:93], v[60:61], v[252:253] op_sel_hi:[1,0,1]
  v_pk_fma_f32 v[254:255], v[94:95], v[60:61], v[254:255] op_sel_hi:[1,0,1]
  v_pk_mul_f32 v[112:113], v[240:241], v[62:63] op_sel_hi:[1,0]
  v_pk_mul_f32 v[114:115], v[242:243], v[62:63] op_sel_hi:[1,0]
  v_pk_mul_f32 v[116:117], v[248:249], v[62:63] op_sel_hi:[1,0]
  v_pk_mul_f32 v[118:119], v[250:251], v[62:63] op_sel_hi:[1,0]
  v_exp_f32 v112, v112
  v_exp_f32 v113, v113
  v_exp_f32 v114, v114
  v_exp_f32 v115, v115
  v_exp_f32 v116, v116
  v_exp_f32 v117, v117
  v_exp_f32 v118, v118
  v_exp_f32 v119, v119
  v_pk_mul_f32 v[240:241], v[240:241], v[244:245]
  v_pk_mul_f32 v[242:243], v[242:243], v[246:247]
  v_pk_mul_f32 v[248:249], v[248:249], v[252:253]
  v_pk_mul_f32 v[250:251], v[250:251], v[254:255]
  v_pk_fma_f32 v[112:113], v[112:113], v[60:61], v[60:61] op_sel:[0,1,1] op_sel_hi:[1,1,1]
  v_pk_fma_f32 v[114:115], v[114:115], v[60:61], v[60:61] op_sel:[0,1,1] op_sel_hi:[1,1,1]
  v_pk_fma_f32 v[116:117], v[116:117], v[60:61], v[60:61] op_sel:[0,1,1] op_sel_hi:[1,1,1]
  v_pk_fma_f32 v[118:119], v[118:119], v[60:61], v[60:61] op_sel:[0,1,1] op_sel_hi:[1,1,1]
  v_rcp_f32 v112, v112
  v_rcp_f32 v113, v113
  v_rcp_f32 v114, v114
  v_rcp_f32 v115, v115
  v_rcp_f32 v116, v116
  v_rcp_f32 v117, v117
  v_rcp_f32 v118, v118
  v_rcp_f32 v119, v119
  s_add_u32 s4, s9, 104448
  v_pk_mul_f32 v[240:241], v[240:241], v[112:113]
  v_pk_mul_f32 v[242:243], v[242:243], v[114:115]
  v_pk_mul_f32 v[248:249], v[248:249], v[116:117]
  v_pk_mul_f32 v[250:251], v[250:251], v[118:119]
  v_cvt_pk_bf16_f32 v120, v240, v241
  v_cvt_pk_bf16_f32 v121, v242, v243
  v_cvt_pk_bf16_f32 v122, v248, v249
  v_cvt_pk_bf16_f32 v123, v250, v251
  buffer_store_dwordx4 v[120:123], v7, s[48:51], s4 offen sc1
  v_mov_b32 v10, 1
  ds_write_b32 v8, v10 offset:32
  s_lshl_b32 s57, s8, 4
  s_add_u32 s57, s57, s61
  s_lshl_b32 s57, s57, 1
  s_add_u32 s57, s57, s12
  s_lshl_b32 s57, s57, 7
  s_add_u32 s57, s57, 0xd90000
Lg2_8:
  v_lshrrev_b32 v9, 4, v1
  v_and_b32 v10, 15, v1
  v_lshlrev_b32 v10, 4, v10
  v_lshl_add_u32 v10, v9, 9, v10
  s_xor_b32 s4, s3, 0
  s_lshr_b32 s5, s4, 1
  s_mul_i32 s5, s5, 98304
  s_and_b32 s4, s4, 1
  s_lshl_b32 s4, s4, 8
  s_add_u32 s4, s4, s5
  v_add_u32 v12, s4, v10
  s_xor_b32 s4, s3, 1
  s_lshr_b32 s5, s4, 1
  s_mul_i32 s5, s5, 98304
  s_and_b32 s4, s4, 1
  s_lshl_b32 s4, s4, 8
  s_add_u32 s4, s4, s5
  v_add_u32 v13, s4, v10
  s_xor_b32 s4, s3, 2
  s_lshr_b32 s5, s4, 1
  s_mul_i32 s5, s5, 98304
  s_and_b32 s4, s4, 1
  s_lshl_b32 s4, s4, 8
  s_add_u32 s4, s4, s5
  v_add_u32 v14, s4, v10
  s_xor_b32 s4, s3, 3
  s_lshr_b32 s5, s4, 1
  s_mul_i32 s5, s5, 98304
  s_and_b32 s4, s4, 1
  s_lshl_b32 s4, s4, 8
  s_add_u32 s4, s4, s5
  v_add_u32 v15, s4, v10
  s_mov_b32 s4, 49664
  s_cmp_lt_u32 s3, 2
  s_cselect_b32 s4, s4, 18944
  s_bitcmp1_b32 s3, 0
  s_cselect_b32 s7, 5120, 0
  s_add_u32 s4, s4, s7
  v_add_u32 v16, s4, v7
  s_mov_b32 s4, 29184
  s_cmp_lt_u32 s3, 2
  s_cselect_b32 s4, s4, 59904
  s_bitcmp1_b32 s3, 0
  s_cselect_b32 s7, 5120, 0
  s_add_u32 s4, s4, s7
  v_add_u32 v17, s4, v7
  s_mov_b32 s4, 70144
  s_cmp_lt_u32 s3, 2
  s_cselect_b32 s4, s4, 80384
  s_bitcmp1_b32 s3, 0
  s_cselect_b32 s7, 5120, 0
  s_add_u32 s4, s4, s7
  v_add_u32 v18, s4, v7
  s_mov_b32 s4, 90624
  s_cmp_lt_u32 s3, 2
  s_cselect_b32 s4, s4, 8704
  s_bitcmp1_b32 s3, 0
  s_cselect_b32 s7, 5120, 0
  s_add_u32 s4, s4, s7
  v_add_u32 v19, s4, v7
  s_mov_b32 s4, 100864
  s_cmp_lt_u32 s3, 2
  s_cselect_b32 s4, s4, 111104
  s_bitcmp1_b32 s3, 0
  s_cselect_b32 s7, 5120, 0
  s_add_u32 s4, s4, s7
  v_add_u32 v20, s4, v7
  s_cmp_ge_u32 s2, 192
  s_cbranch_scc1 Lsg_83
  s_waitcnt vmcnt(0)
  v_mov_b32 v10, 0
  v_mov_b32 v11, s1
  s_mov_b64 exec, 1
  buffer_store_dword v11, v10, s[48:51], s57 offen sc1
  s_mov_b64 exec, -1
  buffer_load_dwordx4 v[128:131], v7, s[48:51], s52 offen offset:0 sc1
  buffer_load_dwordx4 v[132:135], v7, s[48:51], s52 offen offset:1024 sc1
  buffer_load_dwordx4 v[136:139], v7, s[48:51], s52 offen offset:2048 sc1
  buffer_load_dwordx4 v[140:143], v7, s[48:51], s52 offen offset:3072 sc1
  buffer_load_dwordx4 v[24:27], v22, s[48:51], s52 offen sc1
  s_add_u32 s52, s52, 5120
  s_cmp_ge_u32 s52, s53
  s_cselect_b32 s5, 61440, 0
  s_sub_u32 s52, s52, s5
  buffer_load_dwordx4 v[28:31], v7, s[48:51], s52 offen offset:0 sc1
  buffer_load_dwordx4 v[32:35], v7, s[48:51], s52 offen offset:1024 sc1
  buffer_load_dwordx4 v[36:39], v7, s[48:51], s52 offen offset:2048 sc1
  buffer_load_dwordx4 v[144:147], v7, s[48:51], s52 offen offset:3072 sc1
  buffer_load_dwordx4 v[148:151], v22, s[48:51], s52 offen sc1
  s_add_u32 s52, s52, 5120
  s_cmp_ge_u32 s52, s53
  s_cselect_b32 s5, 61440, 0
  s_sub_u32 s52, s52, s5
  buffer_load_dwordx4 v[152:155], v7, s[48:51], s52 offen offset:0 sc1
  buffer_load_dwordx4 v[156:159], v7, s[48:51], s52 offen offset:1024 sc1
  buffer_load_dwordx4 v[40:43], v7, s[48:51], s52 offen offset:2048 sc1
  buffer_load_dwordx4 v[44:47], v7, s[48:51], s52 offen offset:3072 sc1
  buffer_load_dwordx4 v[48:51], v22, s[48:51], s52 offen sc1
  s_add_u32 s52, s52, 5120
  s_cmp_ge_u32 s52, s53
  s_cselect_b32 s5, 61440, 0
  s_sub_u32 s52, s52, s5
  buffer_load_dwordx4 v[52:55], v7, s[48:51], s52 offen offset:0 sc1
  buffer_load_dwordx4 v[160:163], v7, s[48:51], s52 offen offset:1024 sc1
  buffer_load_dwordx4 v[164:167], v7, s[48:51], s52 offen offset:2048 sc1
  buffer_load_dwordx4 v[168:171], v7, s[48:51], s52 offen offset:3072 sc1
  buffer_load_dwordx4 v[172:175], v22, s[48:51], s52 offen sc1
  s_add_u32 s52, s52, 30720
  s_cmp_ge_u32 s52, s53
  s_cselect_b32 s5, 61440, 0
  s_sub_u32 s52, s52, s5
Lsg_83:
  v_mov_b32 v11, 1488
  s_call_b64 s[34:35], Lfw_39
Lok_84:
  v_and_b32 v9, 15, v1
  v_mul_u32_u24 v9, 160, v9
  v_lshrrev_b32 v10, 4, v1
  v_lshl_add_u32 v23, v10, 3, v9
  s_mul_i32 s4, s3, 2560
  s_add_u32 s4, s4, 39424
  v_add_u32 v9, s4, v23
  ds_read_b64 v[196:197], v9 offset:0
  ds_read_b64 v[198:199], v9 offset:32
  ds_read_b64 v[200:201], v9 offset:64
  ds_read_b64 v[202:203], v9 offset:96
  ds_read_b64 v[204:205], v9 offset:128
  s_waitcnt lgkmcnt(0)
  v_lshlrev_b32 v176, 16, v196
  v_and_b32 v177, 0xffff0000, v196
  v_lshlrev_b32 v178, 16, v197
  v_and_b32 v179, 0xffff0000, v197
  v_lshlrev_b32 v180, 16, v198
  v_and_b32 v181, 0xffff0000, v198
  v_lshlrev_b32 v182, 16, v199
  v_and_b32 v183, 0xffff0000, v199
  v_lshlrev_b32 v184, 16, v200
  v_and_b32 v185, 0xffff0000, v200
  v_lshlrev_b32 v186, 16, v201
  v_and_b32 v187, 0xffff0000, v201
  v_lshlrev_b32 v188, 16, v202
  v_and_b32 v189, 0xffff0000, v202
  v_lshlrev_b32 v190, 16, v203
  v_and_b32 v191, 0xffff0000, v203
  v_lshlrev_b32 v192, 16, v204
  v_and_b32 v193, 0xffff0000, v204
  v_lshlrev_b32 v194, 16, v205
  v_and_b32 v195, 0xffff0000, v205
  v_lshlrev_b32 v9, 7, v1
  s_lshl_b32 s6, s62, 12
  s_mul_i32 s4, s3, 768
  s_add_u32 s6, s6, s4
  s_add_u32 s6, s6, 0xd90000
  s_mov_b32 exec_lo, 0x3f
  s_mov_b32 exec_hi, 0x0
Lgp_85:
  s_sub_u32 s0, s0, 1
  s_cbranch_scc1 Lexit_2
  buffer_load_dword v21, v9, s[48:51], s6 offen offset:0 sc1
  s_waitcnt vmcnt(0)
  v_xor_b32 v10, s1, v21
  v_cmp_ne_u32 s[4:5], 0, v10
  s_cmp_eq_u64 s[4:5], 0
  s_cbranch_scc1 Lgd_86
  s_sleep 2
  s_branch Lgp_85
Lgd_86:
  s_mov_b64 exec, -1
  buffer_load_dwordx4 v[56:59], v12, s[48:51], s54 offen sc1
  buffer_load_dwordx4 v[60:63], v13, s[48:51], s54 offen sc1
  buffer_load_dwordx4 v[64:67], v14, s[48:51], s54 offen sc1
  buffer_load_dwordx4 v[68:71], v15, s[48:51], s54 offen sc1
  s_add_u32 s54, s54, 2048
  s_cmp_ge_u32 s54, s56
  s_cselect_b32 s54, s55, s54
  buffer_load_dwordx4 v[72:75], v12, s[48:51], s54 offen sc1
  buffer_load_dwordx4 v[76:79], v13, s[48:51], s54 offen sc1
  buffer_load_dwordx4 v[80:83], v14, s[48:51], s54 offen sc1
  buffer_load_dwordx4 v[84:87], v15, s[48:51], s54 offen sc1
  s_add_u32 s54, s54, 2048
  s_cmp_ge_u32 s54, s56
  s_cselect_b32 s54, s55, s54
  buffer_load_dwordx4 v[88:91], v12, s[48:51], s54 offen sc1
  buffer_load_dwordx4 v[92:95], v13, s[48:51], s54 offen sc1
  buffer_load_dwordx4 v[96:99], v14, s[48:51], s54 offen sc1
  buffer_load_dwordx4 v[100:103], v15, s[48:51], s54 offen sc1
  s_add_u32 s54, s54, 2048
  s_cmp_ge_u32 s54, s56
  s_cselect_b32 s54, s55, s54
  buffer_load_dwordx4 v[104:107], v12, s[48:51], s54 offen sc1
  buffer_load_dwordx4 v[108:111], v13, s[48:51], s54 offen sc1
  buffer_load_dwordx4 v[112:115], v14, s[48:51], s54 offen sc1
  buffer_load_dwordx4 v[116:119], v15, s[48:51], s54 offen sc1
  s_add_u32 s54, s54, 2048
  s_cmp_ge_u32 s54, s56
  s_cselect_b32 s54, s55, s54
  buffer_load_dwordx4 v[120:123], v12, s[48:51], s54 offen sc1
  buffer_load_dwordx4 v[124:127], v13, s[48:51], s54 offen sc1
  s_xor_b32 s5, s3, 1
  s_mov_b32 s58, 29184
  s_cmp_lt_u32 s5, 2
  s_cselect_b32 s58, s58, 59904
  s_bitcmp1_b32 s5, 0
  s_cselect_b32 s7, 5120, 0
  s_add_u32 s58, s58, s7
  s_xor_b32 s5, s3, 2
  s_mov_b32 s59, 70144
  s_cmp_lt_u32 s5, 2
  s_cselect_b32 s59, s59, 80384
  s_bitcmp1_b32 s5, 0
  s_cselect_b32 s7, 5120, 0
  s_add_u32 s59, s59, s7
  s_xor_b32 s5, s3, 3
  s_mov_b32 s15, 90624
  s_cmp_lt_u32 s5, 2
  s_cselect_b32 s15, s15, 8704
  s_bitcmp1_b32 s5, 0
  s_cselect_b32 s7, 5120, 0
  s_add_u32 s15, s15, s7
  s_lshl_b32 s6, s3, 4
  s_add_u32 s6, s6, 2048
  v_lshrrev_b32 v9, 1, v1
  v_lshlrev_b32 v9, 6, v9
  v_and_b32 v10, 1, v1
  v_lshl_add_u32 v9, v10, 3, v9
  v_add_u32 v21, s6, v9
  s_mov_b32 s64, s42
  s_mov_b32 s65, s43
  s_mov_b32 s66, 0x280000
  s_mov_b32 s67, 0x20000
  s_mov_b32 s4, 49664
  s_cmp_lt_u32 s3, 2
  s_cselect_b32 s4, s4, 18944
  s_bitcmp1_b32 s3, 0
  s_cselect_b32 s7, 5120, 0
  s_add_u32 s4, s4, s7
  v_add_u32 v23, s4, v23
  v_add_u32 v9, 0, v1
  v_mul_u32_u24 v10, 52429, v9
  v_lshrrev_b32 v10, 19, v10
  v_mul_u32_u24 v10, 1120, v10
  v_lshl_add_u32 v2, v9, 4, v10
  v_add_u32 v9, 64, v1
  v_mul_u32_u24 v10, 52429, v9
  v_lshrrev_b32 v10, 19, v10
  v_mul_u32_u24 v10, 1120, v10
  v_lshl_add_u32 v3, v9, 4, v10
  v_add_u32 v9, 128, v1
  v_mul_u32_u24 v10, 52429, v9
  v_lshrrev_b32 v10, 19, v10
  v_mul_u32_u24 v10, 1120, v10
  v_lshl_add_u32 v6, v9, 4, v10
  s_lshl_b32 s14, s62, 2
  s_add_u32 s14, s14, s3
  s_mul_i32 s14, s14, 20480
  s_mul_i32 s7, s63, 160
  s_add_u32 s14, s14, s7
  s_waitcnt vmcnt(17)
  v_mfma_f32_16x16x32_bf16 v[176:179], v[128:131], v[56:59], v[176:179]
  s_waitcnt vmcnt(16)
  v_mfma_f32_16x16x32_bf16 v[196:199], v[128:131], v[60:63], 0
  s_waitcnt vmcnt(15)
  v_mfma_f32_16x16x32_bf16 v[216:219], v[128:131], v[64:67], 0
  s_waitcnt vmcnt(14)
  v_mfma_f32_16x16x32_bf16 v[236:239], v[128:131], v[68:71], 0
  v_mfma_f32_16x16x32_bf16 v[180:183], v[132:135], v[56:59], v[180:183]
  v_mfma_f32_16x16x32_bf16 v[200:203], v[132:135], v[60:63], 0
  buffer_load_dwordx4 v[128:131], v14, s[48:51], s54 offen sc1
  v_mfma_f32_16x16x32_bf16 v[220:223], v[132:135], v[64:67], 0
  v_mfma_f32_16x16x32_bf16 v[240:243], v[132:135], v[68:71], 0
  v_mfma_f32_16x16x32_bf16 v[184:187], v[136:139], v[56:59], v[184:187]
  v_mfma_f32_16x16x32_bf16 v[204:207], v[136:139], v[60:63], 0
  buffer_load_dwordx4 v[132:135], v15, s[48:51], s54 offen sc1
  s_add_u32 s54, s54, 2048
  s_cmp_ge_u32 s54, s56
  s_cselect_b32 s54, s55, s54
  v_mfma_f32_16x16x32_bf16 v[224:227], v[136:139], v[64:67], 0
  v_mfma_f32_16x16x32_bf16 v[244:247], v[136:139], v[68:71], 0
  v_mfma_f32_16x16x32_bf16 v[188:191], v[140:143], v[56:59], v[188:191]
  v_mfma_f32_16x16x32_bf16 v[208:211], v[140:143], v[60:63], 0
  buffer_load_dwordx4 v[136:139], v12, s[48:51], s54 offen sc1
  v_mfma_f32_16x16x32_bf16 v[228:231], v[140:143], v[64:67], 0
  v_mfma_f32_16x16x32_bf16 v[248:251], v[140:143], v[68:71], 0
  v_mfma_f32_16x16x32_bf16 v[192:195], v[24:27], v[56:59], v[192:195]
  v_mfma_f32_16x16x32_bf16 v[212:215], v[24:27], v[60:63], 0
  buffer_load_dwordx4 v[140:143], v13, s[48:51], s54 offen sc1
  v_mfma_f32_16x16x32_bf16 v[232:235], v[24:27], v[64:67], 0
  v_mfma_f32_16x16x32_bf16 v[252:255], v[24:27], v[68:71], 0
  buffer_load_dwordx4 v[56:59], v14, s[48:51], s54 offen sc1
  s_waitcnt vmcnt(18)
  v_mfma_f32_16x16x32_bf16 v[176:179], v[28:31], v[72:75], v[176:179]
  s_waitcnt vmcnt(17)
  v_mfma_f32_16x16x32_bf16 v[196:199], v[28:31], v[76:79], v[196:199]
  buffer_load_dwordx4 v[60:63], v15, s[48:51], s54 offen sc1
  s_add_u32 s54, s54, 2048
  s_cmp_ge_u32 s54, s56
  s_cselect_b32 s54, s55, s54
  s_waitcnt vmcnt(17)
  v_mfma_f32_16x16x32_bf16 v[216:219], v[28:31], v[80:83], v[216:219]
  s_waitcnt vmcnt(16)
  v_mfma_f32_16x16x32_bf16 v[236:239], v[28:31], v[84:87], v[236:239]
  buffer_load_dwordx4 v[64:67], v12, s[48:51], s54 offen sc1
  v_mfma_f32_16x16x32_bf16 v[180:183], v[32:35], v[72:75], v[180:183]
  v_mfma_f32_16x16x32_bf16 v[200:203], v[32:35], v[76:79], v[200:203]
  buffer_load_dwordx4 v[68:71], v13, s[48:51], s54 offen sc1
  v_mfma_f32_16x16x32_bf16 v[220:223], v[32:35], v[80:83], v[220:223]
  v_mfma_f32_16x16x32_bf16 v[240:243], v[32:35], v[84:87], v[240:243]
  buffer_load_dwordx4 v[24:27], v14, s[48:51], s54 offen sc1
  v_mfma_f32_16x16x32_bf16 v[184:187], v[36:39], v[72:75], v[184:187]
  v_mfma_f32_16x16x32_bf16 v[204:207], v[36:39], v[76:79], v[204:207]
  buffer_load_dwordx4 v[28:31], v15, s[48:51], s54 offen sc1
  s_add_u32 s54, s54, 2048
  s_cmp_ge_u32 s54, s56
  s_cselect_b32 s54, s55, s54
  v_mfma_f32_16x16x32_bf16 v[224:227], v[36:39], v[80:83], v[224:227]
  v_mfma_f32_16x16x32_bf16 v[244:247], v[36:39], v[84:87], v[244:247]
  buffer_load_dwordx4 v[32:35], v12, s[48:51], s54 offen sc1
  v_mfma_f32_16x16x32_bf16 v[188:191], v[144:147], v[72:75], v[188:191]
  v_mfma_f32_16x16x32_bf16 v[208:211], v[144:147], v[76:79], v[208:211]
  buffer_load_dwordx4 v[36:39], v13, s[48:51], s54 offen sc1
  v_mfma_f32_16x16x32_bf16 v[228:231], v[144:147], v[80:83], v[228:231]
  v_mfma_f32_16x16x32_bf16 v[248:251], v[144:147], v[84:87], v[248:251]
  v_mfma_f32_16x16x32_bf16 v[192:195], v[148:151], v[72:75], v[192:195]
  v_mfma_f32_16x16x32_bf16 v[212:215], v[148:151], v[76:79], v[212:215]
  buffer_load_dwordx4 v[144:147], v14, s[48:51], s54 offen sc1
  v_mfma_f32_16x16x32_bf16 v[232:235], v[148:151], v[80:83], v[232:235]
  v_mfma_f32_16x16x32_bf16 v[252:255], v[148:151], v[84:87], v[252:255]
  buffer_load_dwordx4 v[72:75], v15, s[48:51], s54 offen sc1
  s_add_u32 s54, s54, 2048
  s_cmp_ge_u32 s54, s56
  s_cselect_b32 s54, s55, s54
  s_waitcnt vmcnt(23)
  v_mfma_f32_16x16x32_bf16 v[176:179], v[152:155], v[88:91], v[176:179]
  s_waitcnt vmcnt(22)
  v_mfma_f32_16x16x32_bf16 v[196:199], v[152:155], v[92:95], v[196:199]
  buffer_load_dwordx4 v[76:79], v12, s[48:51], s54 offen sc1
  s_waitcnt vmcnt(22)
  v_mfma_f32_16x16x32_bf16 v[216:219], v[152:155], v[96:99], v[216:219]
  s_waitcnt vmcnt(21)
  v_mfma_f32_16x16x32_bf16 v[236:239], v[152:155], v[100:103], v[236:239]
  buffer_load_dwordx4 v[80:83], v13, s[48:51], s54 offen sc1
  v_mfma_f32_16x16x32_bf16 v[180:183], v[156:159], v[88:91], v[180:183]
  v_mfma_f32_16x16x32_bf16 v[200:203], v[156:159], v[92:95], v[200:203]
  buffer_load_dwordx4 v[84:87], v14, s[48:51], s54 offen sc1
  v_mfma_f32_16x16x32_bf16 v[220:223], v[156:159], v[96:99], v[220:223]
  v_mfma_f32_16x16x32_bf16 v[240:243], v[156:159], v[100:103], v[240:243]
  buffer_load_dwordx4 v[148:151], v15, s[48:51], s54 offen sc1
  s_add_u32 s54, s54, 2048
  s_cmp_ge_u32 s54, s56
  s_cselect_b32 s54, s55, s54
  v_mfma_f32_16x16x32_bf16 v[184:187], v[40:43], v[88:91], v[184:187]
  v_mfma_f32_16x16x32_bf16 v[204:207], v[40:43], v[92:95], v[204:207]
  buffer_load_dwordx4 v[152:155], v12, s[48:51], s54 offen sc1
  v_mfma_f32_16x16x32_bf16 v[224:227], v[40:43], v[96:99], v[224:227]
  v_mfma_f32_16x16x32_bf16 v[244:247], v[40:43], v[100:103], v[244:247]
  buffer_load_dwordx4 v[156:159], v13, s[48:51], s54 offen sc1
  v_mfma_f32_16x16x32_bf16 v[188:191], v[44:47], v[88:91], v[188:191]
  v_mfma_f32_16x16x32_bf16 v[208:211], v[44:47], v[92:95], v[208:211]
  buffer_load_dwordx4 v[40:43], v14, s[48:51], s54 offen sc1
  v_mfma_f32_16x16x32_bf16 v[228:231], v[44:47], v[96:99], v[228:231]
  v_mfma_f32_16x16x32_bf16 v[248:251], v[44:47], v[100:103], v[248:251]
  v_mfma_f32_16x16x32_bf16 v[192:195], v[48:51], v[88:91], v[192:195]
  v_mfma_f32_16x16x32_bf16 v[212:215], v[48:51], v[92:95], v[212:215]
  buffer_load_dwordx4 v[44:47], v15, s[48:51], s54 offen sc1
  s_add_u32 s54, s54, 2048
  s_cmp_ge_u32 s54, s56
  s_cselect_b32 s54, s55, s54
  v_mfma_f32_16x16x32_bf16 v[232:235], v[48:51], v[96:99], v[232:235]
  v_mfma_f32_16x16x32_bf16 v[252:255], v[48:51], v[100:103], v[252:255]
  buffer_load_dwordx4 v[88:91], v7, s[48:51], s52 offen offset:0 sc1
  s_waitcnt vmcnt(28)
  v_mfma_f32_16x16x32_bf16 v[176:179], v[52:55], v[104:107], v[176:179]
  s_waitcnt vmcnt(27)
  v_mfma_f32_16x16x32_bf16 v[196:199], v[52:55], v[108:111], v[196:199]
  buffer_load_dwordx4 v[92:95], v7, s[48:51], s52 offen offset:1024 sc1
  s_waitcnt vmcnt(27)
  v_mfma_f32_16x16x32_bf16 v[216:219], v[52:55], v[112:115], v[216:219]
  s_waitcnt vmcnt(26)
  v_mfma_f32_16x16x32_bf16 v[236:239], v[52:55], v[116:119], v[236:239]
  buffer_load_dwordx4 v[96:99], v7, s[48:51], s52 offen offset:2048 sc1
  v_mov_b32 v11, 1528
  s_call_b64 s[34:35], Lfw_39
Lok_87:
  ds_read_b128 v[52:55], v16 offset:0
  v_mfma_f32_16x16x32_bf16 v[180:183], v[160:163], v[104:107], v[180:183]
  v_mfma_f32_16x16x32_bf16 v[200:203], v[160:163], v[108:111], v[200:203]
  buffer_load_dwordx4 v[100:103], v7, s[48:51], s52 offen offset:3072 sc1
  v_mfma_f32_16x16x32_bf16 v[220:223], v[160:163], v[112:115], v[220:223]
  v_mfma_f32_16x16x32_bf16 v[240:243], v[160:163], v[116:119], v[240:243]
  buffer_load_dwordx4 v[48:51], v22, s[48:51], s52 offen sc1
  s_add_u32 s52, s52, 5120
  s_cmp_ge_u32 s52, s53
  s_cselect_b32 s5, 61440, 0
  s_sub_u32 s52, s52, s5
  ds_read_b128 v[160:163], v16 offset:1024
  v_mfma_f32_16x16x32_bf16 v[184:187], v[164:167], v[104:107], v[184:187]
  v_mfma_f32_16x16x32_bf16 v[204:207], v[164:167], v[108:111], v[204:207]
  v_mfma_f32_16x16x32_bf16 v[224:227], v[164:167], v[112:115], v[224:227]
  v_mfma_f32_16x16x32_bf16 v[244:247], v[164:167], v[116:119], v[244:247]
  ds_read_b128 v[164:167], v16 offset:2048
  v_mfma_f32_16x16x32_bf16 v[188:191], v[168:171], v[104:107], v[188:191]
  v_mfma_f32_16x16x32_bf16 v[208:211], v[168:171], v[108:111], v[208:211]
  v_mfma_f32_16x16x32_bf16 v[228:231], v[168:171], v[112:115], v[228:231]
  v_mfma_f32_16x16x32_bf16 v[248:251], v[168:171], v[116:119], v[248:251]
  ds_read_b128 v[168:171], v16 offset:3072
  v_mfma_f32_16x16x32_bf16 v[192:195], v[172:175], v[104:107], v[192:195]
  v_mfma_f32_16x16x32_bf16 v[212:215], v[172:175], v[108:111], v[212:215]
  buffer_load_dwordx4 v[104:107], v12, s[48:51], s54 offen sc1
  v_mfma_f32_16x16x32_bf16 v[232:235], v[172:175], v[112:115], v[232:235]
  v_mfma_f32_16x16x32_bf16 v[252:255], v[172:175], v[116:119], v[252:255]
  buffer_load_dwordx4 v[108:111], v13, s[48:51], s54 offen sc1
  ds_read_b128 v[172:175], v16 offset:4096
  s_waitcnt lgkmcnt(4)
  s_waitcnt vmcnt(30)
  v_mfma_f32_16x16x32_bf16 v[176:179], v[52:55], v[120:123], v[176:179]
  s_waitcnt vmcnt(29)
  v_mfma_f32_16x16x32_bf16 v[196:199], v[52:55], v[124:127], v[196:199]
  buffer_load_dwordx4 v[112:115], v14, s[48:51], s54 offen sc1
  s_waitcnt vmcnt(29)
  v_mfma_f32_16x16x32_bf16 v[216:219], v[52:55], v[128:131], v[216:219]
  s_waitcnt vmcnt(28)
  v_mfma_f32_16x16x32_bf16 v[236:239], v[52:55], v[132:135], v[236:239]
  buffer_load_dwordx4 v[116:119], v15, s[48:51], s54 offen sc1
  s_add_u32 s54, s54, 2048
  s_cmp_ge_u32 s54, s56
  s_cselect_b32 s54, s55, s54
  v_mov_b32 v10, 0
  ds_write_b32 v8, v10 offset:2016
  ds_read_b128 v[52:55], v17 offset:0
  s_waitcnt lgkmcnt(5)
  v_mfma_f32_16x16x32_bf16 v[180:183], v[160:163], v[120:123], v[180:183]
  v_mfma_f32_16x16x32_bf16 v[200:203], v[160:163], v[124:127], v[200:203]
  v_mfma_f32_16x16x32_bf16 v[220:223], v[160:163], v[128:131], v[220:223]
  v_mfma_f32_16x16x32_bf16 v[240:243], v[160:163], v[132:135], v[240:243]
  ds_read_b128 v[160:163], v17 offset:1024
  s_waitcnt lgkmcnt(5)
  v_mfma_f32_16x16x32_bf16 v[184:187], v[164:167], v[120:123], v[184:187]
  v_mfma_f32_16x16x32_bf16 v[204:207], v[164:167], v[124:127], v[204:207]
  v_mfma_f32_16x16x32_bf16 v[224:227], v[164:167], v[128:131], v[224:227]
  v_mfma_f32_16x16x32_bf16 v[244:247], v[164:167], v[132:135], v[244:247]
  ds_read_b128 v[164:167], v17 offset:2048
  s_waitcnt lgkmcnt(5)
  v_mfma_f32_16x16x32_bf16 v[188:191], v[168:171], v[120:123], v[188:191]
  v_mfma_f32_16x16x32_bf16 v[208:211], v[168:171], v[124:127], v[208:211]
  v_mfma_f32_16x16x32_bf16 v[228:231], v[168:171], v[128:131], v[228:231]
  v_mfma_f32_16x16x32_bf16 v[248:251], v[168:171], v[132:135], v[248:251]
  ds_read_b128 v[168:171], v17 offset:3072
  s_waitcnt lgkmcnt(5)
  v_mfma_f32_16x16x32_bf16 v[192:195], v[172:175], v[120:123], v[192:195]
  v_mfma_f32_16x16x32_bf16 v[212:215], v[172:175], v[124:127], v[212:215]
  buffer_load_dwordx4 v[120:123], v7, s[48:51], s52 offen offset:0 sc1
  v_mfma_f32_16x16x32_bf16 v[232:235], v[172:175], v[128:131], v[232:235]
  v_mfma_f32_16x16x32_bf16 v[252:255], v[172:175], v[132:135], v[252:255]
  buffer_load_dwordx4 v[124:127], v7, s[48:51], s52 offen offset:1024 sc1
  ds_read_b128 v[172:175], v17 offset:4096
  s_waitcnt lgkmcnt(4)
  s_waitcnt vmcnt(30)
  v_mfma_f32_16x16x32_bf16 v[176:179], v[52:55], v[136:139], v[176:179]
  s_waitcnt vmcnt(29)
  v_mfma_f32_16x16x32_bf16 v[196:199], v[52:55], v[140:143], v[196:199]
  buffer_load_dwordx4 v[128:131], v7, s[48:51], s52 offen offset:2048 sc1
  s_waitcnt vmcnt(29)
  v_mfma_f32_16x16x32_bf16 v[216:219], v[52:55], v[56:59], v[216:219]
  s_waitcnt vmcnt(28)
  v_mfma_f32_16x16x32_bf16 v[236:239], v[52:55], v[60:63], v[236:239]
  buffer_load_dwordx4 v[132:135], v7, s[48:51], s52 offen offset:3072 sc1
  ds_read_b128 v[52:55], v18 offset:0
  s_waitcnt lgkmcnt(4)
  v_mfma_f32_16x16x32_bf16 v[180:183], v[160:163], v[136:139], v[180:183]
  v_mfma_f32_16x16x32_bf16 v[200:203], v[160:163], v[140:143], v[200:203]
  v_mfma_f32_16x16x32_bf16 v[220:223], v[160:163], v[56:59], v[220:223]
  v_mfma_f32_16x16x32_bf16 v[240:243], v[160:163], v[60:63], v[240:243]
  ds_read_b128 v[160:163], v18 offset:1024
  s_waitcnt lgkmcnt(4)
  v_mfma_f32_16x16x32_bf16 v[184:187], v[164:167], v[136:139], v[184:187]
  v_mfma_f32_16x16x32_bf16 v[204:207], v[164:167], v[140:143], v[204:207]
  v_mfma_f32_16x16x32_bf16 v[224:227], v[164:167], v[56:59], v[224:227]
  v_mfma_f32_16x16x32_bf16 v[244:247], v[164:167], v[60:63], v[244:247]
  ds_read_b128 v[164:167], v18 offset:2048
  s_waitcnt lgkmcnt(4)
  v_mfma_f32_16x16x32_bf16 v[188:191], v[168:171], v[136:139], v[188:191]
  v_mfma_f32_16x16x32_bf16 v[208:211], v[168:171], v[140:143], v[208:211]
  v_mfma_f32_16x16x32_bf16 v[228:231], v[168:171], v[56:59], v[228:231]
  v_mfma_f32_16x16x32_bf16 v[248:251], v[168:171], v[60:63], v[248:251]
  ds_read_b128 v[168:171], v18 offset:3072
  s_waitcnt lgkmcnt(4)
  v_mfma_f32_16x16x32_bf16 v[192:195], v[172:175], v[136:139], v[192:195]
  v_mfma_f32_16x16x32_bf16 v[212:215], v[172:175], v[140:143], v[212:215]
  buffer_load_dwordx4 v[136:139], v22, s[48:51], s52 offen sc1
  s_add_u32 s52, s52, 5120
  s_cmp_ge_u32 s52, s53
  s_cselect_b32 s5, 61440, 0
  s_sub_u32 s52, s52, s5
  v_mfma_f32_16x16x32_bf16 v[232:235], v[172:175], v[56:59], v[232:235]
  v_mfma_f32_16x16x32_bf16 v[252:255], v[172:175], v[60:63], v[252:255]
  buffer_load_dwordx4 v[140:143], v12, s[48:51], s54 offen sc1
  ds_read_b128 v[172:175], v18 offset:4096
  s_waitcnt lgkmcnt(4)
  s_waitcnt vmcnt(30)
  v_mfma_f32_16x16x32_bf16 v[176:179], v[52:55], v[64:67], v[176:179]
  s_waitcnt vmcnt(29)
  v_mfma_f32_16x16x32_bf16 v[196:199], v[52:55], v[68:71], v[196:199]
  buffer_load_dwordx4 v[56:59], v13, s[48:51], s54 offen sc1
  s_waitcnt vmcnt(29)
  v_mfma_f32_16x16x32_bf16 v[216:219], v[52:55], v[24:27], v[216:219]
  s_waitcnt vmcnt(28)
  v_mfma_f32_16x16x32_bf16 v[236:239], v[52:55], v[28:31], v[236:239]
  buffer_load_dwordx4 v[60:63], v14, s[48:51], s54 offen sc1
  ds_read_b128 v[52:55], v19 offset:0
  s_waitcnt lgkmcnt(4)
  v_mfma_f32_16x16x32_bf16 v[180:183], v[160:163], v[64:67], v[180:183]
  v_mfma_f32_16x16x32_bf16 v[200:203], v[160:163], v[68:71], v[200:203]
  v_mfma_f32_16x16x32_bf16 v[220:223], v[160:163], v[24:27], v[220:223]
  v_mfma_f32_16x16x32_bf16 v[240:243], v[160:163], v[28:31], v[240:243]
  ds_read_b128 v[160:163], v19 offset:1024
  s_waitcnt lgkmcnt(4)
  v_mfma_f32_16x16x32_bf16 v[184:187], v[164:167], v[64:67], v[184:187]
  v_mfma_f32_16x16x32_bf16 v[204:207], v[164:167], v[68:71], v[204:207]
  v_mfma_f32_16x16x32_bf16 v[224:227], v[164:167], v[24:27], v[224:227]
  v_mfma_f32_16x16x32_bf16 v[244:247], v[164:167], v[28:31], v[244:247]
  ds_read_b128 v[164:167], v19 offset:2048
  s_waitcnt lgkmcnt(4)
  v_mfma_f32_16x16x32_bf16 v[188:191], v[168:171], v[64:67], v[188:191]
  v_mfma_f32_16x16x32_bf16 v[208:211], v[168:171], v[68:71], v[208:211]
  v_mfma_f32_16x16x32_bf16 v[228:231], v[168:171], v[24:27], v[228:231]
  v_mfma_f32_16x16x32_bf16 v[248:251], v[168:171], v[28:31], v[248:251]
  ds_read_b128 v[168:171], v19 offset:3072
  s_waitcnt lgkmcnt(4)
  v_mfma_f32_16x16x32_bf16 v[192:195], v[172:175], v[64:67], v[192:195]
  v_mfma_f32_16x16x32_bf16 v[212:215], v[172:175], v[68:71], v[212:215]
  buffer_load_dwordx4 v[64:67], v15, s[48:51], s54 offen sc1
  v_mfma_f32_16x16x32_bf16 v[232:235], v[172:175], v[24:27], v[232:235]
  v_mfma_f32_16x16x32_bf16 v[252:255], v[172:175], v[28:31], v[252:255]
  buffer_load_dwordx4 v[68:71], v7, s[48:51], s52 offen offset:0 sc1
  ds_read_b128 v[172:175], v19 offset:4096
  s_waitcnt lgkmcnt(4)
  s_waitcnt vmcnt(30)
  v_mfma_f32_16x16x32_bf16 v[176:179], v[52:55], v[32:35], v[176:179]
  s_waitcnt vmcnt(29)
  v_mfma_f32_16x16x32_bf16 v[196:199], v[52:55], v[36:39], v[196:199]
  buffer_load_dwordx4 v[24:27], v7, s[48:51], s52 offen offset:1024 sc1
  s_waitcnt vmcnt(29)
  v_mfma_f32_16x16x32_bf16 v[216:219], v[52:55], v[144:147], v[216:219]
  s_waitcnt vmcnt(28)
  v_mfma_f32_16x16x32_bf16 v[236:239], v[52:55], v[72:75], v[236:239]
  buffer_load_dwordx4 v[28:31], v7, s[48:51], s52 offen offset:2048 sc1
  ds_read_b128 v[52:55], v20 offset:0
  s_waitcnt lgkmcnt(4)
  v_mfma_f32_16x16x32_bf16 v[180:183], v[160:163], v[32:35], v[180:183]
  v_mfma_f32_16x16x32_bf16 v[200:203], v[160:163], v[36:39], v[200:203]
  v_mfma_f32_16x16x32_bf16 v[220:223], v[160:163], v[144:147], v[220:223]
  v_mfma_f32_16x16x32_bf16 v[240:243], v[160:163], v[72:75], v[240:243]
  ds_read_b128 v[160:163], v20 offset:1024
  s_waitcnt lgkmcnt(4)
  v_mfma_f32_16x16x32_bf16 v[184:187], v[164:167], v[32:35], v[184:187]
  v_mfma_f32_16x16x32_bf16 v[204:207], v[164:167], v[36:39], v[204:207]
  v_mfma_f32_16x16x32_bf16 v[224:227], v[164:167], v[144:147], v[224:227]
  v_mfma_f32_16x16x32_bf16 v[244:247], v[164:167], v[72:75], v[244:247]
  ds_read_b128 v[164:167], v20 offset:2048
  s_waitcnt lgkmcnt(4)
  v_mfma_f32_16x16x32_bf16 v[188:191], v[168:171], v[32:35], v[188:191]
  v_mfma_f32_16x16x32_bf16 v[208:211], v[168:171], v[36:39], v[208:211]
  v_mfma_f32_16x16x32_bf16 v[228:231], v[168:171], v[144:147], v[228:231]
  v_mfma_f32_16x16x32_bf16 v[248:251], v[168:171], v[72:75], v[248:251]
  ds_read_b128 v[168:171], v20 offset:3072
  s_waitcnt lgkmcnt(4)
  v_mfma_f32_16x16x32_bf16 v[192:195], v[172:175], v[32:35], v[192:195]
  v_mfma_f32_16x16x32_bf16 v[212:215], v[172:175], v[36:39], v[212:215]
  buffer_load_dwordx4 v[32:35], v7, s[48:51], s52 offen offset:3072 sc1
  v_mfma_f32_16x16x32_bf16 v[232:235], v[172:175], v[144:147], v[232:235]
  v_mfma_f32_16x16x32_bf16 v[252:255], v[172:175], v[72:75], v[252:255]
  buffer_load_dwordx4 v[36:39], v22, s[48:51], s52 offen sc1
  ds_read_b128 v[172:175], v20 offset:4096
  s_waitcnt lgkmcnt(4)
  s_waitcnt vmcnt(30)
  v_mfma_f32_16x16x32_bf16 v[176:179], v[52:55], v[76:79], v[176:179]
  s_waitcnt vmcnt(29)
  v_mfma_f32_16x16x32_bf16 v[196:199], v[52:55], v[80:83], v[196:199]
  s_waitcnt vmcnt(28)
  v_mfma_f32_16x16x32_bf16 v[216:219], v[52:55], v[84:87], v[216:219]
  s_waitcnt vmcnt(27)
  v_mfma_f32_16x16x32_bf16 v[236:239], v[52:55], v[148:151], v[236:239]
  s_waitcnt lgkmcnt(3)
  v_mfma_f32_16x16x32_bf16 v[180:183], v[160:163], v[76:79], v[180:183]
  v_mfma_f32_16x16x32_bf16 v[200:203], v[160:163], v[80:83], v[200:203]
  v_mfma_f32_16x16x32_bf16 v[220:223], v[160:163], v[84:87], v[220:223]
  v_mfma_f32_16x16x32_bf16 v[240:243], v[160:163], v[148:151], v[240:243]
  s_waitcnt lgkmcnt(2)
  v_mfma_f32_16x16x32_bf16 v[184:187], v[164:167], v[76:79], v[184:187]
  v_mfma_f32_16x16x32_bf16 v[204:207], v[164:167], v[80:83], v[204:207]
  v_mfma_f32_16x16x32_bf16 v[224:227], v[164:167], v[84:87], v[224:227]
  v_mfma_f32_16x16x32_bf16 v[244:247], v[164:167], v[148:151], v[244:247]
  s_waitcnt lgkmcnt(1)
  v_mfma_f32_16x16x32_bf16 v[188:191], v[168:171], v[76:79], v[188:191]
  v_mfma_f32_16x16x32_bf16 v[208:211], v[168:171], v[80:83], v[208:211]
  v_mfma_f32_16x16x32_bf16 v[228:231], v[168:171], v[84:87], v[228:231]
  v_mfma_f32_16x16x32_bf16 v[248:251], v[168:171], v[148:151], v[248:251]
  s_waitcnt lgkmcnt(0)
  v_mfma_f32_16x16x32_bf16 v[192:195], v[172:175], v[76:79], v[192:195]
  v_mfma_f32_16x16x32_bf16 v[212:215], v[172:175], v[80:83], v[212:215]
  v_mfma_f32_16x16x32_bf16 v[232:235], v[172:175], v[84:87], v[232:235]
  v_mfma_f32_16x16x32_bf16 v[252:255], v[172:175], v[148:151], v[252:255]
  s_waitcnt vmcnt(22)
  v_mfma_f32_16x16x32_bf16 v[176:179], v[88:91], v[152:155], v[176:179]
  v_mfma_f32_16x16x32_bf16 v[196:199], v[88:91], v[156:159], v[196:199]
  v_mfma_f32_16x16x32_bf16 v[216:219], v[88:91], v[40:43], v[216:219]
  v_mfma_f32_16x16x32_bf16 v[236:239], v[88:91], v[44:47], v[236:239]
  s_waitcnt vmcnt(21)
  v_mfma_f32_16x16x32_bf16 v[180:183], v[92:95], v[152:155], v[180:183]
  v_mfma_f32_16x16x32_bf16 v[200:203], v[92:95], v[156:159], v[200:203]
  v_mfma_f32_16x16x32_bf16 v[220:223], v[92:95], v[40:43], v[220:223]
  v_mfma_f32_16x16x32_bf16 v[240:243], v[92:95], v[44:47], v[240:243]
  s_waitcnt vmcnt(20)
  v_mfma_f32_16x16x32_bf16 v[184:187], v[96:99], v[152:155], v[184:187]
  v_mfma_f32_16x16x32_bf16 v[204:207], v[96:99], v[156:159], v[204:207]
  v_mfma_f32_16x16x32_bf16 v[224:227], v[96:99], v[40:43], v[224:227]
  v_mfma_f32_16x16x32_bf16 v[244:247], v[96:99], v[44:47], v[244:247]
  s_waitcnt vmcnt(19)
  v_mfma_f32_16x16x32_bf16 v[188:191], v[100:103], v[152:155], v[188:191]
  v_mfma_f32_16x16x32_bf16 v[208:211], v[100:103], v[156:159], v[208:211]
  v_mfma_f32_16x16x32_bf16 v[228:231], v[100:103], v[40:43], v[228:231]
  v_mfma_f32_16x16x32_bf16 v[248:251], v[100:103], v[44:47], v[248:251]
  s_waitcnt vmcnt(18)
  v_mfma_f32_16x16x32_bf16 v[192:195], v[48:51], v[152:155], v[192:195]
  v_mfma_f32_16x16x32_bf16 v[212:215], v[48:51], v[156:159], v[212:215]
  v_mfma_f32_16x16x32_bf16 v[232:235], v[48:51], v[40:43], v[232:235]
  v_mfma_f32_16x16x32_bf16 v[252:255], v[48:51], v[44:47], v[252:255]
  s_waitcnt vmcnt(13)
  v_mfma_f32_16x16x32_bf16 v[176:179], v[120:123], v[104:107], v[176:179]
  v_mfma_f32_16x16x32_bf16 v[196:199], v[120:123], v[108:111], v[196:199]
  v_mfma_f32_16x16x32_bf16 v[216:219], v[120:123], v[112:115], v[216:219]
  v_mfma_f32_16x16x32_bf16 v[236:239], v[120:123], v[116:119], v[236:239]
  s_waitcnt vmcnt(12)
  v_mfma_f32_16x16x32_bf16 v[180:183], v[124:127], v[104:107], v[180:183]
  v_mfma_f32_16x16x32_bf16 v[200:203], v[124:127], v[108:111], v[200:203]
  v_mfma_f32_16x16x32_bf16 v[220:223], v[124:127], v[112:115], v[220:223]
  v_mfma_f32_16x16x32_bf16 v[240:243], v[124:127], v[116:119], v[240:243]
  s_waitcnt vmcnt(11)
  v_mfma_f32_16x16x32_bf16 v[184:187], v[128:131], v[104:107], v[184:187]
  v_mfma_f32_16x16x32_bf16 v[204:207], v[128:131], v[108:111], v[204:207]
  v_mfma_f32_16x16x32_bf16 v[224:227], v[128:131], v[112:115], v[224:227]
  v_mfma_f32_16x16x32_bf16 v[244:247], v[128:131], v[116:119], v[244:247]
  s_waitcnt vmcnt(10)
  v_mfma_f32_16x16x32_bf16 v[188:191], v[132:135], v[104:107], v[188:191]
  v_mfma_f32_16x16x32_bf16 v[208:211], v[132:135], v[108:111], v[208:211]
  v_mfma_f32_16x16x32_bf16 v[228:231], v[132:135], v[112:115], v[228:231]
  v_mfma_f32_16x16x32_bf16 v[248:251], v[132:135], v[116:119], v[248:251]
  s_waitcnt vmcnt(9)
  v_mfma_f32_16x16x32_bf16 v[192:195], v[136:139], v[104:107], v[192:195]
  v_mfma_f32_16x16x32_bf16 v[212:215], v[136:139], v[108:111], v[212:215]
  v_mfma_f32_16x16x32_bf16 v[232:235], v[136:139], v[112:115], v[232:235]
  v_mfma_f32_16x16x32_bf16 v[252:255], v[136:139], v[116:119], v[252:255]
  s_waitcnt vmcnt(7)
  s_waitcnt vmcnt(4)
  v_mfma_f32_16x16x32_bf16 v[196:199], v[68:71], v[56:59], v[196:199]
  s_waitcnt vmcnt(3)
  v_mfma_f32_16x16x32_bf16 v[200:203], v[24:27], v[56:59], v[200:203]
  s_waitcnt vmcnt(2)
  v_mfma_f32_16x16x32_bf16 v[204:207], v[28:31], v[56:59], v[204:207]
  s_waitcnt vmcnt(1)
  v_mfma_f32_16x16x32_bf16 v[208:211], v[32:35], v[56:59], v[208:211]
  s_waitcnt vmcnt(0)
  v_mfma_f32_16x16x32_bf16 v[212:215], v[36:39], v[56:59], v[212:215]
  v_mfma_f32_16x16x32_bf16 v[216:219], v[68:71], v[60:63], v[216:219]
  v_mfma_f32_16x16x32_bf16 v[220:223], v[24:27], v[60:63], v[220:223]
  v_mfma_f32_16x16x32_bf16 v[224:227], v[28:31], v[60:63], v[224:227]
  v_mfma_f32_16x16x32_bf16 v[228:231], v[32:35], v[60:63], v[228:231]
  ds_write_b128 v17, v[196:199] offset:0
  v_mfma_f32_16x16x32_bf16 v[232:235], v[36:39], v[60:63], v[232:235]
  ds_write_b128 v17, v[200:203] offset:1024
  v_mfma_f32_16x16x32_bf16 v[236:239], v[68:71], v[64:67], v[236:239]
  ds_write_b128 v17, v[204:207] offset:2048
  v_mfma_f32_16x16x32_bf16 v[240:243], v[24:27], v[64:67], v[240:243]
  ds_write_b128 v17, v[208:211] offset:3072
  v_mfma_f32_16x16x32_bf16 v[244:247], v[28:31], v[64:67], v[244:247]
  ds_write_b128 v17, v[212:215] offset:4096
  v_mfma_f32_16x16x32_bf16 v[248:251], v[32:35], v[64:67], v[248:251]
  ds_write_b128 v18, v[216:219] offset:0
  v_mfma_f32_16x16x32_bf16 v[252:255], v[36:39], v[64:67], v[252:255]
  ds_write_b128 v18, v[220:223] offset:1024
  v_mfma_f32_16x16x32_bf16 v[176:179], v[68:71], v[140:143], v[176:179]
  ds_write_b128 v18, v[224:227] offset:2048
  v_mfma_f32_16x16x32_bf16 v[180:183], v[24:27], v[140:143], v[180:183]
  ds_write_b128 v18, v[228:231] offset:3072
  v_mfma_f32_16x16x32_bf16 v[184:187], v[28:31], v[140:143], v[184:187]
  ds_write_b128 v18, v[232:235] offset:4096
  v_mfma_f32_16x16x32_bf16 v[188:191], v[32:35], v[140:143], v[188:191]
  ds_write_b128 v19, v[236:239] offset:0
  v_mfma_f32_16x16x32_bf16 v[192:195], v[36:39], v[140:143], v[192:195]
  ds_write_b128 v19, v[240:243] offset:1024
  ds_write_b128 v19, v[244:247] offset:2048
  ds_write_b128 v19, v[248:251] offset:3072
  ds_write_b128 v19, v[252:255] offset:4096
  v_add_u32 v13, s58, v7
  v_add_u32 v14, s59, v7
  v_add_u32 v15, s15, v7
  v_add_u32 v12, 119296, v21
  s_waitcnt lgkmcnt(0)
  s_barrier
  ds_read_b64_tr_b16 v[98:99], v12 offset:21248
  ds_read_b128 v[100:103], v13 offset:0
  ds_read_b128 v[104:107], v14 offset:0
  ds_read_b128 v[108:111], v15 offset:0
  ds_read_b64_tr_b16 v[114:115], v12 offset:23296
  ds_read_b128 v[116:119], v13 offset:1024
  ds_read_b128 v[120:123], v14 offset:1024
  ds_read_b128 v[124:127], v15 offset:1024
  ds_read_b64_tr_b16 v[130:131], v12 offset:0
  ds_read_b128 v[132:135], v13 offset:2048
  ds_read_b128 v[136:139], v14 offset:2048
  ds_read_b128 v[140:143], v15 offset:2048
  ds_read_b64_tr_b16 v[146:147], v12 offset:2048
  ds_read_b128 v[148:151], v13 offset:3072
  ds_read_b128 v[152:155], v14 offset:3072
  ds_read_b128 v[156:159], v15 offset:3072
  ds_read_b64_tr_b16 v[162:163], v21
  ds_read_b128 v[164:167], v13 offset:4096
  ds_read_b128 v[168:171], v14 offset:4096
  ds_read_b128 v[172:175], v15 offset:4096
  s_waitcnt lgkmcnt(15)
  v_lshlrev_b32 v96, 16, v98
  v_and_b32 v97, 0xffff0000, v98
  v_lshlrev_b32 v98, 16, v99
  v_and_b32 v99, 0xffff0000, v99
  v_pk_add_f32 v[176:177], v[176:177], v[100:101]
  v_pk_add_f32 v[104:105], v[104:105], v[108:109]
  v_pk_add_f32 v[178:179], v[178:179], v[102:103]
  v_pk_add_f32 v[106:107], v[106:107], v[110:111]
  v_pk_add_f32 v[176:177], v[176:177], v[96:97]
  v_pk_add_f32 v[178:179], v[178:179], v[98:99]
  v_pk_add_f32 v[176:177], v[176:177], v[104:105]
  v_pk_add_f32 v[178:179], v[178:179], v[106:107]
  v_cvt_pk_bf16_f32 v64, v176, v177
  v_cvt_pk_bf16_f32 v65, v178, v179
  ds_write_b64 v23, v[64:65] offset:0
  s_waitcnt lgkmcnt(13)
  v_lshlrev_b32 v112, 16, v114
  v_and_b32 v113, 0xffff0000, v114
  v_lshlrev_b32 v114, 16, v115
  v_and_b32 v115, 0xffff0000, v115
  v_pk_add_f32 v[180:181], v[180:181], v[116:117]
  v_pk_add_f32 v[120:121], v[120:121], v[124:125]
  v_pk_add_f32 v[182:183], v[182:183], v[118:119]
  v_pk_add_f32 v[122:123], v[122:123], v[126:127]
  v_pk_add_f32 v[180:181], v[180:181], v[112:113]
  v_pk_add_f32 v[182:183], v[182:183], v[114:115]
  v_pk_add_f32 v[180:181], v[180:181], v[120:121]
  v_pk_add_f32 v[182:183], v[182:183], v[122:123]
  v_cvt_pk_bf16_f32 v66, v180, v181
  v_cvt_pk_bf16_f32 v67, v182, v183
  ds_write_b64 v23, v[66:67] offset:32
  s_waitcnt lgkmcnt(10)
  v_lshlrev_b32 v128, 16, v130
  v_and_b32 v129, 0xffff0000, v130
  v_lshlrev_b32 v130, 16, v131
  v_and_b32 v131, 0xffff0000, v131
  v_pk_add_f32 v[184:185], v[184:185], v[132:133]
  v_pk_add_f32 v[136:137], v[136:137], v[140:141]
  v_pk_add_f32 v[186:187], v[186:187], v[134:135]
  v_pk_add_f32 v[138:139], v[138:139], v[142:143]
  v_pk_add_f32 v[184:185], v[184:185], v[128:129]
  v_pk_add_f32 v[186:187], v[186:187], v[130:131]
  v_pk_add_f32 v[184:185], v[184:185], v[136:137]
  v_pk_add_f32 v[186:187], v[186:187], v[138:139]
  v_cvt_pk_bf16_f32 v68, v184, v185
  v_cvt_pk_bf16_f32 v69, v186, v187
  ds_write_b64 v23, v[68:69] offset:64
  s_waitcnt lgkmcnt(7)
  v_lshlrev_b32 v144, 16, v146
  v_and_b32 v145, 0xffff0000, v146
  v_lshlrev_b32 v146, 16, v147
  v_and_b32 v147, 0xffff0000, v147
  v_pk_add_f32 v[188:189], v[188:189], v[148:149]
  v_pk_add_f32 v[152:153], v[152:153], v[156:157]
  v_pk_add_f32 v[190:191], v[190:191], v[150:151]
  v_pk_add_f32 v[154:155], v[154:155], v[158:159]
  v_pk_add_f32 v[188:189], v[188:189], v[144:145]
  v_pk_add_f32 v[190:191], v[190:191], v[146:147]
  v_pk_add_f32 v[188:189], v[188:189], v[152:153]
  v_pk_add_f32 v[190:191], v[190:191], v[154:155]
  v_cvt_pk_bf16_f32 v70, v188, v189
  v_cvt_pk_bf16_f32 v71, v190, v191
  ds_write_b64 v23, v[70:71] offset:96
  s_waitcnt lgkmcnt(4)
  v_lshlrev_b32 v160, 16, v162
  v_and_b32 v161, 0xffff0000, v162
  v_lshlrev_b32 v162, 16, v163
  v_and_b32 v163, 0xffff0000, v163
  v_pk_add_f32 v[192:193], v[192:193], v[164:165]
  v_pk_add_f32 v[168:169], v[168:169], v[172:173]
  v_pk_add_f32 v[194:195], v[194:195], v[166:167]
  v_pk_add_f32 v[170:171], v[170:171], v[174:175]
  v_pk_add_f32 v[192:193], v[192:193], v[160:161]
  v_pk_add_f32 v[194:195], v[194:195], v[162:163]
  v_pk_add_f32 v[192:193], v[192:193], v[168:169]
  v_pk_add_f32 v[194:195], v[194:195], v[170:171]
  v_cvt_pk_bf16_f32 v72, v192, v193
  v_cvt_pk_bf16_f32 v73, v194, v195
  ds_write_b64 v23, v[72:73] offset:128
  ds_read_b128 v[80:83], v16 offset:0
  ds_read_b128 v[84:87], v16 offset:1024
  ds_read_b128 v[88:91], v16 offset:2048
  s_waitcnt lgkmcnt(2)
  buffer_store_dwordx4 v[80:83], v2, s[64:67], s14 offen
  s_waitcnt lgkmcnt(1)
  buffer_store_dwordx4 v[84:87], v3, s[64:67], s14 offen
  s_waitcnt lgkmcnt(0)
  s_mov_b32 exec_hi, 0
  buffer_store_dwordx4 v[88:91], v6, s[64:67], s14 offen
  s_mov_b64 exec, -1
  s_endpgm
Lfw_39:
  s_sub_u32 s0, s0, 1
  s_cbranch_scc1 Lexit_2
  ds_read_b32 v5, v11
  s_waitcnt lgkmcnt(0)
  v_readfirstlane_b32 s10, v5
  s_cmp_eq_u32 s10, 0
  s_cbranch_scc0 Lfw_39
  s_setpc_b64 s[34:35]
Lpoll_46:
  s_sub_u32 s0, s0, 1
  s_cbranch_scc1 Lexit_2
  ds_read_b32 v20, v4 offset:4
  s_waitcnt lgkmcnt(0)
  v_readfirstlane_b32 s1, v20
  s_cmp_lg_u32 s1, 0
  s_cbranch_scc1 Lok_45
  s_sleep 1
  s_branch Lpoll_46
Lfs_50:
  v_mov_b32 v11, 1432
  s_call_b64 s[34:35], Lfw_39
  s_branch Lok_49
Lfs_52:
  v_mov_b32 v11, 1436
  s_call_b64 s[34:35], Lfw_39
  s_branch Lok_51
Lfs_54:
  v_mov_b32 v11, 1440
  s_call_b64 s[34:35], Lfw_39
  s_branch Lok_53
Lfs_56:
  v_mov_b32 v11, 1444
  s_call_b64 s[34:35], Lfw_39
  s_branch Lok_55
Lfs_58:
  v_mov_b32 v11, 1448
  s_call_b64 s[34:35], Lfw_39
  s_branch Lok_57
Lfs_60:
  v_mov_b32 v11, 1452
  s_call_b64 s[34:35], Lfw_39
  s_branch Lok_59
Lfs_62:
  v_mov_b32 v11, 1456
  s_call_b64 s[34:35], Lfw_39
  s_branch Lok_61
Lfs_64:
  v_mov_b32 v11, 1460
  s_call_b64 s[34:35], Lfw_39
  s_branch Lok_63
Lfs_66:
  v_mov_b32 v11, 1464
  s_call_b64 s[34:35], Lfw_39
  s_branch Lok_65
Lfs_68:
  v_mov_b32 v11, 1468
  s_call_b64 s[34:35], Lfw_39
  s_branch Lok_67
Lfs_70:
  v_mov_b32 v11, 1472
  s_call_b64 s[34:35], Lfw_39
  s_branch Lok_69
Lfs_72:
  v_mov_b32 v11, 1476
  s_call_b64 s[34:35], Lfw_39
  s_branch Lok_71
Lss_74:
Lgp_88:
  s_sub_u32 s0, s0, 1
  s_cbranch_scc1 Lexit_2
  buffer_load_dwordx2 v[16:17], v9, s[48:51], s6 offen offset:0 sc1
  buffer_load_dwordx2 v[18:19], v9, s[48:51], s6 offen offset:256 sc1
  s_waitcnt vmcnt(0)
  v_xor_b32 v10, s1, v17
  v_xor_b32 v11, s1, v19
  v_or_b32 v10, v10, v11
  v_cmp_ne_u32 s[4:5], 0, v10
  s_cmp_eq_u64 s[4:5], 0
  s_cbranch_scc1 Lgd_89
  s_sleep 2
  s_branch Lgp_88
Lgd_89:
  s_branch Lst_73
Lfs_76:
  v_mov_b32 v11, 1480
  s_call_b64 s[34:35], Lfw_39
  s_branch Lok_75
Lpoll_78:
  s_sub_u32 s0, s0, 1
  s_cbranch_scc1 Lexit_2
  ds_read_b32 v20, v4 offset:60
  s_waitcnt lgkmcnt(0)
  v_readfirstlane_b32 s10, v20
  s_cmp_lg_u32 s10, 0
  s_cbranch_scc1 Lok_77
  s_sleep 1
  s_branch Lpoll_78
Lfs_80:
  v_mov_b32 v11, 1484
  s_call_b64 s[34:35], Lfw_39
  s_branch Lok_79
Lpoll_82:
  s_sub_u32 s0, s0, 1
  s_cbranch_scc1 Lexit_2
  ds_read_b32 v23, v4 offset:116
  s_waitcnt lgkmcnt(0)
  v_readfirstlane_b32 s10, v23
  s_cmp_lg_u32 s10, 0
  s_cbranch_scc1 Lok_81
  s_sleep 1
  s_branch Lpoll_82
LS_7:
  s_cmp_ge_u32 s3, 4
  s_cbranch_scc1 Lch_5
  s_setprio 2
  v_mov_b32 v4, 0
  s_lshl_b32 s4, s3, 2
  v_mov_b32 v8, s4
  s_add_u32 s13, s4, 1664
  v_mov_b32 v6, 0x7ffffff0
  s_mul_i32 s15, s3, 19072
  s_add_u32 s15, s15, 2048
  s_and_b32 s4, s2, 1
  s_lshl_b32 s9, s4, 7
  s_bfe_u32 s4, s2, 0x20001
  s_lshl_b32 s4, s4, 5
  s_add_u32 s9, s9, s4
  s_bfe_u32 s4, s2, 0x30003
  s_lshl_b32 s4, s4, 2
  s_add_u32 s9, s9, s4
  s_add_u32 s9, s9, s3
  s_and_b32 s68, s2, 7
  s_mul_i32 s68, s68, 80
  s_lshr_b32 s4, s2, 3
  s_lshl_b32 s4, s4, 2
  s_add_u32 s68, s68, s4
  s_add_u32 s68, s68, s3
  s_sub_u32 s68, s68, 48
  s_mov_b32 s66, s15
  v_mov_b32 v40, 0
  v_mov_b32 v41, 0
  v_mov_b32 v42, 0
  v_mov_b32 v43, 0
  v_mov_b32 v44, 0
  v_mov_b32 v45, 0
  v_mov_b32 v46, 0
  s_mul_i32 s4, s68, 384
  v_lshlrev_b32 v60, 1, v1
  v_add_u32 v60, s4, v60
  s_lshl_b32 s4, s68, 1
  v_mov_b32 v61, s4
  s_waitcnt lgkmcnt(0)
  global_load_short_d16_hi v46, v61, s[30:31]
  global_load_short_d16_hi v40, v60, s[18:19] offset:256
  global_load_short_d16_hi v41, v60, s[20:21] offset:256
  global_load_short_d16_hi v42, v60, s[22:23] offset:256
  global_load_short_d16_hi v43, v60, s[24:25] offset:256
  global_load_short_d16_hi v44, v60, s[26:27] offset:256
  global_load_short_d16_hi v45, v60, s[28:29] offset:256
  s_barrier
  s_mov_b32 s0, 0x40000
  s_mov_b32 s48, s46
  s_mov_b32 s49, s47
  s_mov_b32 s50, 0x1200000
  s_mov_b32 s51, 0x20000
  v_bfe_u32 v82, v1, 1, 2
  v_lshlrev_b32 v82, 4, v82
  v_lshl_add_u32 v82, v1, 6, v82
  v_xor_b32 v212, 0, v82
  v_add_u32 v212, s66, v212
  v_xor_b32 v213, 16, v82
  v_add_u32 v213, s66, v213
  v_xor_b32 v214, 32, v82
  v_add_u32 v214, s66, v214
  v_xor_b32 v215, 48, v82
  v_add_u32 v215, s66, v215
  v_bfe_u32 v82, v1, 2, 2
  v_lshrrev_b32 v83, 5, v1
  v_lshl_add_u32 v82, v83, 3, v82
  v_lshlrev_b32 v70, 6, v82
  v_bfe_u32 v82, v1, 4, 1
  v_bfe_u32 v83, v1, 1, 1
  v_lshl_add_u32 v82, v82, 1, v83
  v_bfe_u32 v83, v1, 3, 1
  v_xor_b32 v82, v82, v83
  v_lshl_add_u32 v70, v82, 4, v70
  v_and_b32 v82, 1, v1
  v_lshl_add_u32 v70, v82, 3, v70
  v_xor_b32 v71, 32, v70
  v_add_u32 v70, s66, v70
  v_add_u32 v71, s66, v71
  v_mov_b32 v72, 1.0
  v_mov_b32 v73, 0
  s_lshr_b32 s5, s2, 3
  s_and_b32 s62, s2, 1
  s_lshl_b32 s62, s62, 4
  s_bfe_u32 s4, s2, 0x10001
  s_lshl_b32 s4, s4, 3
  s_add_u32 s62, s62, s4
  s_and_b32 s6, s5, 7
  s_add_u32 s62, s62, s6
  s_and_b32 s63, s2, 4
  s_lshr_b32 s6, s5, 3
  s_add_u32 s63, s63, s6
  s_mov_b32 s52, s16
  s_mov_b32 s53, s17
  s_mov_b32 s54, 0x280000
  s_mov_b32 s55, 0x20000
  s_waitcnt vmcnt(0)
  v_mul_f32 v68, 0x3fb8aa3b, v46
  v_exp_f32 v68, v68
  v_mov_b32 v62, v40
  v_mov_b32 v63, v41
  v_mov_b32 v64, v42
  v_mov_b32 v65, v43
  v_mov_b32 v66, v44
  v_mov_b32 v67, v45
  v_cvt_pk_bf16_f32 v68, v68, v68
  v_and_b32 v68, 0xffff0000, v68
  v_mov_b32 v196, 0
  v_mov_b32 v197, 0
  v_mov_b32 v198, 0
  v_mov_b32 v199, 0
  v_mov_b32 v200, 0
  v_mov_b32 v201, 0
  v_mov_b32 v202, 0
  v_mov_b32 v203, 0
  v_mov_b32 v204, 0
  v_mov_b32 v205, 0
  v_mov_b32 v206, 0
  v_mov_b32 v207, 0
  v_mov_b32 v208, 0
  v_mov_b32 v209, 0
  v_mov_b32 v210, 0
  v_mov_b32 v211, 0
  s_call_b64 s[34:35], Lkgen
  s_setprio 2
  v_lshrrev_b32 v24, 3, v1
  v_and_b32 v25, 7, v1
  v_mul_u32_u24 v26, 1280, v24
  v_lshl_add_u32 v26, v25, 4, v26
  s_mul_i32 s4, s9, 10240
  buffer_load_dwordx4 v[216:219], v26, s[52:55], s4 offen offset:0
  buffer_load_dwordx4 v[220:223], v26, s[52:55], s4 offen offset:128
  buffer_load_dwordx4 v[224:227], v26, s[52:55], s4 offen offset:256
  buffer_load_dwordx4 v[228:231], v26, s[52:55], s4 offen offset:384
  buffer_load_dwordx4 v[232:235], v26, s[52:55], s4 offen offset:512
  buffer_load_dwordx4 v[236:239], v26, s[52:55], s4 offen offset:640
  buffer_load_dwordx4 v[240:243], v26, s[52:55], s4 offen offset:768
  buffer_load_dwordx4 v[244:247], v26, s[52:55], s4 offen offset:896
  buffer_load_dwordx4 v[248:251], v26, s[52:55], s4 offen offset:1024
  buffer_load_dwordx4 v[252:255], v26, s[52:55], s4 offen offset:1152
  s_mov_b32 s56, s40
  s_mov_b32 s57, s41
  s_mov_b32 s58, 0x1e0000
  s_mov_b32 s59, 0x20000
  s_sub_u32 s4, s2, 192
  s_lshl_b32 s4, s4, 2
  s_add_u32 s4, s4, s3
  s_mul_i32 s14, s4, 52429
  s_lshr_b32 s14, s14, 18
  s_mul_i32 s5, s14, 5
  s_sub_u32 s13, s4, s5
  s_lshl_b32 s13, s13, 1
  s_mul_i32 s4, s14, 40960
  s_lshl_b32 s5, s13, 7
  s_add_u32 s4, s4, s5
  v_lshrrev_b32 v20, 4, v1
  v_mul_u32_u24 v20, 1280, v20
  v_and_b32 v21, 15, v1
  v_lshl_add_u32 v20, v21, 4, v20
  s_add_u32 m0, s15, 10496
  s_nop 0
  buffer_load_dwordx4 v20, s[56:59], s4 offen lds
  s_add_u32 s4, s4, 5120
  s_add_u32 m0, s15, 11520
  s_nop 0
  buffer_load_dwordx4 v20, s[56:59], s4 offen lds
  s_add_u32 s4, s4, 5120
  s_add_u32 m0, s15, 12544
  s_nop 0
  buffer_load_dwordx4 v20, s[56:59], s4 offen lds
  s_add_u32 s4, s4, 5120
  s_add_u32 m0, s15, 13568
  s_nop 0
  buffer_load_dwordx4 v20, s[56:59], s4 offen lds
  s_add_u32 s4, s4, 5120
  s_add_u32 m0, s15, 14592
  s_nop 0
  buffer_load_dwordx4 v20, s[56:59], s4 offen lds
  s_add_u32 s4, s4, 5120
  s_add_u32 m0, s15, 15616
  s_nop 0
  buffer_load_dwordx4 v20, s[56:59], s4 offen lds
  s_add_u32 s4, s4, 5120
  s_add_u32 m0, s15, 16640
  s_nop 0
  buffer_load_dwordx4 v20, s[56:59], s4 offen lds
  s_add_u32 s4, s4, 5120
  s_add_u32 m0, s15, 17664
  s_nop 0
  buffer_load_dwordx4 v20, s[56:59], s4 offen lds
  s_add_u32 s4, s4, 5120
  v_mov_b32 v22, 0
  global_load_dword v22, v22, s[44:45] sc1
  s_add_u32 s4, s3, 1
  s_mul_i32 s4, s4, 21248
  s_sub_u32 s7, 172032, s4
  v_lshlrev_b32 v10, 4, v1
  v_add_u32 v10, s7, v10
  s_nop 15
  ds_write_b128 v10, v[196:199] offset:0
  ds_write_b128 v10, v[200:203] offset:1024
  ds_write_b128 v10, v[204:207] offset:2048
  s_lshl_b32 s4, s3, 2
  v_mov_b32 v10, s4
  v_mov_b32 v11, 1
  ds_write_b32 v10, v11 offset:16
  s_waitcnt lgkmcnt(0)
  s_waitcnt vmcnt(9)
  v_lshlrev_b32 v64, 16, v216
  v_and_b32 v65, 0xffff0000, v216
  v_lshlrev_b32 v66, 16, v217
  v_and_b32 v67, 0xffff0000, v217
  v_lshlrev_b32 v68, 16, v218
  v_and_b32 v69, 0xffff0000, v218
  v_lshlrev_b32 v70, 16, v219
  v_and_b32 v71, 0xffff0000, v219
  v_lshlrev_b32 v72, 16, v220
  v_and_b32 v73, 0xffff0000, v220
  v_lshlrev_b32 v74, 16, v221
  v_and_b32 v75, 0xffff0000, v221
  v_lshlrev_b32 v76, 16, v222
  v_and_b32 v77, 0xffff0000, v222
  v_lshlrev_b32 v78, 16, v223
  v_and_b32 v79, 0xffff0000, v223
  v_lshlrev_b32 v80, 16, v224
  v_and_b32 v81, 0xffff0000, v224
  v_lshlrev_b32 v82, 16, v225
  v_and_b32 v83, 0xffff0000, v225
  v_lshlrev_b32 v84, 16, v226
  v_and_b32 v85, 0xffff0000, v226
  v_lshlrev_b32 v86, 16, v227
  v_and_b32 v87, 0xffff0000, v227
  v_lshlrev_b32 v88, 16, v228
  v_and_b32 v89, 0xffff0000, v228
  v_lshlrev_b32 v90, 16, v229
  v_and_b32 v91, 0xffff0000, v229
  v_lshlrev_b32 v92, 16, v230
  v_and_b32 v93, 0xffff0000, v230
  v_lshlrev_b32 v94, 16, v231
  v_and_b32 v95, 0xffff0000, v231
  v_lshlrev_b32 v96, 16, v232
  v_and_b32 v97, 0xffff0000, v232
  v_lshlrev_b32 v98, 16, v233
  v_and_b32 v99, 0xffff0000, v233
  v_lshlrev_b32 v100, 16, v234
  v_and_b32 v101, 0xffff0000, v234
  v_lshlrev_b32 v102, 16, v235
  v_and_b32 v103, 0xffff0000, v235
  v_lshlrev_b32 v104, 16, v236
  v_and_b32 v105, 0xffff0000, v236
  v_lshlrev_b32 v106, 16, v237
  v_and_b32 v107, 0xffff0000, v237
  v_lshlrev_b32 v108, 16, v238
  v_and_b32 v109, 0xffff0000, v238
  v_lshlrev_b32 v110, 16, v239
  v_and_b32 v111, 0xffff0000, v239
  v_lshlrev_b32 v112, 16, v240
  v_and_b32 v113, 0xffff0000, v240
  v_lshlrev_b32 v114, 16, v241
  v_and_b32 v115, 0xffff0000, v241
  v_lshlrev_b32 v116, 16, v242
  v_and_b32 v117, 0xffff0000, v242
  v_lshlrev_b32 v118, 16, v243
  v_and_b32 v119, 0xffff0000, v243
  v_lshlrev_b32 v120, 16, v244
  v_and_b32 v121, 0xffff0000, v244
  v_lshlrev_b32 v122, 16, v245
  v_and_b32 v123, 0xffff0000, v245
  v_lshlrev_b32 v124, 16, v246
  v_and_b32 v125, 0xffff0000, v246
  v_lshlrev_b32 v126, 16, v247
  v_and_b32 v127, 0xffff0000, v247
  v_lshlrev_b32 v128, 16, v248
  v_and_b32 v129, 0xffff0000, v248
  v_lshlrev_b32 v130, 16, v249
  v_and_b32 v131, 0xffff0000, v249
  v_lshlrev_b32 v132, 16, v250
  v_and_b32 v133, 0xffff0000, v250
  v_lshlrev_b32 v134, 16, v251
  v_and_b32 v135, 0xffff0000, v251
  v_lshlrev_b32 v136, 16, v252
  v_and_b32 v137, 0xffff0000, v252
  v_lshlrev_b32 v138, 16, v253
  v_and_b32 v139, 0xffff0000, v253
  v_lshlrev_b32 v140, 16, v254
  v_and_b32 v141, 0xffff0000, v254
  v_lshlrev_b32 v142, 16, v255
  v_and_b32 v143, 0xffff0000, v255
  v_pk_add_f32 v[28:29], v[64:65], v[66:67]
  v_pk_add_f32 v[30:31], v[68:69], v[70:71]
  v_pk_add_f32 v[28:29], v[28:29], v[72:73]
  v_pk_add_f32 v[30:31], v[30:31], v[74:75]
  v_pk_add_f32 v[28:29], v[28:29], v[76:77]
  v_pk_add_f32 v[30:31], v[30:31], v[78:79]
  v_pk_add_f32 v[28:29], v[28:29], v[80:81]
  v_pk_add_f32 v[30:31], v[30:31], v[82:83]
  v_pk_add_f32 v[28:29], v[28:29], v[84:85]
  v_pk_add_f32 v[30:31], v[30:31], v[86:87]
  v_pk_add_f32 v[28:29], v[28:29], v[88:89]
  v_pk_add_f32 v[30:31], v[30:31], v[90:91]
  v_pk_add_f32 v[28:29], v[28:29], v[92:93]
  v_pk_add_f32 v[30:31], v[30:31], v[94:95]
  v_pk_add_f32 v[28:29], v[28:29], v[96:97]
  v_pk_add_f32 v[30:31], v[30:31], v[98:99]
  v_pk_add_f32 v[28:29], v[28:29], v[100:101]
  v_pk_add_f32 v[30:31], v[30:31], v[102:103]
  v_pk_add_f32 v[28:29], v[28:29], v[104:105]
  v_pk_add_f32 v[30:31], v[30:31], v[106:107]
  v_pk_add_f32 v[28:29], v[28:29], v[108:109]
  v_pk_add_f32 v[30:31], v[30:31], v[110:111]
  v_pk_add_f32 v[28:29], v[28:29], v[112:113]
  v_pk_add_f32 v[30:31], v[30:31], v[114:115]
  v_pk_add_f32 v[28:29], v[28:29], v[116:117]
  v_pk_add_f32 v[30:31], v[30:31], v[118:119]
  v_pk_add_f32 v[28:29], v[28:29], v[120:121]
  v_pk_add_f32 v[30:31], v[30:31], v[122:123]
  v_pk_add_f32 v[28:29], v[28:29], v[124:125]
  v_pk_add_f32 v[30:31], v[30:31], v[126:127]
  v_pk_add_f32 v[28:29], v[28:29], v[128:129]
  v_pk_add_f32 v[30:31], v[30:31], v[130:131]
  v_pk_add_f32 v[28:29], v[28:29], v[132:133]
  v_pk_add_f32 v[30:31], v[30:31], v[134:135]
  v_pk_add_f32 v[28:29], v[28:29], v[136:137]
  v_pk_add_f32 v[30:31], v[30:31], v[138:139]
  v_pk_add_f32 v[28:29], v[28:29], v[140:141]
  v_pk_add_f32 v[30:31], v[30:31], v[142:143]
  v_pk_add_f32 v[28:29], v[28:29], v[30:31]
  v_add_f32 v28, v28, v29
  s_nop 1
  v_add_f32_dpp v28, v28, v28 quad_perm:[1,0,3,2] row_mask:0xf bank_mask:0xf
  s_nop 1
  v_add_f32_dpp v28, v28, v28 quad_perm:[2,3,0,1] row_mask:0xf bank_mask:0xf
  s_nop 1
  v_add_f32_dpp v28, v28, v28 row_half_mirror row_mask:0xf bank_mask:0xf
  v_mul_f32 v33, 0x3acccccd, v28
  v_cvt_pk_bf16_f32 v32, v33, v33
  v_and_b32 v32, 0xffff0000, v32
  v_pk_add_f32 v[64:65], v[64:65], v[32:33] op_sel_hi:[1,0] neg_lo:[0,1] neg_hi:[0,1]
  v_pk_add_f32 v[66:67], v[66:67], v[32:33] op_sel_hi:[1,0] neg_lo:[0,1] neg_hi:[0,1]
  v_pk_add_f32 v[68:69], v[68:69], v[32:33] op_sel_hi:[1,0] neg_lo:[0,1] neg_hi:[0,1]
  v_pk_add_f32 v[70:71], v[70:71], v[32:33] op_sel_hi:[1,0] neg_lo:[0,1] neg_hi:[0,1]
  v_pk_add_f32 v[72:73], v[72:73], v[32:33] op_sel_hi:[1,0] neg_lo:[0,1] neg_hi:[0,1]
  v_pk_add_f32 v[74:75], v[74:75], v[32:33] op_sel_hi:[1,0] neg_lo:[0,1] neg_hi:[0,1]
  v_pk_add_f32 v[76:77], v[76:77], v[32:33] op_sel_hi:[1,0] neg_lo:[0,1] neg_hi:[0,1]
  v_pk_add_f32 v[78:79], v[78:79], v[32:33] op_sel_hi:[1,0] neg_lo:[0,1] neg_hi:[0,1]
  v_pk_add_f32 v[80:81], v[80:81], v[32:33] op_sel_hi:[1,0] neg_lo:[0,1] neg_hi:[0,1]
  v_pk_add_f32 v[82:83], v[82:83], v[32:33] op_sel_hi:[1,0] neg_lo:[0,1] neg_hi:[0,1]
  v_pk_add_f32 v[84:85], v[84:85], v[32:33] op_sel_hi:[1,0] neg_lo:[0,1] neg_hi:[0,1]
  v_pk_add_f32 v[86:87], v[86:87], v[32:33] op_sel_hi:[1,0] neg_lo:[0,1] neg_hi:[0,1]
  v_pk_add_f32 v[88:89], v[88:89], v[32:33] op_sel_hi:[1,0] neg_lo:[0,1] neg_hi:[0,1]
  v_pk_add_f32 v[90:91], v[90:91], v[32:33] op_sel_hi:[1,0] neg_lo:[0,1] neg_hi:[0,1]
  v_pk_add_f32 v[92:93], v[92:93], v[32:33] op_sel_hi:[1,0] neg_lo:[0,1] neg_hi:[0,1]
  v_pk_add_f32 v[94:95], v[94:95], v[32:33] op_sel_hi:[1,0] neg_lo:[0,1] neg_hi:[0,1]
  v_pk_add_f32 v[96:97], v[96:97], v[32:33] op_sel_hi:[1,0] neg_lo:[0,1] neg_hi:[0,1]
  v_pk_add_f32 v[98:99], v[98:99], v[32:33] op_sel_hi:[1,0] neg_lo:[0,1] neg_hi:[0,1]
  v_pk_add_f32 v[100:101], v[100:101], v[32:33] op_sel_hi:[1,0] neg_lo:[0,1] neg_hi:[0,1]
  v_pk_add_f32 v[102:103], v[102:103], v[32:33] op_sel_hi:[1,0] neg_lo:[0,1] neg_hi:[0,1]
  v_pk_add_f32 v[104:105], v[104:105], v[32:33] op_sel_hi:[1,0] neg_lo:[0,1] neg_hi:[0,1]
  v_pk_add_f32 v[106:107], v[106:107], v[32:33] op_sel_hi:[1,0] neg_lo:[0,1] neg_hi:[0,1]
  v_pk_add_f32 v[108:109], v[108:109], v[32:33] op_sel_hi:[1,0] neg_lo:[0,1] neg_hi:[0,1]
  v_pk_add_f32 v[110:111], v[110:111], v[32:33] op_sel_hi:[1,0] neg_lo:[0,1] neg_hi:[0,1]
  v_pk_add_f32 v[112:113], v[112:113], v[32:33] op_sel_hi:[1,0] neg_lo:[0,1] neg_hi:[0,1]
  v_pk_add_f32 v[114:115], v[114:115], v[32:33] op_sel_hi:[1,0] neg_lo:[0,1] neg_hi:[0,1]
  v_pk_add_f32 v[116:117], v[116:117], v[32:33] op_sel_hi:[1,0] neg_lo:[0,1] neg_hi:[0,1]
  v_pk_add_f32 v[118:119], v[118:119], v[32:33] op_sel_hi:[1,0] neg_lo:[0,1] neg_hi:[0,1]
  v_pk_add_f32 v[120:121], v[120:121], v[32:33] op_sel_hi:[1,0] neg_lo:[0,1] neg_hi:[0,1]
  v_pk_add_f32 v[122:123], v[122:123], v[32:33] op_sel_hi:[1,0] neg_lo:[0,1] neg_hi:[0,1]
  v_pk_add_f32 v[124:125], v[124:125], v[32:33] op_sel_hi:[1,0] neg_lo:[0,1] neg_hi:[0,1]
  v_pk_add_f32 v[126:127], v[126:127], v[32:33] op_sel_hi:[1,0] neg_lo:[0,1] neg_hi:[0,1]
  v_pk_add_f32 v[128:129], v[128:129], v[32:33] op_sel_hi:[1,0] neg_lo:[0,1] neg_hi:[0,1]
  v_pk_add_f32 v[130:131], v[130:131], v[32:33] op_sel_hi:[1,0] neg_lo:[0,1] neg_hi:[0,1]
  v_pk_add_f32 v[132:133], v[132:133], v[32:33] op_sel_hi:[1,0] neg_lo:[0,1] neg_hi:[0,1]
  v_pk_add_f32 v[134:135], v[134:135], v[32:33] op_sel_hi:[1,0] neg_lo:[0,1] neg_hi:[0,1]
  v_pk_add_f32 v[136:137], v[136:137], v[32:33] op_sel_hi:[1,0] neg_lo:[0,1] neg_hi:[0,1]
  v_pk_add_f32 v[138:139], v[138:139], v[32:33] op_sel_hi:[1,0] neg_lo:[0,1] neg_hi:[0,1]
  v_pk_add_f32 v[140:141], v[140:141], v[32:33] op_sel_hi:[1,0] neg_lo:[0,1] neg_hi:[0,1]
  v_pk_add_f32 v[142:143], v[142:143], v[32:33] op_sel_hi:[1,0] neg_lo:[0,1] neg_hi:[0,1]
  v_pk_mul_f32 v[28:29], v[64:65], v[64:65]
  v_pk_mul_f32 v[30:31], v[66:67], v[66:67]
  v_pk_fma_f32 v[28:29], v[68:69], v[68:69], v[28:29]
  v_pk_fma_f32 v[30:31], v[70:71], v[70:71], v[30:31]
  v_pk_fma_f32 v[28:29], v[72:73], v[72:73], v[28:29]
  v_pk_fma_f32 v[30:31], v[74:75], v[74:75], v[30:31]
  v_pk_fma_f32 v[28:29], v[76:77], v[76:77], v[28:29]
  v_pk_fma_f32 v[30:31], v[78:79], v[78:79], v[30:31]
  v_pk_fma_f32 v[28:29], v[80:81], v[80:81], v[28:29]
  v_pk_fma_f32 v[30:31], v[82:83], v[82:83], v[30:31]
  v_pk_fma_f32 v[28:29], v[84:85], v[84:85], v[28:29]
  v_pk_fma_f32 v[30:31], v[86:87], v[86:87], v[30:31]
  v_pk_fma_f32 v[28:29], v[88:89], v[88:89], v[28:29]
  v_pk_fma_f32 v[30:31], v[90:91], v[90:91], v[30:31]
  v_pk_fma_f32 v[28:29], v[92:93], v[92:93], v[28:29]
  v_pk_fma_f32 v[30:31], v[94:95], v[94:95], v[30:31]
  v_pk_fma_f32 v[28:29], v[96:97], v[96:97], v[28:29]
  v_pk_fma_f32 v[30:31], v[98:99], v[98:99], v[30:31]
  v_pk_fma_f32 v[28:29], v[100:101], v[100:101], v[28:29]
  v_pk_fma_f32 v[30:31], v[102:103], v[102:103], v[30:31]
  v_pk_fma_f32 v[28:29], v[104:105], v[104:105], v[28:29]
  v_pk_fma_f32 v[30:31], v[106:107], v[106:107], v[30:31]
  v_pk_fma_f32 v[28:29], v[108:109], v[108:109], v[28:29]
  v_pk_fma_f32 v[30:31], v[110:111], v[110:111], v[30:31]
  v_pk_fma_f32 v[28:29], v[112:113], v[112:113], v[28:29]
  v_pk_fma_f32 v[30:31], v[114:115], v[114:115], v[30:31]
  v_pk_fma_f32 v[28:29], v[116:117], v[116:117], v[28:29]
  v_pk_fma_f32 v[30:31], v[118:119], v[118:119], v[30:31]
  v_pk_fma_f32 v[28:29], v[120:121], v[120:121], v[28:29]
  v_pk_fma_f32 v[30:31], v[122:123], v[122:123], v[30:31]
  v_pk_fma_f32 v[28:29], v[124:125], v[124:125], v[28:29]
  v_pk_fma_f32 v[30:31], v[126:127], v[126:127], v[30:31]
  v_pk_fma_f32 v[28:29], v[128:129], v[128:129], v[28:29]
  v_pk_fma_f32 v[30:31], v[130:131], v[130:131], v[30:31]
  v_pk_fma_f32 v[28:29], v[132:133], v[132:133], v[28:29]
  v_pk_fma_f32 v[30:31], v[134:135], v[134:135], v[30:31]
  v_pk_fma_f32 v[28:29], v[136:137], v[136:137], v[28:29]
  v_pk_fma_f32 v[30:31], v[138:139], v[138:139], v[30:31]
  v_pk_fma_f32 v[28:29], v[140:141], v[140:141], v[28:29]
  v_pk_fma_f32 v[30:31], v[142:143], v[142:143], v[30:31]
  v_pk_add_f32 v[28:29], v[28:29], v[30:31]
  v_add_f32 v28, v28, v29
  s_nop 1
  v_add_f32_dpp v28, v28, v28 quad_perm:[1,0,3,2] row_mask:0xf bank_mask:0xf
  s_nop 1
  v_add_f32_dpp v28, v28, v28 quad_perm:[2,3,0,1] row_mask:0xf bank_mask:0xf
  s_nop 1
  v_add_f32_dpp v28, v28, v28 row_half_mirror row_mask:0xf bank_mask:0xf
  v_sub_f32 v33, v33, v32
  v_mul_f32 v34, 0x3acccccd, v28
  v_fma_f32 v34, -v33, v33, v34
  v_max_f32 v34, 0, v34
  v_cvt_pk_bf16_f32 v34, v34, v34
  v_and_b32 v34, 0xffff0000, v34
  v_add_f32 v34, 0x3727c5ac, v34
  v_cvt_pk_bf16_f32 v34, v34, v34
  v_and_b32 v34, 0xffff0000, v34
  v_sqrt_f32 v34, v34
  s_nop 0
  v_cvt_pk_bf16_f32 v28, v32, v34
  v_and_b32 v34, 0xffff0000, v28
  v_rcp_f32 v34, v34
  v_mul_u32_u24 v26, 1312, v24
  v_lshl_add_u32 v26, v25, 4, v26
  v_add_u32 v26, s15, v26
  v_pk_mul_f32 v[64:65], v[64:65], v[34:35] op_sel_hi:[1,0]
  v_pk_mul_f32 v[66:67], v[66:67], v[34:35] op_sel_hi:[1,0]
  v_pk_mul_f32 v[68:69], v[68:69], v[34:35] op_sel_hi:[1,0]
  v_pk_mul_f32 v[70:71], v[70:71], v[34:35] op_sel_hi:[1,0]
  v_cvt_pk_bf16_f32 v216, v64, v65
  v_cvt_pk_bf16_f32 v217, v66, v67
  v_cvt_pk_bf16_f32 v218, v68, v69
  v_cvt_pk_bf16_f32 v219, v70, v71
  v_pk_mul_f32 v[72:73], v[72:73], v[34:35] op_sel_hi:[1,0]
  v_pk_mul_f32 v[74:75], v[74:75], v[34:35] op_sel_hi:[1,0]
  v_pk_mul_f32 v[76:77], v[76:77], v[34:35] op_sel_hi:[1,0]
  v_pk_mul_f32 v[78:79], v[78:79], v[34:35] op_sel_hi:[1,0]
  ds_write_b128 v26, v[216:219] offset:0
  v_cvt_pk_bf16_f32 v220, v72, v73
  v_cvt_pk_bf16_f32 v221, v74, v75
  v_cvt_pk_bf16_f32 v222, v76, v77
  v_cvt_pk_bf16_f32 v223, v78, v79
  v_pk_mul_f32 v[80:81], v[80:81], v[34:35] op_sel_hi:[1,0]
  v_pk_mul_f32 v[82:83], v[82:83], v[34:35] op_sel_hi:[1,0]
  v_pk_mul_f32 v[84:85], v[84:85], v[34:35] op_sel_hi:[1,0]
  v_pk_mul_f32 v[86:87], v[86:87], v[34:35] op_sel_hi:[1,0]
  ds_write_b128 v26, v[220:223] offset:128
  v_cvt_pk_bf16_f32 v224, v80, v81
  v_cvt_pk_bf16_f32 v225, v82, v83
  v_cvt_pk_bf16_f32 v226, v84, v85
  v_cvt_pk_bf16_f32 v227, v86, v87
  v_pk_mul_f32 v[88:89], v[88:89], v[34:35] op_sel_hi:[1,0]
  v_pk_mul_f32 v[90:91], v[90:91], v[34:35] op_sel_hi:[1,0]
  v_pk_mul_f32 v[92:93], v[92:93], v[34:35] op_sel_hi:[1,0]
  v_pk_mul_f32 v[94:95], v[94:95], v[34:35] op_sel_hi:[1,0]
  ds_write_b128 v26, v[224:227] offset:256
  v_cvt_pk_bf16_f32 v228, v88, v89
  v_cvt_pk_bf16_f32 v229, v90, v91
  v_cvt_pk_bf16_f32 v230, v92, v93
  v_cvt_pk_bf16_f32 v231, v94, v95
  v_pk_mul_f32 v[96:97], v[96:97], v[34:35] op_sel_hi:[1,0]
  v_pk_mul_f32 v[98:99], v[98:99], v[34:35] op_sel_hi:[1,0]
  v_pk_mul_f32 v[100:101], v[100:101], v[34:35] op_sel_hi:[1,0]
  v_pk_mul_f32 v[102:103], v[102:103], v[34:35] op_sel_hi:[1,0]
  ds_write_b128 v26, v[228:231] offset:384
  v_cvt_pk_bf16_f32 v232, v96, v97
  v_cvt_pk_bf16_f32 v233, v98, v99
  v_cvt_pk_bf16_f32 v234, v100, v101
  v_cvt_pk_bf16_f32 v235, v102, v103
  v_pk_mul_f32 v[104:105], v[104:105], v[34:35] op_sel_hi:[1,0]
  v_pk_mul_f32 v[106:107], v[106:107], v[34:35] op_sel_hi:[1,0]
  v_pk_mul_f32 v[108:109], v[108:109], v[34:35] op_sel_hi:[1,0]
  v_pk_mul_f32 v[110:111], v[110:111], v[34:35] op_sel_hi:[1,0]
  ds_write_b128 v26, v[232:235] offset:512
  v_cvt_pk_bf16_f32 v236, v104, v105
  v_cvt_pk_bf16_f32 v237, v106, v107
  v_cvt_pk_bf16_f32 v238, v108, v109
  v_cvt_pk_bf16_f32 v239, v110, v111
  v_pk_mul_f32 v[112:113], v[112:113], v[34:35] op_sel_hi:[1,0]
  v_pk_mul_f32 v[114:115], v[114:115], v[34:35] op_sel_hi:[1,0]
  v_pk_mul_f32 v[116:117], v[116:117], v[34:35] op_sel_hi:[1,0]
  v_pk_mul_f32 v[118:119], v[118:119], v[34:35] op_sel_hi:[1,0]
  ds_write_b128 v26, v[236:239] offset:640
  v_cvt_pk_bf16_f32 v240, v112, v113
  v_cvt_pk_bf16_f32 v241, v114, v115
  v_cvt_pk_bf16_f32 v242, v116, v117
  v_cvt_pk_bf16_f32 v243, v118, v119
  v_pk_mul_f32 v[120:121], v[120:121], v[34:35] op_sel_hi:[1,0]
  v_pk_mul_f32 v[122:123], v[122:123], v[34:35] op_sel_hi:[1,0]
  v_pk_mul_f32 v[124:125], v[124:125], v[34:35] op_sel_hi:[1,0]
  v_pk_mul_f32 v[126:127], v[126:127], v[34:35] op_sel_hi:[1,0]
  ds_write_b128 v26, v[240:243] offset:768
  v_cvt_pk_bf16_f32 v244, v120, v121
  v_cvt_pk_bf16_f32 v245, v122, v123
  v_cvt_pk_bf16_f32 v246, v124, v125
  v_cvt_pk_bf16_f32 v247, v126, v127
  v_pk_mul_f32 v[128:129], v[128:129], v[34:35] op_sel_hi:[1,0]
  v_pk_mul_f32 v[130:131], v[130:131], v[34:35] op_sel_hi:[1,0]
  v_pk_mul_f32 v[132:133], v[132:133], v[34:35] op_sel_hi:[1,0]
  v_pk_mul_f32 v[134:135], v[134:135], v[34:35] op_sel_hi:[1,0]
  ds_write_b128 v26, v[244:247] offset:896
  v_cvt_pk_bf16_f32 v248, v128, v129
  v_cvt_pk_bf16_f32 v249, v130, v131
  v_cvt_pk_bf16_f32 v250, v132, v133
  v_cvt_pk_bf16_f32 v251, v134, v135
  v_pk_mul_f32 v[136:137], v[136:137], v[34:35] op_sel_hi:[1,0]
  v_pk_mul_f32 v[138:139], v[138:139], v[34:35] op_sel_hi:[1,0]
  v_pk_mul_f32 v[140:141], v[140:141], v[34:35] op_sel_hi:[1,0]
  v_pk_mul_f32 v[142:143], v[142:143], v[34:35] op_sel_hi:[1,0]
  ds_write_b128 v26, v[248:251] offset:1024
  v_cvt_pk_bf16_f32 v252, v136, v137
  v_cvt_pk_bf16_f32 v253, v138, v139
  v_cvt_pk_bf16_f32 v254, v140, v141
  v_cvt_pk_bf16_f32 v255, v142, v143
  ds_write_b128 v26, v[252:255] offset:1152
  s_branch Lnc_91
Lnp_90:
  s_sub_u32 s0, s0, 1
  s_cbranch_scc1 Lexit_2
  v_mov_b32 v22, 0
  global_load_dword v22, v22, s[44:45] sc1
Lnc_91:
  s_waitcnt vmcnt(0)
  v_readfirstlane_b32 s1, v22
  s_cmp_lg_u32 s1, 0
  s_cbranch_scc0 Lnp_90
  v_mov_b32 v23, 0
  ds_write_b32 v23, v22 offset:4
  v_bfe_u32 v36, v1, 2, 2
  v_mul_u32_u24 v36, 1312, v36
  v_lshrrev_b32 v37, 4, v1
  v_lshl_add_u32 v36, v37, 5, v36
  v_and_b32 v37, 3, v1
  v_lshl_add_u32 v36, v37, 3, v36
  v_add_u32 v36, s15, v36
  ds_read_b64_tr_b16 v[64:65], v36 offset:0
  ds_read_b64_tr_b16 v[66:67], v36 offset:5248
  ds_read_b64_tr_b16 v[68:69], v36 offset:128
  ds_read_b64_tr_b16 v[70:71], v36 offset:5376
  ds_read_b64_tr_b16 v[72:73], v36 offset:256
  ds_read_b64_tr_b16 v[74:75], v36 offset:5504
  ds_read_b64_tr_b16 v[76:77], v36 offset:384
  ds_read_b64_tr_b16 v[78:79], v36 offset:5632
  ds_read_b64_tr_b16 v[80:81], v36 offset:512
  ds_read_b64_tr_b16 v[82:83], v36 offset:5760
  ds_read_b64_tr_b16 v[84:85], v36 offset:640
  ds_read_b64_tr_b16 v[86:87], v36 offset:5888
  ds_read_b64_tr_b16 v[88:89], v36 offset:768
  ds_read_b64_tr_b16 v[90:91], v36 offset:6016
  ds_read_b64_tr_b16 v[92:93], v36 offset:896
  ds_read_b64_tr_b16 v[94:95], v36 offset:6144
  ds_read_b64_tr_b16 v[96:97], v36 offset:1024
  ds_read_b64_tr_b16 v[98:99], v36 offset:6272
  ds_read_b64_tr_b16 v[100:101], v36 offset:1152
  ds_read_b64_tr_b16 v[102:103], v36 offset:6400
  v_mov_b32 v29, s1
  s_lshl_b32 s6, s9, 6
  s_add_u32 s6, s6, 0x0
  s_mov_b32 exec_lo, 0x1010101
  s_mov_b32 exec_hi, 0x1010101
  buffer_store_dwordx2 v[28:29], v1, s[48:51], s6 offen sc1
  s_mov_b64 exec, -1
  v_lshlrev_b32 v36, 4, v1
  s_mul_i32 s7, s9, 10240
  s_add_u32 s7, s7, 0x280000
  s_waitcnt lgkmcnt(0)
  buffer_store_dwordx4 v[64:67], v36, s[48:51], s7 offen offset:0 sc1
  buffer_store_dwordx4 v[68:71], v36, s[48:51], s7 offen offset:1024 sc1
  buffer_store_dwordx4 v[72:75], v36, s[48:51], s7 offen offset:2048 sc1
  buffer_store_dwordx4 v[76:79], v36, s[48:51], s7 offen offset:3072 sc1
  s_add_u32 s7, s7, 4096
  buffer_store_dwordx4 v[80:83], v36, s[48:51], s7 offen offset:0 sc1
  buffer_store_dwordx4 v[84:87], v36, s[48:51], s7 offen offset:1024 sc1
  buffer_store_dwordx4 v[88:91], v36, s[48:51], s7 offen offset:2048 sc1
  buffer_store_dwordx4 v[92:95], v36, s[48:51], s7 offen offset:3072 sc1
  s_add_u32 s7, s7, 4096
  buffer_store_dwordx4 v[96:99], v36, s[48:51], s7 offen offset:0 sc1
  buffer_store_dwordx4 v[100:103], v36, s[48:51], s7 offen offset:1024 sc1
  v_lshrrev_b32 v20, 2, v1
  v_lshlrev_b32 v20, 8, v20
  v_and_b32 v21, 3, v1
  v_lshl_add_u32 v20, v21, 3, v20
  v_add_u32 v20, s15, v20
  v_lshlrev_b32 v21, 4, v1
  ds_read_b64_tr_b16 v[160:161], v20 offset:10496
  ds_read_b64_tr_b16 v[162:163], v20 offset:14592
  ds_read_b64_tr_b16 v[164:165], v20 offset:10528
  ds_read_b64_tr_b16 v[166:167], v20 offset:14624
  ds_read_b64_tr_b16 v[168:169], v20 offset:10560
  ds_read_b64_tr_b16 v[170:171], v20 offset:14656
  ds_read_b64_tr_b16 v[172:173], v20 offset:10592
  ds_read_b64_tr_b16 v[174:175], v20 offset:14688
  ds_read_b64_tr_b16 v[176:177], v20 offset:10624
  ds_read_b64_tr_b16 v[178:179], v20 offset:14720
  ds_read_b64_tr_b16 v[180:181], v20 offset:10656
  ds_read_b64_tr_b16 v[182:183], v20 offset:14752
  ds_read_b64_tr_b16 v[184:185], v20 offset:10688
  ds_read_b64_tr_b16 v[186:187], v20 offset:14784
  ds_read_b64_tr_b16 v[188:189], v20 offset:10720
  ds_read_b64_tr_b16 v[190:191], v20 offset:14816
  s_lshl_b32 s4, s13, 2
  s_mul_i32 s5, s4, 52429
  s_lshr_b32 s5, s5, 18
  s_mul_i32 s6, s5, 5
  s_sub_u32 s13, s4, s6
  s_mul_i32 s5, s5, 240
  s_mul_i32 s6, s14, 5
  s_add_u32 s5, s5, s6
  s_add_u32 s5, s5, s13
  s_lshl_b32 s5, s5, 10
  s_add_u32 s8, s5, 0x1000000
  v_mov_b32 v10, 0
  v_mov_b32 v11, 1
  s_waitcnt vmcnt(0)
  s_mov_b64 exec, 1
  ds_add_rtn_u32 v11, v10, v11 offset:80
  s_mov_b64 exec, -1
  s_waitcnt lgkmcnt(0)
  v_readfirstlane_b32 s4, v11
  s_cmp_lg_u32 s4, 3
  s_cbranch_scc1 Lf_93
  s_lshl_b32 s6, s2, 7
  s_add_u32 s6, s6, 0xd7a000
  v_mov_b32 v10, 0
  v_mov_b32 v11, s1
  s_mov_b64 exec, 1
  buffer_store_dword v11, v10, s[48:51], s6 offen sc1
  s_mov_b64 exec, -1
Lf_93:
  s_cmp_ge_u32 s14, 48
  s_cbranch_scc1 Lwd_92
  buffer_store_dwordx4 v[160:163], v21, s[48:51], s8 offen sc1
  s_add_u32 s13, s13, 1
  s_cmp_eq_u32 s13, 5
  s_cselect_b32 s13, 0, s13
  s_cselect_b32 s4, 240640, 0
  s_add_u32 s8, s8, s4
  s_add_u32 s8, s8, 1024
  buffer_store_dwordx4 v[164:167], v21, s[48:51], s8 offen sc1
  s_add_u32 s13, s13, 1
  s_cmp_eq_u32 s13, 5
  s_cselect_b32 s13, 0, s13
  s_cselect_b32 s4, 240640, 0
  s_add_u32 s8, s8, s4
  s_add_u32 s8, s8, 1024
  buffer_store_dwordx4 v[168:171], v21, s[48:51], s8 offen sc1
  s_add_u32 s13, s13, 1
  s_cmp_eq_u32 s13, 5
  s_cselect_b32 s13, 0, s13
  s_cselect_b32 s4, 240640, 0
  s_add_u32 s8, s8, s4
  s_add_u32 s8, s8, 1024
  buffer_store_dwordx4 v[172:175], v21, s[48:51], s8 offen sc1
  s_add_u32 s13, s13, 1
  s_cmp_eq_u32 s13, 5
  s_cselect_b32 s13, 0, s13
  s_cselect_b32 s4, 240640, 0
  s_add_u32 s8, s8, s4
  s_add_u32 s8, s8, 1024
  buffer_store_dwordx4 v[176:179], v21, s[48:51], s8 offen sc1
  s_add_u32 s13, s13, 1
  s_cmp_eq_u32 s13, 5
  s_cselect_b32 s13, 0, s13
  s_cselect_b32 s4, 240640, 0
  s_add_u32 s8, s8, s4
  s_add_u32 s8, s8, 1024
  buffer_store_dwordx4 v[180:183], v21, s[48:51], s8 offen sc1
  s_add_u32 s13, s13, 1
  s_cmp_eq_u32 s13, 5
  s_cselect_b32 s13, 0, s13
  s_cselect_b32 s4, 240640, 0
  s_add_u32 s8, s8, s4
  s_add_u32 s8, s8, 1024
  buffer_store_dwordx4 v[184:187], v21, s[48:51], s8 offen sc1
  s_add_u32 s13, s13, 1
  s_cmp_eq_u32 s13, 5
  s_cselect_b32 s13, 0, s13
  s_cselect_b32 s4, 240640, 0
  s_add_u32 s8, s8, s4
  s_add_u32 s8, s8, 1024
  buffer_store_dwordx4 v[188:191], v21, s[48:51], s8 offen sc1
Lwd_92:
  s_cmp_lt_u32 s3, 2
  s_mov_b32 s4, 0xfffff
  s_cselect_b32 s4, 0x3fffff, s4
  v_lshl_add_u32 v10, v1, 4, v8
  v_mov_b32 v11, 0
  s_mov_b32 exec_lo, s4
  s_mov_b32 exec_hi, 0
  ds_write_b32 v10, v11 offset:1664
  s_mov_b64 exec, -1
  v_mov_b32 v10, 0
  v_mov_b32 v11, 1
  s_waitcnt vmcnt(0)
  s_mov_b64 exec, 1
  ds_add_rtn_u32 v11, v10, v11 offset:112
  s_mov_b64 exec, -1
  s_waitcnt lgkmcnt(0)
  v_readfirstlane_b32 s4, v11
  s_cmp_lg_u32 s4, 3
  s_cbranch_scc1 Lf_94
  s_lshl_b32 s6, s2, 7
  s_add_u32 s6, s6, 0xd7e000
  v_mov_b32 v10, 0
  v_mov_b32 v11, s1
  s_mov_b64 exec, 1
  buffer_store_dword v11, v10, s[48:51], s6 offen sc1
  s_mov_b64 exec, -1
Lf_94:
  s_cmp_eq_u32 s3, 1
  s_cbranch_scc1 Ls1_96
  s_cmp_lg_u32 s3, 0
  s_cbranch_scc1 Ls0_95
  v_lshlrev_b32 v12, 7, v1
  s_mov_b32 s6, 0xd80000
Lgp_97:
  s_sub_u32 s0, s0, 1
  s_cbranch_scc1 Lexit_2
  buffer_load_dword v16, v12, s[48:51], s6 offen offset:0 sc1
  s_waitcnt vmcnt(0)
  v_xor_b32 v13, s1, v16
  v_cmp_ne_u32 s[4:5], 0, v13
  s_cmp_eq_u64 s[4:5], 0
  s_cbranch_scc1 Lgd_98
  s_sleep 3
  s_branch Lgp_97
Lgd_98:
  v_mov_b32 v12, 0
  v_mov_b32 v13, 1
  ds_write_b32 v12, v13 offset:84
Lpoll_100:
  s_sub_u32 s0, s0, 1
  s_cbranch_scc1 Lexit_2
  ds_read_b32 v12, v8 offset:64
  s_waitcnt lgkmcnt(0)
  v_readfirstlane_b32 s10, v12
  s_cmp_lg_u32 s10, 0
  s_cbranch_scc1 Lok_99
  s_sleep 4
  s_branch Lpoll_100
Lok_99:
  v_lshlrev_b32 v12, 7, v1
  s_mov_b32 s6, 0xd84000
Lgp_101:
  s_sub_u32 s0, s0, 1
  s_cbranch_scc1 Lexit_2
  buffer_load_dword v16, v12, s[48:51], s6 offen offset:0 sc1
  s_waitcnt vmcnt(0)
  v_xor_b32 v13, s1, v16
  v_cmp_ne_u32 s[4:5], 0, v13
  s_cmp_eq_u64 s[4:5], 0
  s_cbranch_scc1 Lgd_102
  s_sleep 3
  s_branch Lgp_101
Lgd_102:
  v_mov_b32 v12, 0
  v_mov_b32 v13, 1
  ds_write_b32 v12, v13 offset:116
  v_mov_b32 v36, 0
  v_mov_b32 v27, 0x7ffffff0
  s_mov_b32 s12, s16
  s_mov_b32 s13, s17
  s_mov_b32 s14, 0x280000
  s_mov_b32 s15, 0x20000
  s_branch Lload_g2
Ls1_96:
  v_lshlrev_b32 v12, 2, v1
  v_mov_b32 v13, 1
  s_mov_b64 exec, 15
  ds_write_b32 v12, v13 offset:32
  s_mov_b64 exec, -1
Ls0_95:
Lpoll_104:
  s_sub_u32 s0, s0, 1
  s_cbranch_scc1 Lexit_2
  ds_read_b32 v12, v8 offset:64
  s_waitcnt lgkmcnt(0)
  v_readfirstlane_b32 s10, v12
  s_cmp_lg_u32 s10, 0
  s_cbranch_scc1 Lok_103
  s_sleep 4
  s_branch Lpoll_104
Lok_103:
Ls_join:
  s_and_b32 s4, s62, 7
  s_mul_i32 s4, s4, 3
  s_lshr_b32 s4, s4, 1
  s_mul_i32 s53, s63, 48
  s_mul_i32 s5, s3, 12
  s_add_u32 s53, s53, s5
  s_mul_i32 s53, s53, 5120
  s_add_u32 s53, s53, 0x1000000
  s_mul_i32 s5, s4, 5120
  s_add_u32 s52, s53, s5
  s_add_u32 s53, s53, 61440
  s_mul_i32 s55, s62, 196608
  s_mul_i32 s5, s3, 24576
  s_add_u32 s55, s55, s5
  s_add_u32 s55, s55, 0x500000
  s_add_u32 s56, s55, 24576
  s_lshl_b32 s5, s4, 11
  s_add_u32 s54, s55, s5
  v_lshlrev_b32 v7, 4, v1
  v_add_u32 v22, 4096, v7
Lpoll_106:
  s_sub_u32 s0, s0, 1
  s_cbranch_scc1 Lexit_2
  ds_read_b32 v10, v4 offset:116
  s_waitcnt lgkmcnt(0)
  v_readfirstlane_b32 s10, v10
  s_cmp_lg_u32 s10, 0
  s_cbranch_scc1 Lok_105
  s_sleep 4
  s_branch Lpoll_106
Lok_105:
  buffer_load_dwordx4 v[128:131], v7, s[48:51], s52 offen offset:0 sc1
  buffer_load_dwordx4 v[132:135], v7, s[48:51], s52 offen offset:1024 sc1
  buffer_load_dwordx4 v[136:139], v7, s[48:51], s52 offen offset:2048 sc1
  buffer_load_dwordx4 v[140:143], v7, s[48:51], s52 offen offset:3072 sc1
  buffer_load_dwordx4 v[24:27], v22, s[48:51], s52 offen sc1
  s_add_u32 s52, s52, 5120
  s_cmp_ge_u32 s52, s53
  s_cselect_b32 s5, 61440, 0
  s_sub_u32 s52, s52, s5
  buffer_load_dwordx4 v[28:31], v7, s[48:51], s52 offen offset:0 sc1
  buffer_load_dwordx4 v[32:35], v7, s[48:51], s52 offen offset:1024 sc1
  buffer_load_dwordx4 v[36:39], v7, s[48:51], s52 offen offset:2048 sc1
  buffer_load_dwordx4 v[144:147], v7, s[48:51], s52 offen offset:3072 sc1
  buffer_load_dwordx4 v[148:151], v22, s[48:51], s52 offen sc1
  s_add_u32 s52, s52, 5120
  s_cmp_ge_u32 s52, s53
  s_cselect_b32 s5, 61440, 0
  s_sub_u32 s52, s52, s5
  buffer_load_dwordx4 v[152:155], v7, s[48:51], s52 offen offset:0 sc1
  buffer_load_dwordx4 v[156:159], v7, s[48:51], s52 offen offset:1024 sc1
  buffer_load_dwordx4 v[40:43], v7, s[48:51], s52 offen offset:2048 sc1
  buffer_load_dwordx4 v[44:47], v7, s[48:51], s52 offen offset:3072 sc1
  buffer_load_dwordx4 v[48:51], v22, s[48:51], s52 offen sc1
  s_add_u32 s52, s52, 5120
  s_cmp_ge_u32 s52, s53
  s_cselect_b32 s5, 61440, 0
  s_sub_u32 s52, s52, s5
  buffer_load_dwordx4 v[52:55], v7, s[48:51], s52 offen offset:0 sc1
  buffer_load_dwordx4 v[160:163], v7, s[48:51], s52 offen offset:1024 sc1
  buffer_load_dwordx4 v[164:167], v7, s[48:51], s52 offen offset:2048 sc1
  buffer_load_dwordx4 v[168:171], v7, s[48:51], s52 offen offset:3072 sc1
  buffer_load_dwordx4 v[172:175], v22, s[48:51], s52 offen sc1
  s_add_u32 s52, s52, 30720
  s_cmp_ge_u32 s52, s53
  s_cselect_b32 s5, 61440, 0
  s_sub_u32 s52, s52, s5
  s_branch Lg2_8
Ljob_9:
  s_and_b32 s68, s2, 7
  s_mul_i32 s68, s68, 80
  s_lshr_b32 s4, s2, 3
  s_lshl_b32 s4, s4, 1
  s_add_u32 s68, s68, s4
  s_add_u32 s67, s68, 1
  s_mov_b32 s66, 147008
  v_mov_b32 v40, 0
  v_mov_b32 v41, 0
  v_mov_b32 v42, 0
  v_mov_b32 v43, 0
  v_mov_b32 v44, 0
  v_mov_b32 v45, 0
  v_mov_b32 v46, 0
  s_mul_i32 s4, s68, 384
  v_lshlrev_b32 v60, 1, v1
  v_add_u32 v60, s4, v60
  s_lshl_b32 s4, s68, 1
  v_mov_b32 v61, s4
  v_mov_b32 v48, 0
  v_mov_b32 v49, 0
  v_mov_b32 v50, 0
  v_mov_b32 v51, 0
  v_mov_b32 v52, 0
  v_mov_b32 v53, 0
  v_mov_b32 v54, 0
  s_mul_i32 s4, s67, 384
  v_lshlrev_b32 v58, 1, v1
  v_add_u32 v58, s4, v58
  s_lshl_b32 s4, s67, 1
  v_mov_b32 v59, s4
  s_setprio 2
  s_waitcnt lgkmcnt(0)
  global_load_short_d16_hi v46, v61, s[30:31]
  global_load_short_d16_hi v40, v60, s[18:19] offset:256
  global_load_short_d16_hi v41, v60, s[20:21] offset:256
  global_load_short_d16_hi v42, v60, s[22:23] offset:256
  global_load_short_d16_hi v43, v60, s[24:25] offset:256
  global_load_short_d16_hi v44, v60, s[26:27] offset:256
  global_load_short_d16_hi v45, v60, s[28:29] offset:256
  global_load_short_d16_hi v54, v59, s[30:31]
  global_load_short_d16_hi v48, v58, s[18:19] offset:256
  global_load_short_d16_hi v49, v58, s[20:21] offset:256
  global_load_short_d16_hi v50, v58, s[22:23] offset:256
  global_load_short_d16_hi v51, v58, s[24:25] offset:256
  global_load_short_d16_hi v52, v58, s[26:27] offset:256
  global_load_short_d16_hi v53, v58, s[28:29] offset:256
  v_bfe_u32 v82, v1, 1, 2
  v_lshlrev_b32 v82, 4, v82
  v_lshl_add_u32 v82, v1, 6, v82
  v_xor_b32 v212, 0, v82
  v_add_u32 v212, s66, v212
  v_xor_b32 v213, 16, v82
  v_add_u32 v213, s66, v213
  v_xor_b32 v214, 32, v82
  v_add_u32 v214, s66, v214
  v_xor_b32 v215, 48, v82
  v_add_u32 v215, s66, v215
  v_bfe_u32 v82, v1, 2, 2
  v_lshrrev_b32 v83, 5, v1
  v_lshl_add_u32 v82, v83, 3, v82
  v_lshlrev_b32 v70, 6, v82
  v_bfe_u32 v82, v1, 4, 1
  v_bfe_u32 v83, v1, 1, 1
  v_lshl_add_u32 v82, v82, 1, v83
  v_bfe_u32 v83, v1, 3, 1
  v_xor_b32 v82, v82, v83
  v_lshl_add_u32 v70, v82, 4, v70
  v_and_b32 v82, 1, v1
  v_lshl_add_u32 v70, v82, 3, v70
  v_xor_b32 v71, 32, v70
  v_add_u32 v70, s66, v70
  v_add_u32 v71, s66, v71
  v_mov_b32 v72, 1.0
  v_mov_b32 v73, 0
  s_barrier
  s_mov_b32 s0, 0x40000
  s_mov_b32 s48, s46
  s_mov_b32 s49, s47
  s_mov_b32 s50, 0x1200000
  s_mov_b32 s51, 0x20000
  s_waitcnt vmcnt(7)
  s_setprio 0
  v_mov_b32 v4, 0
  global_load_dword v4, v4, s[44:45] sc1
  v_mul_f32 v68, 0x3fb8aa3b, v46
  v_exp_f32 v68, v68
  v_mov_b32 v62, v40
  v_mov_b32 v63, v41
  v_mov_b32 v64, v42
  v_mov_b32 v65, v43
  v_mov_b32 v66, v44
  v_mov_b32 v67, v45
  v_cvt_pk_bf16_f32 v68, v68, v68
  v_and_b32 v68, 0xffff0000, v68
  v_mov_b32 v196, 0
  v_mov_b32 v197, 0
  v_mov_b32 v198, 0
  v_mov_b32 v199, 0
  v_mov_b32 v200, 0
  v_mov_b32 v201, 0
  v_mov_b32 v202, 0
  v_mov_b32 v203, 0
  v_mov_b32 v204, 0
  v_mov_b32 v205, 0
  v_mov_b32 v206, 0
  v_mov_b32 v207, 0
  v_mov_b32 v208, 0
  v_mov_b32 v209, 0
  v_mov_b32 v210, 0
  v_mov_b32 v211, 0
  s_call_b64 s[34:35], Lkgen
  s_branch Lnc_108
Lnp_107:
  s_sub_u32 s0, s0, 1
  s_cbranch_scc1 Lexit_2
  v_mov_b32 v4, 0
  global_load_dword v4, v4, s[44:45] sc1
Lnc_108:
  s_waitcnt vmcnt(0)
  v_readfirstlane_b32 s1, v4
  s_cmp_lg_u32 s1, 0
  s_cbranch_scc0 Lnp_107
  v_mov_b32 v5, 0
  ds_write_b32 v5, v4 offset:4
  s_nop 7
  v_mov_b32 v220, v196
  v_mov_b32 v221, v197
  v_mov_b32 v222, v198
  v_mov_b32 v223, v199
  v_mov_b32 v224, v200
  v_mov_b32 v225, v201
  v_mov_b32 v226, v202
  v_mov_b32 v227, v203
  v_mov_b32 v228, v204
  v_mov_b32 v229, v205
  v_mov_b32 v230, v206
  v_mov_b32 v231, v207
  v_mul_f32 v68, 0x3fb8aa3b, v54
  v_exp_f32 v68, v68
  v_mov_b32 v62, v48
  v_mov_b32 v63, v49
  v_mov_b32 v64, v50
  v_mov_b32 v65, v51
  v_mov_b32 v66, v52
  v_mov_b32 v67, v53
  v_cvt_pk_bf16_f32 v68, v68, v68
  v_and_b32 v68, 0xffff0000, v68
  v_mov_b32 v196, 0
  v_mov_b32 v197, 0
  v_mov_b32 v198, 0
  v_mov_b32 v199, 0
  v_mov_b32 v200, 0
  v_mov_b32 v201, 0
  v_mov_b32 v202, 0
  v_mov_b32 v203, 0
  v_mov_b32 v204, 0
  v_mov_b32 v205, 0
  v_mov_b32 v206, 0
  v_mov_b32 v207, 0
  v_mov_b32 v208, 0
  v_mov_b32 v209, 0
  v_mov_b32 v210, 0
  v_mov_b32 v211, 0
  s_call_b64 s[34:35], Lkgen
  s_mov_b32 s7, 150080
  s_mov_b32 s8, 0
  v_lshlrev_b32 v10, 4, v1
  v_add_u32 v10, s7, v10
  ds_write_b128 v10, v[220:223] offset:0
  ds_write_b128 v10, v[224:227] offset:1024
  ds_write_b128 v10, v[228:231] offset:2048
  s_lshl_b32 s4, s8, 2
  v_mov_b32 v10, s4
  v_mov_b32 v11, 1
  ds_write_b32 v10, v11 offset:16
  s_mov_b32 s7, 147008
  s_mov_b32 s8, 1
  v_lshlrev_b32 v10, 4, v1
  v_add_u32 v10, s7, v10
  s_nop 15
  ds_write_b128 v10, v[196:199] offset:0
  ds_write_b128 v10, v[200:203] offset:1024
  ds_write_b128 v10, v[204:207] offset:2048
  s_lshl_b32 s4, s8, 2
  v_mov_b32 v10, s4
  v_mov_b32 v11, 1
  ds_write_b32 v10, v11 offset:16
  s_waitcnt lgkmcnt(0)
  s_and_b32 s4, s2, 7
  s_lshr_b32 s5, s2, 3
  s_and_b32 s60, s4, 1
  s_lshl_b32 s60, s60, 3
  s_and_b32 s6, s5, 7
  s_add_u32 s60, s60, s6
  s_lshr_b32 s61, s4, 1
  s_mul_i32 s61, s61, 3
  s_lshr_b32 s6, s5, 3
  s_add_u32 s61, s61, s6
  s_lshr_b32 s5, s2, 3
  s_and_b32 s62, s2, 1
  s_lshl_b32 s62, s62, 4
  s_bfe_u32 s4, s2, 0x10001
  s_lshl_b32 s4, s4, 3
  s_add_u32 s62, s62, s4
  s_and_b32 s6, s5, 7
  s_add_u32 s62, s62, s6
  s_and_b32 s63, s2, 4
  s_lshr_b32 s6, s5, 3
  s_add_u32 s63, s63, s6
  v_mov_b32 v16, 0
Lpw_109:
  s_sub_u32 s0, s0, 1
  s_cbranch_scc1 Lexit_2
  ds_read_b128 v[12:15], v16 offset:1872
  s_waitcnt lgkmcnt(0)
  v_or_b32 v12, v12, v13
  v_or3_b32 v12, v12, v14, v15
  s_nop 0
  v_readfirstlane_b32 s10, v12
  s_cmp_eq_u32 s10, 0
  s_cbranch_scc1 Lpo_110
  s_sleep 8
  s_branch Lpw_109
Lpo_110:
  v_lshlrev_b32 v2, 7, v1
  s_mov_b32 s6, 0xd84000
Lgp_111:
  s_sub_u32 s0, s0, 1
  s_cbranch_scc1 Lexit_2
  buffer_load_dword v6, v2, s[48:51], s6 offen offset:0 sc1
  s_waitcnt vmcnt(0)
  v_xor_b32 v3, s1, v6
  v_cmp_ne_u32 s[4:5], 0, v3
  s_cmp_eq_u64 s[4:5], 0
  s_cbranch_scc1 Lgd_112
  s_sleep 12
  s_branch Lgp_111
Lgd_112:
  v_mov_b32 v2, 0
  v_mov_b32 v3, 1
  ds_write_b32 v2, v3 offset:84
  ds_write_b32 v2, v3 offset:116
  s_sub_u32 s12, s3, 6
  s_add_u32 s4, s12, 1
  s_mul_i32 s4, s4, 21248
  s_sub_u32 s69, 163840, s4
  s_lshl_b32 s4, s12, 2
  v_mov_b32 v12, s4
  v_and_b32 v50, 15, v1
  v_lshrrev_b32 v51, 4, v1
  v_add_u32 v46, 1, v50
  v_and_b32 v47, 3, v46
  v_mul_u32_u24 v48, 4160, v47
  v_lshrrev_b32 v46, 2, v46
  v_lshlrev_b32 v46, 3, v46
  v_sub_u32 v48, v48, v46
  v_lshl_add_u32 v48, v51, 4, v48
  s_sub_u32 s5, s69, 256
  s_add_u32 s4, s5, 288
  v_add_u32 v48, s4, v48
  v_lshlrev_b32 v49, 5, v50
  v_lshl_add_u32 v49, v51, 4, v49
  v_add_u32 v49, s5, v49
  v_mov_b32 v192, 0
  v_mov_b32 v193, 0
  v_mov_b32 v194, 0
  v_mov_b32 v195, 0
  v_mov_b32 v196, 0
  v_mov_b32 v197, 0
  v_mov_b32 v198, 0
  v_mov_b32 v199, 0
  v_mov_b32 v200, 0
  v_mov_b32 v201, 0
  v_mov_b32 v202, 0
  v_mov_b32 v203, 0
  v_mov_b32 v204, 0
  v_mov_b32 v205, 0
  v_mov_b32 v206, 0
  v_mov_b32 v207, 0
  v_mov_b32 v208, 0
  v_mov_b32 v209, 0
  v_mov_b32 v210, 0
  v_mov_b32 v211, 0
  v_mov_b32 v212, 0
  v_mov_b32 v213, 0
  v_mov_b32 v214, 0
  v_mov_b32 v215, 0
  v_mov_b32 v216, 0
  v_mov_b32 v217, 0
  v_mov_b32 v218, 0
  v_mov_b32 v219, 0
  v_mov_b32 v220, 0
  v_mov_b32 v221, 0
  v_mov_b32 v222, 0
  v_mov_b32 v223, 0
  s_mov_b32 s14, 1
  s_call_b64 s[34:35], Lconv
Lpoll_114:
  s_sub_u32 s0, s0, 1
  s_cbranch_scc1 Lexit_2
  ds_read_b32 v13, v12 offset:88
  s_waitcnt lgkmcnt(0)
  v_readfirstlane_b32 s10, v13
  s_cmp_lg_u32 s10, 0
  s_cbranch_scc1 Lok_113
  s_sleep 0
  s_branch Lpoll_114
Lok_113:
  v_lshlrev_b32 v5, 4, v1
  v_add_u32 v5, s69, v5
  s_nop 4
  ds_write_b128 v5, v[192:195] offset:0
  ds_write_b128 v5, v[196:199] offset:1024
  ds_write_b128 v5, v[200:203] offset:2048
  ds_write_b128 v5, v[204:207] offset:3072
  ds_write_b128 v5, v[208:211] offset:4096
  ds_write_b128 v5, v[212:215] offset:5120
  ds_write_b128 v5, v[216:219] offset:6144
  ds_write_b128 v5, v[220:223] offset:7168
  v_mov_b32 v13, 1
  ds_write_b32 v12, v13 offset:104
  s_waitcnt lgkmcnt(0)
  s_branch Lfetch_10
Lch_5:
  s_sub_u32 s12, s3, 4
  s_lshr_b32 s5, s2, 3
  s_lshl_b32 s6, s5, 1
  s_lshl_b32 s7, s5, 2
  s_sub_u32 s7, s7, 48
  s_cmp_lt_u32 s5, 24
  s_cselect_b32 s6, s6, s7
  s_cselect_b32 s15, 1, 0
  s_and_b32 s68, s2, 7
  s_mul_i32 s68, s68, 80
  s_add_u32 s68, s68, s6
  s_add_u32 s68, s68, s12
  s_add_u32 s4, s12, 1
  s_mul_i32 s4, s4, 21248
  s_sub_u32 s69, 163840, s4
  s_cmp_eq_u32 s12, 0
  s_cselect_b32 s66, 155648, s69
  s_cmp_lg_u32 s3, 7
  s_cbranch_scc1 L7_116
  v_lshlrev_b32 v2, 2, v1
  v_mov_b32 v3, 1
  ds_write_b32 v2, v3 offset:1408
  ds_write_b32 v2, v3 offset:1664
  ds_write_b32 v2, v3 offset:1792
L7_116:
  v_mov_b32 v40, 0
  v_mov_b32 v41, 0
  v_mov_b32 v42, 0
  v_mov_b32 v43, 0
  v_mov_b32 v44, 0
  v_mov_b32 v45, 0
  v_mov_b32 v46, 0
  v_mov_b32 v47, 0
  v_mov_b32 v48, 0
  v_mov_b32 v49, 0
  v_mov_b32 v50, 0
  v_mov_b32 v51, 0
  v_mov_b32 v52, 0
  s_mul_i32 s4, s68, 384
  v_lshlrev_b32 v60, 1, v1
  v_add_u32 v60, s4, v60
  s_lshl_b32 s4, s68, 1
  v_mov_b32 v61, s4
  v_mov_b32 v59, 0
  s_setprio 2
  s_waitcnt lgkmcnt(0)
  s_cmp_lg_u32 s68, 0
  s_cbranch_scc1 Lnn_115
  s_memrealtime s[4:5]
  s_waitcnt lgkmcnt(0)
  s_or_b32 s4, s4, 1
  v_mov_b32 v2, 0
  v_mov_b32 v3, s4
  s_mov_b64 exec, 1
  global_store_dword v2, v3, s[44:45] sc1
  s_mov_b64 exec, -1
Lnn_115:
  global_load_short_d16_hi v52, v61, s[30:31]
  global_load_short_d16_hi v40, v60, s[18:19] offset:0
  global_load_short_d16_hi v41, v60, s[20:21] offset:0
  global_load_short_d16_hi v42, v60, s[22:23] offset:0
  global_load_short_d16_hi v43, v60, s[24:25] offset:0
  global_load_short_d16_hi v44, v60, s[26:27] offset:0
  global_load_short_d16_hi v45, v60, s[28:29] offset:0
  global_load_short_d16_hi v46, v60, s[18:19] offset:128
  global_load_short_d16_hi v47, v60, s[20:21] offset:128
  global_load_short_d16_hi v48, v60, s[22:23] offset:128
  global_load_short_d16_hi v49, v60, s[24:25] offset:128
  global_load_short_d16_hi v50, v60, s[26:27] offset:128
  global_load_short_d16_hi v51, v60, s[28:29] offset:128
  global_load_short_d16_hi v59, v61, s[32:33]
  v_bfe_u32 v82, v1, 1, 2
  v_lshlrev_b32 v82, 4, v82
  v_lshl_add_u32 v82, v1, 6, v82
  v_xor_b32 v212, 0, v82
  v_add_u32 v212, s66, v212
  v_xor_b32 v213, 16, v82
  v_add_u32 v213, s66, v213
  v_xor_b32 v214, 32, v82
  v_add_u32 v214, s66, v214
  v_xor_b32 v215, 48, v82
  v_add_u32 v215, s66, v215
  v_bfe_u32 v82, v1, 2, 2
  v_lshrrev_b32 v83, 5, v1
  v_lshl_add_u32 v82, v83, 3, v82
  v_lshlrev_b32 v70, 6, v82
  v_bfe_u32 v82, v1, 4, 1
  v_bfe_u32 v83, v1, 1, 1
  v_lshl_add_u32 v82, v82, 1, v83
  v_bfe_u32 v83, v1, 3, 1
  v_xor_b32 v82, v82, v83
  v_lshl_add_u32 v70, v82, 4, v70
  v_and_b32 v82, 1, v1
  v_lshl_add_u32 v70, v82, 3, v70
  v_xor_b32 v71, 32, v70
  v_add_u32 v70, s66, v70
  v_add_u32 v71, s66, v71
  v_mov_b32 v72, 1.0
  v_mov_b32 v73, 0
  s_barrier
  s_mov_b32 s0, 0x40000
  s_mov_b32 s48, s46
  s_mov_b32 s49, s47
  s_mov_b32 s50, 0x1200000
  s_mov_b32 s51, 0x20000
  s_waitcnt vmcnt(7)
  s_setprio 0
  v_mul_f32 v68, 0x3fb8aa3b, v52
  v_exp_f32 v68, v68
  v_mov_b32 v62, v40
  v_mov_b32 v63, v41
  v_mov_b32 v64, v42
  v_mov_b32 v65, v43
  v_mov_b32 v66, v44
  v_mov_b32 v67, v45
  v_cvt_pk_bf16_f32 v68, v68, v68
  v_and_b32 v68, 0xffff0000, v68
  v_mov_b32 v196, 0
  v_mov_b32 v197, 0
  v_mov_b32 v198, 0
  v_mov_b32 v199, 0
  v_mov_b32 v200, 0
  v_mov_b32 v201, 0
  v_mov_b32 v202, 0
  v_mov_b32 v203, 0
  v_mov_b32 v204, 0
  v_mov_b32 v205, 0
  v_mov_b32 v206, 0
  v_mov_b32 v207, 0
  v_mov_b32 v208, 0
  v_mov_b32 v209, 0
  v_mov_b32 v210, 0
  v_mov_b32 v211, 0
  s_call_b64 s[34:35], Lkgen
  s_waitcnt vmcnt(0)
  v_mul_f32 v68, 0x3fb8aa3b, v52
  v_exp_f32 v68, v68
  v_mov_b32 v62, v46
  v_mov_b32 v63, v47
  v_mov_b32 v64, v48
  v_mov_b32 v65, v49
  v_mov_b32 v66, v50
  v_mov_b32 v67, v51
  v_cvt_pk_bf16_f32 v68, v68, v68
  v_and_b32 v68, 0xffff0000, v68
  s_call_b64 s[34:35], Lkgen
  s_and_b32 s4, s2, 7
  s_lshr_b32 s5, s2, 3
  s_and_b32 s60, s4, 1
  s_lshl_b32 s60, s60, 3
  s_and_b32 s6, s5, 7
  s_add_u32 s60, s60, s6
  s_lshr_b32 s61, s4, 1
  s_mul_i32 s61, s61, 3
  s_lshr_b32 s6, s5, 3
  s_add_u32 s61, s61, s6
  s_lshr_b32 s5, s2, 3
  s_and_b32 s62, s2, 1
  s_lshl_b32 s62, s62, 4
  s_bfe_u32 s4, s2, 0x10001
  s_lshl_b32 s4, s4, 3
  s_add_u32 s62, s62, s4
  s_and_b32 s6, s5, 7
  s_add_u32 s62, s62, s6
  s_and_b32 s63, s2, 4
  s_lshr_b32 s6, s5, 3
  s_add_u32 s63, s63, s6
  v_mov_b32 v5, 0
Lpoll_118:
  s_sub_u32 s0, s0, 1
  s_cbranch_scc1 Lexit_2
  ds_read_b32 v4, v5 offset:4
  s_waitcnt lgkmcnt(0)
  v_readfirstlane_b32 s1, v4
  s_cmp_lg_u32 s1, 0
  s_cbranch_scc1 Lok_117
  s_sleep 1
  s_branch Lpoll_118
Lok_117:
  s_and_b32 s4, s12, s15
  s_cbranch_scc0 Lj5_119
  v_mov_b32 v16, 0
Lpw_120:
  s_sub_u32 s0, s0, 1
  s_cbranch_scc1 Lexit_2
  ds_read_b128 v[12:15], v16 offset:1824
  s_waitcnt lgkmcnt(0)
  v_or_b32 v12, v12, v13
  v_or3_b32 v12, v12, v14, v15
  s_nop 0
  v_readfirstlane_b32 s10, v12
  s_cmp_eq_u32 s10, 0
  s_cbranch_scc1 Lpo_121
  s_sleep 8
  s_branch Lpw_120
Lpo_121:
  v_lshlrev_b32 v2, 4, v1
  v_lshlrev_b32 v5, 3, v1
  s_mul_i32 s6, s61, 20480
  s_add_u32 s6, s6, 0x10000
  s_add_u32 s7, s6, 4096
  s_add_u32 s8, s6, 8192
  s_add_u32 s9, s6, 12288
  s_add_u32 s10, s6, 16384
Lgp_122:
  s_sub_u32 s0, s0, 1
  s_cbranch_scc1 Lexit_2
  buffer_load_dwordx4 v[96:99], v2, s[48:51], s6 offen offset:0 sc1
  buffer_load_dwordx4 v[100:103], v2, s[48:51], s6 offen offset:2048 sc1
  buffer_load_dwordx4 v[104:107], v2, s[48:51], s7 offen offset:0 sc1
  buffer_load_dwordx4 v[108:111], v2, s[48:51], s7 offen offset:2048 sc1
  buffer_load_dwordx4 v[112:115], v2, s[48:51], s8 offen offset:0 sc1
  buffer_load_dwordx4 v[116:119], v2, s[48:51], s8 offen offset:2048 sc1
  buffer_load_dwordx4 v[120:123], v2, s[48:51], s9 offen offset:0 sc1
  buffer_load_dwordx4 v[124:127], v2, s[48:51], s9 offen offset:2048 sc1
  buffer_load_dwordx4 v[128:131], v2, s[48:51], s10 offen offset:0 sc1
  buffer_load_dwordx4 v[132:135], v2, s[48:51], s10 offen offset:2048 sc1
  buffer_load_dwordx2 v[136:137], v5, s[48:51], s6 offen offset:1024 sc1
  buffer_load_dwordx2 v[138:139], v5, s[48:51], s6 offen offset:3072 sc1
  buffer_load_dwordx2 v[140:141], v5, s[48:51], s7 offen offset:1024 sc1
  buffer_load_dwordx2 v[142:143], v5, s[48:51], s7 offen offset:3072 sc1
  buffer_load_dwordx2 v[144:145], v5, s[48:51], s8 offen offset:1024 sc1
  buffer_load_dwordx2 v[146:147], v5, s[48:51], s8 offen offset:3072 sc1
  buffer_load_dwordx2 v[148:149], v5, s[48:51], s9 offen offset:1024 sc1
  buffer_load_dwordx2 v[150:151], v5, s[48:51], s9 offen offset:3072 sc1
  buffer_load_dwordx2 v[152:153], v5, s[48:51], s10 offen offset:1024 sc1
  buffer_load_dwordx2 v[154:155], v5, s[48:51], s10 offen offset:3072 sc1
  s_waitcnt vmcnt(0)
  v_xor_b32 v3, s1, v99
  v_xor_b32 v4, s1, v103
  v_or_b32 v3, v3, v4
  v_xor_b32 v4, s1, v107
  v_or_b32 v3, v3, v4
  v_xor_b32 v4, s1, v111
  v_or_b32 v3, v3, v4
  v_xor_b32 v4, s1, v115
  v_or_b32 v3, v3, v4
  v_xor_b32 v4, s1, v119
  v_or_b32 v3, v3, v4
  v_xor_b32 v4, s1, v123
  v_or_b32 v3, v3, v4
  v_xor_b32 v4, s1, v127
  v_or_b32 v3, v3, v4
  v_xor_b32 v4, s1, v131
  v_or_b32 v3, v3, v4
  v_xor_b32 v4, s1, v135
  v_or_b32 v3, v3, v4
  v_xor_b32 v4, s1, v137
  v_or_b32 v3, v3, v4
  v_xor_b32 v4, s1, v139
  v_or_b32 v3, v3, v4
  v_xor_b32 v4, s1, v141
  v_or_b32 v3, v3, v4
  v_xor_b32 v4, s1, v143
  v_or_b32 v3, v3, v4
  v_xor_b32 v4, s1, v145
  v_or_b32 v3, v3, v4
  v_xor_b32 v4, s1, v147
  v_or_b32 v3, v3, v4
  v_xor_b32 v4, s1, v149
  v_or_b32 v3, v3, v4
  v_xor_b32 v4, s1, v151
  v_or_b32 v3, v3, v4
  v_xor_b32 v4, s1, v153
  v_or_b32 v3, v3, v4
  v_xor_b32 v4, s1, v155
  v_or_b32 v3, v3, v4
  v_cmp_ne_u32 s[4:5], 0, v3
  s_cmp_eq_u64 s[4:5], 0
  s_cbranch_scc1 Lgd_123
  s_sleep 8
  s_branch Lgp_122
Lgd_123:
  v_mov_b32 v99, v136
  v_add_f32 v96, v96, v100
  v_add_f32 v97, v97, v101
  v_add_f32 v98, v98, v102
  v_add_f32 v99, v99, v138
  v_add_f32 v96, v96, v104
  v_add_f32 v97, v97, v105
  v_add_f32 v98, v98, v106
  v_add_f32 v99, v99, v140
  v_add_f32 v96, v96, v108
  v_add_f32 v97, v97, v109
  v_add_f32 v98, v98, v110
  v_add_f32 v99, v99, v142
  v_add_f32 v96, v96, v112
  v_add_f32 v97, v97, v113
  v_add_f32 v98, v98, v114
  v_add_f32 v99, v99, v144
  v_add_f32 v96, v96, v116
  v_add_f32 v97, v97, v117
  v_add_f32 v98, v98, v118
  v_add_f32 v99, v99, v146
  v_add_f32 v96, v96, v120
  v_add_f32 v97, v97, v121
  v_add_f32 v98, v98, v122
  v_add_f32 v99, v99, v148
  v_add_f32 v96, v96, v124
  v_add_f32 v97, v97, v125
  v_add_f32 v98, v98, v126
  v_add_f32 v99, v99, v150
  v_add_f32 v96, v96, v128
  v_add_f32 v97, v97, v129
  v_add_f32 v98, v98, v130
  v_add_f32 v99, v99, v152
  v_add_f32 v96, v96, v132
  v_add_f32 v97, v97, v133
  v_add_f32 v98, v98, v134
  v_add_f32 v99, v99, v154
  v_lshlrev_b32 v2, 2, v1
  ds_write_b32 v2, v96 offset:128
  ds_write_b32 v2, v97 offset:384
  ds_write_b32 v2, v98 offset:640
  ds_write_b32 v2, v99 offset:896
  v_mov_b32 v2, 0
  v_mov_b32 v3, 1
  ds_write_b32 v2, v3 offset:60
Lj5_119:
  s_lshl_b32 s4, s12, 2
  v_mov_b32 v10, s4
Lpoll_125:
  s_sub_u32 s0, s0, 1
  s_cbranch_scc1 Lexit_2
  ds_read_b32 v11, v10 offset:16
  s_waitcnt lgkmcnt(0)
  v_readfirstlane_b32 s10, v11
  s_cmp_lg_u32 s10, 0
  s_cbranch_scc1 Lok_124
  s_sleep 1
  s_branch Lpoll_125
Lok_124:
  s_mov_b32 s4, 150080
  s_cmp_eq_u32 s12, 0
  s_cselect_b32 s4, s4, 147008
  s_add_u32 s5, s69, 8192
  s_cmp_eq_u32 s15, 0
  s_cselect_b32 s4, s5, s4
  v_lshlrev_b32 v11, 4, v1
  v_add_u32 v11, s4, v11
  ds_read_b128 v[12:15], v11 offset:0
  ds_read_b128 v[16:19], v11 offset:1024
  ds_read_b128 v[20:23], v11 offset:2048
  v_mov_b32 v11, 1
  ds_write_b32 v10, v11 offset:120
  s_waitcnt lgkmcnt(1)
  v_add_f32 v196, v196, v12
  v_add_f32 v197, v197, v13
  v_add_f32 v198, v198, v14
  v_add_f32 v199, v199, v15
  v_add_f32 v200, v200, v16
  v_add_f32 v201, v201, v17
  v_add_f32 v202, v202, v18
  v_add_f32 v203, v203, v19
  v_add_f32 v204, v204, v20
  v_add_f32 v205, v205, v21
  v_add_f32 v206, v206, v22
  v_add_f32 v207, v207, v23
  v_and_b32 v2, 31, v1
  v_lshrrev_b32 v3, 5, v1
  v_lshlrev_b32 v4, 5, v2
  v_lshl_add_u32 v4, v3, 4, v4
  v_add_u32 v4, s66, v4
  v_lshlrev_b32 v5, 4, v2
  v_add_u32 v5, s66, v5
  v_lshlrev_b32 v6, 3, v2
  v_add_u32 v6, s66, v6
  v_lshlrev_b32 v7, 2, v2
  v_add_u32 v7, s66, v7
  s_nop 7
  s_mov_b64 exec, 1
  v_add_f32 v196, v196, v59
  s_mov_b64 exec, -1
  ds_write_b128 v4, v[196:199]
  s_mov_b32 exec_hi, 0
  ds_write_b128 v5, v[200:203] offset:1024
  ds_write_b32 v7, v204 offset:2048
  ds_write_b32 v7, v205 offset:2176
  ds_write_b32 v7, v206 offset:2304
  ds_write_b32 v7, v207 offset:2432
  s_mov_b32 exec_lo, 0
  s_mov_b32 exec_hi, -1
  ds_write_b64 v6, v[200:201] offset:1536
  ds_write_b64 v6, v[202:203] offset:1792
  ds_write_b32 v7, v204 offset:2560
  s_mov_b64 exec, -1
  v_lshlrev_b32 v2, 3, v1
  v_add_u32 v3, s66, v2
  v_lshlrev_b32 v4, 4, v1
  v_add_u32 v4, s66, v4
  ds_read_b128 v[12:15], v4
  ds_read_b32 v10, v4 offset:16
  ds_read_b64 v[16:17], v3 offset:1024
  ds_read_b32 v18, v3 offset:1032
  ds_read_b64 v[20:21], v3 offset:1536
  ds_read_b32 v22, v3 offset:1544
  ds_read_b64 v[24:25], v3 offset:2048
  ds_read_b32 v26, v3 offset:2056
  v_add_u32 v2, s69, v2
  v_lshrrev_b32 v3, 4, v1
  v_mul_u32_u24 v3, 4160, v3
  v_and_b32 v4, 15, v1
  v_lshl_add_u32 v3, v4, 2, v3
  v_add_u32 v3, s69, v3
  v_sub_u32 v5, 63, v1
  v_lshlrev_b32 v6, 5, v5
  v_add_u32 v6, s69, v6
  v_lshlrev_b32 v7, 4, v5
  v_add_u32 v7, s69, v7
  v_lshlrev_b32 v5, 3, v5
  v_add_u32 v5, s69, v5
  v_mov_b32 v8, 0
  v_mov_b32 v9, 0
  s_lshl_b32 s4, s12, 2
  v_mov_b32 v76, s4
  v_mov_b32 v77, 1
  ds_write_b32 v76, v77 offset:48
  s_waitcnt lgkmcnt(1)
  v_cvt_pk_bf16_f32 v96, v26, v26
  v_cvt_pk_bf16_f32 v97, v26, v26
  v_cvt_pk_bf16_f32 v98, v25, v25
  v_cvt_pk_bf16_f32 v99, v25, v25
  v_cvt_pk_bf16_f32 v100, v25, v25
  v_cvt_pk_bf16_f32 v101, v25, v24
  v_cvt_pk_bf16_f32 v102, v24, v24
  v_cvt_pk_bf16_f32 v103, v24, v24
  v_cvt_pk_bf16_f32 v104, v22, v22
  v_cvt_pk_bf16_f32 v105, v21, v21
  v_cvt_pk_bf16_f32 v106, v21, v20
  v_cvt_pk_bf16_f32 v107, v20, v20
  v_cvt_pk_bf16_f32 v108, v26, v26
  v_cvt_pk_bf16_f32 v109, v26, v26
  v_cvt_pk_bf16_f32 v110, v26, v25
  v_cvt_pk_bf16_f32 v111, v25, v25
  v_cvt_pk_bf16_f32 v112, v25, v25
  v_cvt_pk_bf16_f32 v113, v25, v25
  v_cvt_pk_bf16_f32 v114, v24, v24
  v_cvt_pk_bf16_f32 v115, v24, v24
  v_cvt_pk_bf16_f32 v116, v22, v22
  v_cvt_pk_bf16_f32 v117, v22, v21
  v_cvt_pk_bf16_f32 v118, v21, v21
  v_cvt_pk_bf16_f32 v119, v20, v20
  v_cvt_pk_bf16_f32 v120, v26, v26
  v_cvt_pk_bf16_f32 v121, v26, v26
  v_cvt_pk_bf16_f32 v122, v26, v26
  v_cvt_pk_bf16_f32 v123, v25, v25
  v_cvt_pk_bf16_f32 v124, v25, v25
  v_cvt_pk_bf16_f32 v125, v25, v25
  v_cvt_pk_bf16_f32 v126, v25, v24
  v_cvt_pk_bf16_f32 v127, v24, v24
  v_cvt_pk_bf16_f32 v128, v22, v22
  v_cvt_pk_bf16_f32 v129, v22, v22
  v_cvt_pk_bf16_f32 v130, v21, v21
  v_cvt_pk_bf16_f32 v131, v21, v20
  v_cvt_pk_bf16_f32 v132, v26, v26
  v_cvt_pk_bf16_f32 v133, v26, v26
  v_cvt_pk_bf16_f32 v134, v26, v26
  v_cvt_pk_bf16_f32 v135, v26, v25
  v_cvt_pk_bf16_f32 v136, v25, v25
  v_cvt_pk_bf16_f32 v137, v25, v25
  v_cvt_pk_bf16_f32 v138, v25, v25
  v_cvt_pk_bf16_f32 v139, v24, v24
  v_cvt_pk_bf16_f32 v140, v22, v22
  v_cvt_pk_bf16_f32 v141, v22, v22
  v_cvt_pk_bf16_f32 v142, v22, v21
  v_cvt_pk_bf16_f32 v143, v21, v21
  v_cvt_pk_bf16_f32 v52, v20, v20
  v_cvt_pk_bf16_f32 v64, v18, v17
  v_cvt_pk_bf16_f32 v65, v16, v16
  v_cvt_pk_bf16_f32 v66, v18, v18
  v_cvt_pk_bf16_f32 v67, v17, v16
  v_cvt_pk_bf16_f32 v68, v15, v14
  v_cvt_pk_bf16_f32 v69, v13, v12
  v_cvt_pk_bf16_f32 v70, v10, v15
  v_cvt_pk_bf16_f32 v71, v14, v13
  v_cvt_pk_bf16_f32 v72, v12, 0
  v_add_u32 v73, 11392, v5
  v_add_u32 v74, 15552, v5
  v_and_b32 v50, 15, v1
  v_lshrrev_b32 v51, 4, v1
  v_add_u32 v46, 1, v50
  v_and_b32 v47, 3, v46
  v_mul_u32_u24 v48, 4160, v47
  v_lshrrev_b32 v46, 2, v46
  v_lshlrev_b32 v46, 3, v46
  v_sub_u32 v48, v48, v46
  v_lshl_add_u32 v48, v51, 4, v48
  s_sub_u32 s5, s69, 0
  s_add_u32 s4, s5, 288
  v_add_u32 v48, s4, v48
  v_lshlrev_b32 v49, 5, v50
  v_lshl_add_u32 v49, v51, 4, v49
  v_add_u32 v49, s5, v49
  v_mov_b32 v192, 0
  v_mov_b32 v193, 0
  v_mov_b32 v194, 0
  v_mov_b32 v195, 0
  v_mov_b32 v196, 0
  v_mov_b32 v197, 0
  v_mov_b32 v198, 0
  v_mov_b32 v199, 0
  v_mov_b32 v200, 0
  v_mov_b32 v201, 0
  v_mov_b32 v202, 0
  v_mov_b32 v203, 0
  v_mov_b32 v204, 0
  v_mov_b32 v205, 0
  v_mov_b32 v206, 0
  v_mov_b32 v207, 0
  v_mov_b32 v208, 0
  v_mov_b32 v209, 0
  v_mov_b32 v210, 0
  v_mov_b32 v211, 0
  v_mov_b32 v212, 0
  v_mov_b32 v213, 0
  v_mov_b32 v214, 0
  v_mov_b32 v215, 0
  v_mov_b32 v216, 0
  v_mov_b32 v217, 0
  v_mov_b32 v218, 0
  v_mov_b32 v219, 0
  v_mov_b32 v220, 0
  v_mov_b32 v221, 0
  v_mov_b32 v222, 0
  v_mov_b32 v223, 0
  s_cmp_eq_u32 s15, 0
  s_cbranch_scc1 Lxg_126
  v_mov_b32 v80, 0
Lpw_127:
  s_sub_u32 s0, s0, 1
  s_cbranch_scc1 Lexit_2
  ds_read_b128 v[76:79], v80 offset:1920
  s_waitcnt lgkmcnt(0)
  v_or_b32 v76, v76, v77
  v_or3_b32 v76, v76, v78, v79
  s_nop 0
  v_readfirstlane_b32 s10, v76
  s_cmp_eq_u32 s10, 0
  s_cbranch_scc1 Lpo_128
  s_sleep 4
  s_branch Lpw_127
Lpo_128:
  v_mov_b32 v80, 0
Lpoll_130:
  s_sub_u32 s0, s0, 1
  s_cbranch_scc1 Lexit_2
  ds_read_b32 v76, v80 offset:84
  s_waitcnt lgkmcnt(0)
  v_readfirstlane_b32 s10, v76
  s_cmp_lg_u32 s10, 0
  s_cbranch_scc1 Lok_129
  s_sleep 2
  s_branch Lpoll_130
Lok_129:
  v_lshrrev_b32 v81, 1, v1
  v_mul_u32_u24 v81, 10240, v81
  v_and_b32 v82, 1, v1
  v_lshl_add_u32 v81, v82, 4, v81
  s_and_b32 s4, s68, -2
  s_lshl_b32 s4, s4, 4
  s_and_b32 s5, s12, 1
  s_mul_i32 s5, s5, 1310720
  s_add_u32 s4, s4, s5
  s_add_u32 s4, s4, 0x280000
  buffer_load_dwordx4 v[232:235], v81, s[48:51], s4 offen sc1
  s_add_u32 s4, s4, 327680
  buffer_load_dwordx4 v[236:239], v81, s[48:51], s4 offen sc1
  s_add_u32 s4, s4, 327680
  buffer_load_dwordx4 v[240:243], v81, s[48:51], s4 offen sc1
  s_add_u32 s4, s4, 327680
  buffer_load_dwordx4 v[244:247], v81, s[48:51], s4 offen sc1
Lpoll_132:
  s_sub_u32 s0, s0, 1
  s_cbranch_scc1 Lexit_2
  ds_read_b32 v76, v80 offset:124
  s_waitcnt lgkmcnt(0)
  v_readfirstlane_b32 s10, v76
  s_cmp_lg_u32 s10, 0
  s_cbranch_scc1 Lok_131
  s_sleep 2
  s_branch Lpoll_132
Lok_131:
  v_mov_b32 v80, 0
Lpw_133:
  s_sub_u32 s0, s0, 1
  s_cbranch_scc1 Lexit_2
  ds_read_b128 v[76:79], v80 offset:2000
  s_waitcnt lgkmcnt(0)
  v_or_b32 v76, v76, v77
  v_or3_b32 v76, v76, v78, v79
  s_nop 0
  v_readfirstlane_b32 s10, v76
  s_cmp_eq_u32 s10, 0
  s_cbranch_scc1 Lpo_134
  s_sleep 2
  s_branch Lpw_133
Lpo_134:
Lxg_126:
  ds_write_b64 v2, v[8:9] offset:16640
  ds_write_b32 v3, v8 offset:4096
  ds_write_b128 v6, v[96:99] offset:0
  ds_write_b128 v6, v[100:103] offset:16
  ds_write_b128 v7, v[104:107] offset:2048
  ds_write_b128 v6, v[108:111] offset:4160
  ds_write_b128 v6, v[112:115] offset:4176
  ds_write_b128 v7, v[116:119] offset:6208
  ds_write_b128 v6, v[120:123] offset:8320
  ds_write_b128 v6, v[124:127] offset:8336
  ds_write_b128 v7, v[128:131] offset:10368
  ds_write_b128 v6, v[132:135] offset:12480
  ds_write_b128 v6, v[136:139] offset:12496
  ds_write_b128 v7, v[140:143] offset:14528
  ds_write_b32 v7, v52 offset:10384
  ds_write_b32 v7, v52 offset:14544
  ds_write_b64 v5, v[64:65] offset:3072
  ds_write_b64 v5, v[68:69] offset:3584
  ds_write_b64 v5, v[66:67] offset:7232
  ds_write_b64 v5, v[70:71] offset:7744
  ds_write2_b32 v73, v64, v65 offset0:1 offset1:2
  ds_write2_b32 v73, v68, v69 offset0:129 offset1:130
  ds_write2_b32 v74, v66, v67 offset0:1 offset1:2
  ds_write2_b32 v74, v70, v71 offset0:129 offset1:130
  s_mov_b64 exec, 1
  ds_write_b32 v5, v72 offset:7752
  ds_write_b32 v5, v72 offset:16076
  s_mov_b64 exec, -1
  s_cmp_lg_u32 s15, 0
  s_cbranch_scc1 Lsu_137
  v_mov_b32 v80, 0
Lpoll_139:
  s_sub_u32 s0, s0, 1
  s_cbranch_scc1 Lexit_2
  ds_read_b32 v76, v80 offset:84
  s_waitcnt lgkmcnt(0)
  v_readfirstlane_b32 s10, v76
  s_cmp_lg_u32 s10, 0
  s_cbranch_scc1 Lok_138
  s_sleep 2
  s_branch Lpoll_139
Lok_138:
  v_lshrrev_b32 v81, 1, v1
  v_mul_u32_u24 v81, 10240, v81
  v_and_b32 v82, 1, v1
  v_lshl_add_u32 v81, v82, 4, v81
  s_and_b32 s4, s68, -2
  s_lshl_b32 s4, s4, 4
  s_and_b32 s5, s12, 1
  s_mul_i32 s5, s5, 1310720
  s_add_u32 s4, s4, s5
  s_add_u32 s4, s4, 0x280000
  buffer_load_dwordx4 v[232:235], v81, s[48:51], s4 offen sc1
  s_add_u32 s4, s4, 327680
  buffer_load_dwordx4 v[236:239], v81, s[48:51], s4 offen sc1
  s_add_u32 s4, s4, 327680
  buffer_load_dwordx4 v[240:243], v81, s[48:51], s4 offen sc1
  s_add_u32 s4, s4, 327680
  buffer_load_dwordx4 v[244:247], v81, s[48:51], s4 offen sc1
Lsu_137:
  s_xor_b32 s4, s12, 1
  s_lshl_b32 s4, s4, 2
  v_mov_b32 v5, s4
Lpoll_141:
  s_sub_u32 s0, s0, 1
  s_cbranch_scc1 Lexit_2
  ds_read_b32 v6, v5 offset:48
  s_waitcnt lgkmcnt(0)
  v_readfirstlane_b32 s10, v6
  s_cmp_lg_u32 s10, 0
  s_cbranch_scc1 Lok_140
  s_sleep 1
  s_branch Lpoll_141
Lok_140:
  s_and_b32 s5, s12, 1
  s_mul_i32 s4, s5, 23296
  s_add_u32 s4, s4, s69
  v_lshrrev_b32 v5, 1, v1
  v_lshlrev_b32 v5, 4, v5
  v_and_b32 v6, 1, v1
  v_mul_u32_u24 v6, 21248, v6
  v_sub_u32 v5, v5, v6
  v_add_u32 v5, s4, v5
  s_waitcnt vmcnt(3)
  ds_write_b128 v5, v[232:235] offset:17152
  s_waitcnt vmcnt(2)
  ds_write_b128 v5, v[236:239] offset:17664
  s_waitcnt vmcnt(1)
  ds_write_b128 v5, v[240:243] offset:18176
  s_waitcnt vmcnt(0)
  ds_write_b128 v5, v[244:247] offset:18688
  s_lshl_b32 s4, s12, 2
  v_mov_b32 v12, s4
  v_mov_b32 v13, 1
  ds_write_b32 v12, v13 offset:64
  s_sub_u32 s14, 2, s15
  s_call_b64 s[34:35], Lconv
  v_mov_b32 v14, 0
  s_cmp_lt_u32 s3, 6
  s_cbranch_scc1 Lsk_136
  ds_write_b32 v12, v14 offset:1984
  ds_write_b32 v12, v14 offset:2000
Lsk_136:
  s_cmp_eq_u32 s15, 0
  s_cbranch_scc1 Lsolo_135
  ds_write_b32 v12, v13 offset:88
  v_lshlrev_b32 v5, 4, v1
  v_add_u32 v5, s69, v5
Lpoll_143:
  s_sub_u32 s0, s0, 1
  s_cbranch_scc1 Lexit_2
  ds_read_b32 v14, v12 offset:104
  s_waitcnt lgkmcnt(0)
  v_readfirstlane_b32 s10, v14
  s_cmp_lg_u32 s10, 0
  s_cbranch_scc1 Lok_142
  s_sleep 0
  s_branch Lpoll_143
Lok_142:
  ds_read_b128 v[64:67], v5 offset:0
  ds_read_b128 v[68:71], v5 offset:1024
  ds_read_b128 v[72:75], v5 offset:2048
  ds_read_b128 v[76:79], v5 offset:3072
  ds_read_b128 v[80:83], v5 offset:4096
  ds_read_b128 v[84:87], v5 offset:5120
  ds_read_b128 v[88:91], v5 offset:6144
  ds_read_b128 v[92:95], v5 offset:7168
  s_waitcnt lgkmcnt(7)
  v_add_f32 v192, v192, v64
  v_add_f32 v193, v193, v65
  v_add_f32 v194, v194, v66
  v_add_f32 v195, v195, v67
  s_waitcnt lgkmcnt(6)
  v_add_f32 v196, v196, v68
  v_add_f32 v197, v197, v69
  v_add_f32 v198, v198, v70
  v_add_f32 v199, v199, v71
  s_waitcnt lgkmcnt(5)
  v_add_f32 v200, v200, v72
  v_add_f32 v201, v201, v73
  v_add_f32 v202, v202, v74
  v_add_f32 v203, v203, v75
  s_waitcnt lgkmcnt(4)
  v_add_f32 v204, v204, v76
  v_add_f32 v205, v205, v77
  v_add_f32 v206, v206, v78
  v_add_f32 v207, v207, v79
  s_waitcnt lgkmcnt(3)
  v_add_f32 v208, v208, v80
  v_add_f32 v209, v209, v81
  v_add_f32 v210, v210, v82
  v_add_f32 v211, v211, v83
  s_waitcnt lgkmcnt(2)
  v_add_f32 v212, v212, v84
  v_add_f32 v213, v213, v85
  v_add_f32 v214, v214, v86
  v_add_f32 v215, v215, v87
  s_waitcnt lgkmcnt(1)
  v_add_f32 v216, v216, v88
  v_add_f32 v217, v217, v89
  v_add_f32 v218, v218, v90
  v_add_f32 v219, v219, v91
  s_waitcnt lgkmcnt(0)
  v_add_f32 v220, v220, v92
  v_add_f32 v221, v221, v93
  v_add_f32 v222, v222, v94
  v_add_f32 v223, v223, v95
Lsolo_135:
  v_lshrrev_b32 v4, 2, v50
  v_lshlrev_b32 v4, 7, v4
  v_and_b32 v5, 3, v50
  v_lshl_add_u32 v4, v5, 4, v4
  v_lshrrev_b32 v5, 1, v51
  v_lshl_add_u32 v4, v5, 6, v4
  v_and_b32 v5, 1, v51
  v_lshl_add_u32 v4, v5, 9, v4
  s_lshl_b32 s4, s68, 12
  s_add_u32 s4, s4, 0xb00000
  v_cvt_pk_bf16_f32 v16, v192, v193
  v_cvt_pk_bf16_f32 v17, v194, v195
  v_cvt_pk_bf16_f32 v18, v196, v197
  v_cvt_pk_bf16_f32 v19, v198, v199
  v_cvt_pk_bf16_f32 v20, v200, v201
  v_cvt_pk_bf16_f32 v21, v202, v203
  v_cvt_pk_bf16_f32 v22, v204, v205
  v_cvt_pk_bf16_f32 v23, v206, v207
  v_cvt_pk_bf16_f32 v24, v208, v209
  v_cvt_pk_bf16_f32 v25, v210, v211
  v_cvt_pk_bf16_f32 v26, v212, v213
  v_cvt_pk_bf16_f32 v27, v214, v215
  v_cvt_pk_bf16_f32 v28, v216, v217
  v_cvt_pk_bf16_f32 v29, v218, v219
  v_cvt_pk_bf16_f32 v30, v220, v221
  v_cvt_pk_bf16_f32 v31, v222, v223
  s_nop 1
  v_permlane16_swap_b32 v16, v18
  v_permlane16_swap_b32 v17, v19
  buffer_store_dwordx4 v[16:19], v4, s[48:51], s4 offen offset:0 sc1
  v_permlane16_swap_b32 v20, v22
  v_permlane16_swap_b32 v21, v23
  buffer_store_dwordx4 v[20:23], v4, s[48:51], s4 offen offset:1024 sc1
  v_permlane16_swap_b32 v24, v26
  v_permlane16_swap_b32 v25, v27
  buffer_store_dwordx4 v[24:27], v4, s[48:51], s4 offen offset:2048 sc1
  v_permlane16_swap_b32 v28, v30
  v_permlane16_swap_b32 v29, v31
  buffer_store_dwordx4 v[28:31], v4, s[48:51], s4 offen offset:3072 sc1
  s_cmp_eq_u32 s3, 7
  s_cbranch_scc1 L7_144
  s_lshl_b32 s6, s68, 7
  s_add_u32 s6, s6, 0xdc0000
  s_waitcnt vmcnt(0)
  v_mov_b32 v10, 0
  v_mov_b32 v11, s1
  s_mov_b64 exec, 1
  buffer_store_dword v11, v10, s[48:51], s6 offen sc1
  s_mov_b64 exec, -1
  s_branch Lfetch_10
L7_144:
  v_mov_b32 v36, 0
  v_mov_b32 v27, 0x7ffffff0
  s_mov_b32 s12, s16
  s_mov_b32 s13, s17
  s_mov_b32 s14, 0x280000
  s_mov_b32 s15, 0x20000
  s_and_b32 s4, s62, 7
  s_mul_i32 s4, s4, 3
  s_lshr_b32 s4, s4, 1
  s_add_u32 s4, s4, 6
  s_cmp_ge_u32 s4, 12
  s_cselect_b32 s5, 12, 0
  s_sub_u32 s4, s4, s5
  s_mul_i32 s66, s63, 245760
  s_add_u32 s66, s66, 0x1000000
  s_add_u32 s69, s66, 61440
  s_mul_i32 s4, s4, 5120
  s_add_u32 s64, s66, s4
  v_lshlrev_b32 v32, 4, v1
  v_add_u32 v33, 4096, v32
Lpoll_146:
  s_sub_u32 s0, s0, 1
  s_cbranch_scc1 Lexit_2
  ds_read_b32 v38, v36 offset:1504
  s_waitcnt lgkmcnt(0)
  v_readfirstlane_b32 s4, v38
  s_cmp_eq_u32 s4, 0
  s_cbranch_scc1 Lok_145
  s_sleep 1
  s_branch Lpoll_146
Lok_145:
  s_branch Lload_g2b
Lfetch_10:
  s_setprio 0
  v_mov_b32 v16, 0
Lpw_148:
  s_sub_u32 s0, s0, 1
  s_cbranch_scc1 Lexit_2
  ds_read_b128 v[12:15], v16 offset:2016
  s_waitcnt lgkmcnt(0)
  v_or_b32 v12, v12, v13
  v_or3_b32 v12, v12, v14, v15
  s_nop 0
  v_readfirstlane_b32 s10, v12
  s_cmp_eq_u32 s10, 0
  s_cbranch_scc1 Lpo_149
  s_sleep 4
  s_branch Lpw_148
Lpo_149:
Lgq_147:
  v_mov_b32 v16, 0
Lpw_150:
  s_sub_u32 s0, s0, 1
  s_cbranch_scc1 Lexit_2
  ds_read_b128 v[12:15], v16 offset:2000
  s_waitcnt lgkmcnt(0)
  v_or_b32 v12, v12, v13
  v_or3_b32 v12, v12, v14, v15
  s_nop 0
  v_readfirstlane_b32 s10, v12
  s_cmp_eq_u32 s10, 0
  s_cbranch_scc1 Lpo_151
  s_sleep 4
  s_branch Lpw_150
Lpo_151:
  s_cmp_eq_u32 s3, 6
  s_cselect_b32 s69, 2048, s69
  s_sub_u32 s8, s3, 4
  s_mul_i32 s4, s63, 80
  s_lshl_b32 s5, s8, 5
  s_add_u32 s4, s4, s5
  s_lshl_b32 s6, s4, 12
  s_lshl_b32 s5, s62, 7
  s_add_u32 s6, s6, s5
  s_add_u32 s6, s6, 0xb00000
  v_lshrrev_b32 v2, 3, v1
  v_and_b32 v3, 7, v1
  v_lshlrev_b32 v4, 12, v2
  v_lshl_add_u32 v4, v3, 4, v4
  v_lshlrev_b32 v13, 7, v1
  s_lshl_b32 s9, s4, 7
  s_add_u32 s9, s9, 0xdc0000
  s_cmp_eq_u32 s3, 6
  s_cselect_b32 exec_lo, 0xffff, -1
  s_mov_b32 exec_hi, 0
Lgp_153:
  s_sub_u32 s0, s0, 1
  s_cbranch_scc1 Lexit_2
  buffer_load_dword v14, v13, s[48:51], s9 offen offset:0 sc1
  s_waitcnt vmcnt(0)
  v_xor_b32 v15, s1, v14
  v_cmp_ne_u32 s[4:5], 0, v15
  s_cmp_eq_u64 s[4:5], 0
  s_cbranch_scc1 Lgd_154
  s_sleep 4
  s_branch Lgp_153
Lgd_154:
  s_mov_b64 exec, -1
  s_add_u32 m0, s69, 0
  s_nop 0
  buffer_load_dwordx4 v4, s[48:51], s6 offen sc1 lds
  s_add_u32 s6, s6, 32768
  s_add_u32 m0, s69, 1024
  s_nop 0
  buffer_load_dwordx4 v4, s[48:51], s6 offen sc1 lds
  s_add_u32 s6, s6, 32768
  s_cmp_eq_u32 s3, 6
  s_cbranch_scc1 Laf_152
  s_add_u32 m0, s69, 2048
  s_nop 0
  buffer_load_dwordx4 v4, s[48:51], s6 offen sc1 lds
  s_add_u32 s6, s6, 32768
  s_add_u32 m0, s69, 3072
  s_nop 0
  buffer_load_dwordx4 v4, s[48:51], s6 offen sc1 lds
  s_add_u32 s6, s6, 32768
Laf_152:
  s_waitcnt vmcnt(0)
  s_endpgm
Lkgen:
  v_mul_f32 v62, v68, v62
  v_mul_f32 v63, v68, v63
  v_mul_f32 v62, 0x3fb8aa3b, v62
  v_mul_f32 v63, 0x3e22f983, v63
  v_mul_f32 v82, 0x41000000, v62
  v_mul_f32 v83, 0x41000000, v63
  v_mul_f32 v84, 0x3f800000, v62
  v_mul_f32 v85, 0x3f800000, v63
  v_mul_f32 v86, 0x43800000, v62
  v_mul_f32 v87, 0x43800000, v63
  v_fract_f32 v83, v83
  v_fract_f32 v85, v85
  v_fract_f32 v87, v87
  v_exp_f32 v82, v82
  v_cos_f32 v76, v83
  v_sin_f32 v77, v83
  v_exp_f32 v84, v84
  v_cos_f32 v74, v85
  v_sin_f32 v75, v85
  v_exp_f32 v86, v86
  v_cos_f32 v78, v87
  v_sin_f32 v79, v87
  v_mul_f32 v64, v68, v64
  v_mul_f32 v65, v68, v65
  v_mul_f32 v76, v76, v82
  v_mul_f32 v77, v77, v82
  v_mul_f32 v74, v74, v84
  v_mul_f32 v75, v75, v84
  v_mul_f32 v78, v78, v86
  v_mul_f32 v79, v79, v86
  v_mul_f32 v96, v66, v64
  v_mul_f32 v97, v67, v64
  v_fma_f32 v96, -v67, v65, v96
  v_fmac_f32 v97, v66, v65
  v_mul_f32 v80, v76, v76
  v_mul_f32 v81, v77, v76
  v_fma_f32 v80, -v77, v77, v80
  v_fmac_f32 v81, v76, v77
  v_mul_f32 v94, v76, v80
  v_mul_f32 v95, v77, v80
  v_mul_f32 v98, v96, v74
  v_mul_f32 v99, v97, v74
  v_mul_f32 v112, v96, v78
  v_mul_f32 v113, v97, v78
  v_cvt_pk_bf16_f32 v152, v72, v76
  v_cvt_pk_bf16_f32 v180, v73, v77
  v_fma_f32 v94, -v77, v81, v94
  v_fmac_f32 v95, v76, v81
  v_fma_f32 v98, -v97, v75, v98
  v_fmac_f32 v99, v96, v75
  v_fma_f32 v112, -v97, v79, v112
  v_fmac_f32 v113, v96, v79
  v_mul_f32 v88, v80, v80
  v_mul_f32 v89, v81, v80
  v_mul_f32 v92, v94, v80
  v_mul_f32 v93, v95, v80
  v_mul_f32 v100, v98, v74
  v_mul_f32 v101, v99, v74
  v_mul_f32 v120, v112, v78
  v_mul_f32 v121, v113, v78
  v_cvt_pk_bf16_f32 v140, v96, v98
  v_cvt_pk_bf16_f32 v168, -v97, -v99
  v_cvt_pk_bf16_f32 v153, v80, v94
  v_cvt_pk_bf16_f32 v181, v81, v95
  v_fma_f32 v88, -v81, v81, v88
  v_fmac_f32 v89, v80, v81
  v_fma_f32 v92, -v95, v81, v92
  v_fmac_f32 v93, v94, v81
  v_fma_f32 v100, -v99, v75, v100
  v_fmac_f32 v101, v98, v75
  v_fma_f32 v120, -v113, v79, v120
  v_fmac_f32 v121, v112, v79
  v_mul_f32 v90, v88, v80
  v_mul_f32 v91, v89, v80
  v_mul_f32 v94, v92, v80
  v_mul_f32 v95, v93, v80
  v_mul_f32 v102, v100, v74
  v_mul_f32 v103, v101, v74
  v_mul_f32 v124, v120, v78
  v_mul_f32 v125, v121, v78
  v_mul_f32 v114, v100, v78
  v_mul_f32 v115, v101, v78
  v_cvt_pk_bf16_f32 v154, v88, v92
  v_cvt_pk_bf16_f32 v182, v89, v93
  v_fma_f32 v90, -v89, v81, v90
  v_fmac_f32 v91, v88, v81
  v_fma_f32 v94, -v93, v81, v94
  v_fmac_f32 v95, v92, v81
  v_fma_f32 v102, -v101, v75, v102
  v_fmac_f32 v103, v100, v75
  v_fma_f32 v124, -v121, v79, v124
  v_fmac_f32 v125, v120, v79
  v_fma_f32 v114, -v101, v79, v114
  v_fmac_f32 v115, v100, v79
  v_mul_f32 v88, v90, v80
  v_mul_f32 v89, v91, v80
  v_mul_f32 v92, v94, v80
  v_mul_f32 v93, v95, v80
  v_mul_f32 v104, v102, v74
  v_mul_f32 v105, v103, v74
  v_mul_f32 v128, v124, v78
  v_mul_f32 v129, v125, v78
  v_cvt_pk_bf16_f32 v141, v100, v102
  v_cvt_pk_bf16_f32 v169, -v101, -v103
  v_cvt_pk_bf16_f32 v144, v112, v114
  v_cvt_pk_bf16_f32 v172, -v113, -v115
  v_cvt_pk_bf16_f32 v155, v90, v94
  v_cvt_pk_bf16_f32 v183, v91, v95
  v_fma_f32 v88, -v91, v81, v88
  v_fmac_f32 v89, v90, v81
  v_fma_f32 v92, -v95, v81, v92
  v_fmac_f32 v93, v94, v81
  v_fma_f32 v104, -v103, v75, v104
  v_fmac_f32 v105, v102, v75
  v_fma_f32 v128, -v125, v79, v128
  v_fmac_f32 v129, v124, v79
  v_mul_f32 v90, v88, v80
  v_mul_f32 v91, v89, v80
  v_mul_f32 v94, v92, v80
  v_mul_f32 v95, v93, v80
  v_mul_f32 v106, v104, v74
  v_mul_f32 v107, v105, v74
  v_mul_f32 v130, v128, v78
  v_mul_f32 v131, v129, v78
  v_mul_f32 v116, v104, v78
  v_mul_f32 v117, v105, v78
  v_cvt_pk_bf16_f32 v156, v88, v92
  v_cvt_pk_bf16_f32 v184, v89, v93
  v_fma_f32 v90, -v89, v81, v90
  v_fmac_f32 v91, v88, v81
  v_fma_f32 v94, -v93, v81, v94
  v_fmac_f32 v95, v92, v81
  v_fma_f32 v106, -v105, v75, v106
  v_fmac_f32 v107, v104, v75
  v_fma_f32 v130, -v129, v79, v130
  v_fmac_f32 v131, v128, v79
  v_fma_f32 v116, -v105, v79, v116
  v_fmac_f32 v117, v104, v79
  v_mul_f32 v88, v90, v80
  v_mul_f32 v89, v91, v80
  v_mul_f32 v92, v94, v80
  v_mul_f32 v93, v95, v80
  v_mul_f32 v108, v106, v74
  v_mul_f32 v109, v107, v74
  v_mul_f32 v132, v130, v78
  v_mul_f32 v133, v131, v78
  v_mul_f32 v122, v116, v78
  v_mul_f32 v123, v117, v78
  v_cvt_pk_bf16_f32 v142, v104, v106
  v_cvt_pk_bf16_f32 v170, -v105, -v107
  v_cvt_pk_bf16_f32 v148, v128, v130
  v_cvt_pk_bf16_f32 v176, -v129, -v131
  v_cvt_pk_bf16_f32 v157, v90, v94
  v_cvt_pk_bf16_f32 v185, v91, v95
  v_fma_f32 v88, -v91, v81, v88
  v_fmac_f32 v89, v90, v81
  v_fma_f32 v92, -v95, v81, v92
  v_fmac_f32 v93, v94, v81
  v_fma_f32 v108, -v107, v75, v108
  v_fmac_f32 v109, v106, v75
  v_fma_f32 v132, -v131, v79, v132
  v_fmac_f32 v133, v130, v79
  v_fma_f32 v122, -v117, v79, v122
  v_fmac_f32 v123, v116, v79
  v_mul_f32 v90, v88, v80
  v_mul_f32 v91, v89, v80
  v_mul_f32 v94, v92, v80
  v_mul_f32 v95, v93, v80
  v_mul_f32 v110, v108, v74
  v_mul_f32 v111, v109, v74
  v_mul_f32 v134, v132, v78
  v_mul_f32 v135, v133, v78
  v_mul_f32 v118, v108, v78
  v_mul_f32 v119, v109, v78
  v_cvt_pk_bf16_f32 v146, v120, v122
  v_cvt_pk_bf16_f32 v174, -v121, -v123
  v_cvt_pk_bf16_f32 v158, v88, v92
  v_cvt_pk_bf16_f32 v186, v89, v93
  v_fma_f32 v90, -v89, v81, v90
  v_fmac_f32 v91, v88, v81
  v_fma_f32 v94, -v93, v81, v94
  v_fmac_f32 v95, v92, v81
  v_fma_f32 v110, -v109, v75, v110
  v_fmac_f32 v111, v108, v75
  v_fma_f32 v134, -v133, v79, v134
  v_fmac_f32 v135, v132, v79
  v_fma_f32 v118, -v109, v79, v118
  v_fmac_f32 v119, v108, v79
  v_mul_f32 v88, v90, v80
  v_mul_f32 v89, v91, v80
  v_mul_f32 v92, v94, v80
  v_mul_f32 v93, v95, v80
  v_mul_f32 v136, v134, v78
  v_mul_f32 v137, v135, v78
  v_mul_f32 v126, v122, v78
  v_mul_f32 v127, v123, v78
  v_cvt_pk_bf16_f32 v143, v108, v110
  v_cvt_pk_bf16_f32 v171, -v109, -v111
  v_cvt_pk_bf16_f32 v145, v116, v118
  v_cvt_pk_bf16_f32 v173, -v117, -v119
  v_cvt_pk_bf16_f32 v149, v132, v134
  v_cvt_pk_bf16_f32 v177, -v133, -v135
  v_cvt_pk_bf16_f32 v159, v90, v94
  v_cvt_pk_bf16_f32 v187, v91, v95
  v_fma_f32 v88, -v91, v81, v88
  v_fmac_f32 v89, v90, v81
  v_fma_f32 v92, -v95, v81, v92
  v_fmac_f32 v93, v94, v81
  v_fma_f32 v136, -v135, v79, v136
  v_fmac_f32 v137, v134, v79
  v_fma_f32 v126, -v123, v79, v126
  v_fmac_f32 v127, v122, v79
  v_mul_f32 v90, v88, v80
  v_mul_f32 v91, v89, v80
  v_mul_f32 v94, v92, v80
  v_mul_f32 v95, v93, v80
  ds_write_b128 v212, v[140:143]
  ds_write_b128 v212, v[168:171] offset:4096
  v_cvt_pk_bf16_f32 v147, v124, v126
  v_cvt_pk_bf16_f32 v175, -v125, -v127
  v_cvt_pk_bf16_f32 v150, v136, v136
  v_cvt_pk_bf16_f32 v178, -v137, -v137
  v_cvt_pk_bf16_f32 v160, v88, v92
  v_cvt_pk_bf16_f32 v188, v89, v93
  v_fma_f32 v90, -v89, v81, v90
  v_fmac_f32 v91, v88, v81
  v_fma_f32 v94, -v93, v81, v94
  v_fmac_f32 v95, v92, v81
  v_mul_f32 v88, v90, v80
  v_mul_f32 v89, v91, v80
  v_mul_f32 v92, v94, v80
  v_mul_f32 v93, v95, v80
  ds_write_b128 v213, v[144:147]
  ds_write_b128 v213, v[172:175] offset:4096
  ds_write_b128 v214, v[148:151]
  v_cvt_pk_bf16_f32 v161, v90, v94
  v_cvt_pk_bf16_f32 v189, v91, v95
  v_fma_f32 v88, -v91, v81, v88
  v_fmac_f32 v89, v90, v81
  v_fma_f32 v92, -v95, v81, v92
  v_fmac_f32 v93, v94, v81
  ds_write_b128 v214, v[176:179] offset:4096
  ds_read_b64_tr_b16 v[96:97], v70 offset:0
  ds_read_b64_tr_b16 v[98:99], v71 offset:256
  v_mul_f32 v90, v88, v80
  v_mul_f32 v91, v89, v80
  v_mul_f32 v94, v92, v80
  v_mul_f32 v95, v93, v80
  ds_read_b64_tr_b16 v[100:101], v70 offset:1024
  ds_read_b64_tr_b16 v[102:103], v71 offset:1280
  ds_read_b64_tr_b16 v[104:105], v70 offset:2048
  v_cvt_pk_bf16_f32 v162, v88, v92
  v_cvt_pk_bf16_f32 v190, v89, v93
  v_fma_f32 v90, -v89, v81, v90
  v_fmac_f32 v91, v88, v81
  v_fma_f32 v94, -v93, v81, v94
  v_fmac_f32 v95, v92, v81
  ds_read_b64_tr_b16 v[106:107], v71 offset:2304
  ds_read_b64_tr_b16 v[108:109], v70 offset:3072
  ds_read_b64_tr_b16 v[110:111], v71 offset:3328
  v_mul_f32 v88, v90, v80
  v_mul_f32 v89, v91, v80
  v_mul_f32 v92, v94, v80
  v_mul_f32 v93, v95, v80
  ds_read_b64_tr_b16 v[112:113], v70 offset:4096
  ds_read_b64_tr_b16 v[114:115], v71 offset:4352
  ds_read_b64_tr_b16 v[116:117], v70 offset:5120
  v_cvt_pk_bf16_f32 v163, v90, v94
  v_cvt_pk_bf16_f32 v191, v91, v95
  v_fma_f32 v88, -v91, v81, v88
  v_fmac_f32 v89, v90, v81
  v_fma_f32 v92, -v95, v81, v92
  v_fmac_f32 v93, v94, v81
  ds_read_b64_tr_b16 v[118:119], v71 offset:5376
  ds_read_b64_tr_b16 v[120:121], v70 offset:6144
  ds_read_b64_tr_b16 v[122:123], v71 offset:6400
  v_mul_f32 v90, v88, v80
  v_mul_f32 v91, v89, v80
  v_mul_f32 v94, v92, v80
  v_mul_f32 v95, v93, v80
  ds_read_b64_tr_b16 v[124:125], v70 offset:7168
  ds_read_b64_tr_b16 v[126:127], v71 offset:7424
  ds_write_b128 v212, v[152:155]
  v_cvt_pk_bf16_f32 v164, v88, v92
  v_cvt_pk_bf16_f32 v192, v89, v93
  v_fma_f32 v90, -v89, v81, v90
  v_fmac_f32 v91, v88, v81
  v_fma_f32 v94, -v93, v81, v94
  v_fmac_f32 v95, v92, v81
  ds_write_b128 v212, v[180:183] offset:4096
  ds_write_b128 v213, v[156:159]
  ds_write_b128 v213, v[184:187] offset:4096
  v_mul_f32 v88, v90, v80
  v_mul_f32 v89, v91, v80
  v_mul_f32 v92, v94, v80
  v_mul_f32 v93, v95, v80
  ds_write_b128 v214, v[160:163]
  ds_write_b128 v214, v[188:191] offset:4096
  v_cvt_pk_bf16_f32 v165, v90, v94
  v_cvt_pk_bf16_f32 v193, v91, v95
  v_fma_f32 v88, -v91, v81, v88
  v_fmac_f32 v89, v90, v81
  v_fma_f32 v92, -v95, v81, v92
  v_fmac_f32 v93, v94, v81
  v_mul_f32 v90, v88, v80
  v_mul_f32 v91, v89, v80
  v_mul_f32 v94, v92, v80
  v_mul_f32 v95, v93, v80
  v_cvt_pk_bf16_f32 v166, v88, v92
  v_cvt_pk_bf16_f32 v194, v89, v93
  v_fma_f32 v90, -v89, v81, v90
  v_fmac_f32 v91, v88, v81
  v_fma_f32 v94, -v93, v81, v94
  v_fmac_f32 v95, v92, v81
  v_cvt_pk_bf16_f32 v167, v90, v94
  v_cvt_pk_bf16_f32 v195, v91, v95
  ds_write_b128 v215, v[164:167]
  ds_write_b128 v215, v[192:195] offset:4096
  ds_read_b64_tr_b16 v[140:141], v70 offset:0
  ds_read_b64_tr_b16 v[142:143], v71 offset:256
  ds_read_b64_tr_b16 v[144:145], v70 offset:1024
  ds_read_b64_tr_b16 v[146:147], v71 offset:1280
  ds_read_b64_tr_b16 v[148:149], v70 offset:2048
  ds_read_b64_tr_b16 v[150:151], v71 offset:2304
  ds_read_b64_tr_b16 v[152:153], v70 offset:3072
  ds_read_b64_tr_b16 v[154:155], v71 offset:3328
  ds_read_b64_tr_b16 v[156:157], v70 offset:4096
  ds_read_b64_tr_b16 v[158:159], v71 offset:4352
  ds_read_b64_tr_b16 v[160:161], v70 offset:5120
  ds_read_b64_tr_b16 v[162:163], v71 offset:5376
  ds_read_b64_tr_b16 v[164:165], v70 offset:6144
  ds_read_b64_tr_b16 v[166:167], v71 offset:6400
  ds_read_b64_tr_b16 v[168:169], v70 offset:7168
  ds_read_b64_tr_b16 v[170:171], v71 offset:7424
  s_setprio 3
  s_waitcnt lgkmcnt(14)
  v_mfma_f32_32x32x16_bf16 v[196:211], v[96:99], v[140:143], v[196:211]
  s_waitcnt lgkmcnt(12)
  v_mfma_f32_32x32x16_bf16 v[196:211], v[100:103], v[144:147], v[196:211]
  s_waitcnt lgkmcnt(10)
  v_mfma_f32_32x32x16_bf16 v[196:211], v[104:107], v[148:151], v[196:211]
  s_waitcnt lgkmcnt(8)
  v_mfma_f32_32x32x16_bf16 v[196:211], v[108:111], v[152:155], v[196:211]
  s_waitcnt lgkmcnt(6)
  v_mfma_f32_32x32x16_bf16 v[196:211], v[112:115], v[156:159], v[196:211]
  s_waitcnt lgkmcnt(4)
  v_mfma_f32_32x32x16_bf16 v[196:211], v[116:119], v[160:163], v[196:211]
  s_waitcnt lgkmcnt(2)
  v_mfma_f32_32x32x16_bf16 v[196:211], v[120:123], v[164:167], v[196:211]
  s_waitcnt lgkmcnt(0)
  v_mfma_f32_32x32x16_bf16 v[196:211], v[124:127], v[168:171], v[196:211]
  s_setprio 0
  s_setpc_b64 s[34:35]
Lconv:
  s_and_b32 s4, s12, 2
  s_lshl_b32 s4, s4, 2
  v_mov_b32 v16, s4
Lkw_155:
  s_sub_u32 s0, s0, 1
  s_cbranch_scc1 Lexit_2
  ds_read_b64 v[14:15], v16 offset:64
  s_waitcnt lgkmcnt(0)
  v_and_b32 v14, v14, v15
  s_nop 0
  v_readfirstlane_b32 s10, v14
  s_cmp_lg_u32 s10, 0
  s_cbranch_scc1 Lko_156
  s_sleep 1
  s_branch Lkw_155
Lko_156:
  s_lshl_b32 s4, s3, 2
  v_mov_b32 v10, s4
Lpoll_158:
  s_sub_u32 s0, s0, 1
  s_cbranch_scc1 Lexit_2
  ds_read_b32 v11, v10 offset:16
  s_waitcnt lgkmcnt(0)
  v_readfirstlane_b32 s10, v11
  s_cmp_lg_u32 s10, 0
  s_cbranch_scc1 Lok_157
  s_sleep 2
  s_branch Lpoll_158
Lok_157:
  s_setprio 3
Lcv_159:
  ds_read_b64 v[64:65], v48 offset:3776
  ds_read_b64 v[66:67], v48 offset:3784
  ds_read_b128 v[128:131], v49 offset:17120
  ds_read_b64 v[68:69], v48 offset:3264
  ds_read_b64 v[70:71], v48 offset:3272
  ds_read_b128 v[132:135], v49 offset:17632
  ds_read_b64 v[72:73], v48 offset:2752
  ds_read_b64 v[74:75], v48 offset:2760
  ds_read_b128 v[136:139], v49 offset:18144
  ds_read_b64 v[76:77], v48 offset:2240
  ds_read_b64 v[78:79], v48 offset:2248
  ds_read_b128 v[140:143], v49 offset:18656
  s_waitcnt lgkmcnt(10)
  s_waitcnt lgkmcnt(9)
  v_mfma_f32_16x16x32_bf16 v[192:195], v[64:67], v[128:131], v[192:195]
  ds_read_b64 v[80:81], v48 offset:1728
  ds_read_b64 v[82:83], v48 offset:1736
  s_waitcnt lgkmcnt(8)
  v_mfma_f32_16x16x32_bf16 v[196:199], v[64:67], v[132:135], v[196:199]
  v_mfma_f32_16x16x32_bf16 v[196:199], v[68:71], v[128:131], v[196:199]
  ds_read_b128 v[144:147], v49 offset:19168
  v_mfma_f32_16x16x32_bf16 v[200:203], v[68:71], v[132:135], v[200:203]
  s_waitcnt lgkmcnt(6)
  v_mfma_f32_16x16x32_bf16 v[200:203], v[64:67], v[136:139], v[200:203]
  ds_read_b64 v[84:85], v48 offset:1216
  ds_read_b64 v[86:87], v48 offset:1224
  v_mfma_f32_16x16x32_bf16 v[204:207], v[68:71], v[136:139], v[204:207]
  v_mfma_f32_16x16x32_bf16 v[200:203], v[72:75], v[128:131], v[200:203]
  ds_read_b128 v[148:151], v49 offset:19680
  v_mfma_f32_16x16x32_bf16 v[204:207], v[72:75], v[132:135], v[204:207]
  v_mfma_f32_16x16x32_bf16 v[208:211], v[72:75], v[136:139], v[208:211]
  ds_read_b64 v[88:89], v48 offset:704
  ds_read_b64 v[90:91], v48 offset:712
  s_waitcnt lgkmcnt(8)
  v_mfma_f32_16x16x32_bf16 v[204:207], v[64:67], v[140:143], v[204:207]
  v_mfma_f32_16x16x32_bf16 v[208:211], v[68:71], v[140:143], v[208:211]
  ds_read_b128 v[152:155], v49 offset:20192
  v_mfma_f32_16x16x32_bf16 v[212:215], v[72:75], v[140:143], v[212:215]
  v_mfma_f32_16x16x32_bf16 v[204:207], v[76:79], v[128:131], v[204:207]
  ds_read_b64 v[92:93], v48 offset:192
  ds_read_b64 v[94:95], v48 offset:200
  v_mfma_f32_16x16x32_bf16 v[208:211], v[76:79], v[132:135], v[208:211]
  v_mfma_f32_16x16x32_bf16 v[212:215], v[76:79], v[136:139], v[212:215]
  ds_read_b128 v[156:159], v49 offset:20704
  v_mfma_f32_16x16x32_bf16 v[216:219], v[76:79], v[140:143], v[216:219]
  s_waitcnt lgkmcnt(9)
  v_mfma_f32_16x16x32_bf16 v[208:211], v[64:67], v[144:147], v[208:211]
  ds_read_b64 v[96:97], v48 offset:3712
  ds_read_b64 v[98:99], v48 offset:3720
  v_mfma_f32_16x16x32_bf16 v[212:215], v[68:71], v[144:147], v[212:215]
  v_mfma_f32_16x16x32_bf16 v[216:219], v[72:75], v[144:147], v[216:219]
  ds_read_b128 v[160:163], v49 offset:17056
  v_mfma_f32_16x16x32_bf16 v[220:223], v[76:79], v[144:147], v[220:223]
  v_mfma_f32_16x16x32_bf16 v[208:211], v[80:83], v[128:131], v[208:211]
  ds_read_b64 v[100:101], v48 offset:3200
  ds_read_b64 v[102:103], v48 offset:3208
  v_mfma_f32_16x16x32_bf16 v[212:215], v[80:83], v[132:135], v[212:215]
  v_mfma_f32_16x16x32_bf16 v[216:219], v[80:83], v[136:139], v[216:219]
  v_mfma_f32_16x16x32_bf16 v[220:223], v[80:83], v[140:143], v[220:223]
  s_waitcnt lgkmcnt(11)
  v_mfma_f32_16x16x32_bf16 v[212:215], v[64:67], v[148:151], v[212:215]
  ds_read_b128 v[164:167], v49 offset:17568
  v_mfma_f32_16x16x32_bf16 v[216:219], v[68:71], v[148:151], v[216:219]
  v_mfma_f32_16x16x32_bf16 v[220:223], v[72:75], v[148:151], v[220:223]
  ds_read_b64 v[104:105], v48 offset:2688
  ds_read_b64 v[106:107], v48 offset:2696
  v_mfma_f32_16x16x32_bf16 v[212:215], v[84:87], v[128:131], v[212:215]
  v_mfma_f32_16x16x32_bf16 v[216:219], v[84:87], v[132:135], v[216:219]
  v_mfma_f32_16x16x32_bf16 v[220:223], v[84:87], v[136:139], v[220:223]
  s_waitcnt lgkmcnt(11)
  v_mfma_f32_16x16x32_bf16 v[216:219], v[64:67], v[152:155], v[216:219]
  ds_read_b128 v[168:171], v49 offset:18080
  v_mfma_f32_16x16x32_bf16 v[220:223], v[68:71], v[152:155], v[220:223]
  v_mfma_f32_16x16x32_bf16 v[216:219], v[88:91], v[128:131], v[216:219]
  ds_read_b64 v[108:109], v48 offset:2176
  ds_read_b64 v[110:111], v48 offset:2184
  v_mfma_f32_16x16x32_bf16 v[220:223], v[88:91], v[132:135], v[220:223]
  s_waitcnt lgkmcnt(11)
  v_mfma_f32_16x16x32_bf16 v[220:223], v[64:67], v[156:159], v[220:223]
  ds_read_b128 v[172:175], v49 offset:18592
  v_mfma_f32_16x16x32_bf16 v[220:223], v[92:95], v[128:131], v[220:223]
  s_waitcnt lgkmcnt(10)
  s_waitcnt lgkmcnt(9)
  v_mfma_f32_16x16x32_bf16 v[192:195], v[96:99], v[160:163], v[192:195]
  ds_read_b64 v[112:113], v48 offset:1664
  ds_read_b64 v[114:115], v48 offset:1672
  s_waitcnt lgkmcnt(8)
  v_mfma_f32_16x16x32_bf16 v[196:199], v[96:99], v[164:167], v[196:199]
  v_mfma_f32_16x16x32_bf16 v[196:199], v[100:103], v[160:163], v[196:199]
  ds_read_b128 v[176:179], v49 offset:19104
  v_mfma_f32_16x16x32_bf16 v[200:203], v[100:103], v[164:167], v[200:203]
  s_waitcnt lgkmcnt(6)
  v_mfma_f32_16x16x32_bf16 v[200:203], v[96:99], v[168:171], v[200:203]
  ds_read_b64 v[116:117], v48 offset:1152
  ds_read_b64 v[118:119], v48 offset:1160
  v_mfma_f32_16x16x32_bf16 v[204:207], v[100:103], v[168:171], v[204:207]
  v_mfma_f32_16x16x32_bf16 v[200:203], v[104:107], v[160:163], v[200:203]
  ds_read_b128 v[180:183], v49 offset:19616
  v_mfma_f32_16x16x32_bf16 v[204:207], v[104:107], v[164:167], v[204:207]
  v_mfma_f32_16x16x32_bf16 v[208:211], v[104:107], v[168:171], v[208:211]
  ds_read_b64 v[120:121], v48 offset:640
  ds_read_b64 v[122:123], v48 offset:648
  s_waitcnt lgkmcnt(8)
  v_mfma_f32_16x16x32_bf16 v[204:207], v[96:99], v[172:175], v[204:207]
  v_mfma_f32_16x16x32_bf16 v[208:211], v[100:103], v[172:175], v[208:211]
  ds_read_b128 v[184:187], v49 offset:20128
  v_mfma_f32_16x16x32_bf16 v[212:215], v[104:107], v[172:175], v[212:215]
  v_mfma_f32_16x16x32_bf16 v[204:207], v[108:111], v[160:163], v[204:207]
  ds_read_b64 v[124:125], v48 offset:128
  ds_read_b64 v[126:127], v48 offset:136
  v_mfma_f32_16x16x32_bf16 v[208:211], v[108:111], v[164:167], v[208:211]
  v_mfma_f32_16x16x32_bf16 v[212:215], v[108:111], v[168:171], v[212:215]
  ds_read_b128 v[188:191], v49 offset:20640
  v_mfma_f32_16x16x32_bf16 v[216:219], v[108:111], v[172:175], v[216:219]
  s_waitcnt lgkmcnt(9)
  v_mfma_f32_16x16x32_bf16 v[208:211], v[96:99], v[176:179], v[208:211]
  ds_read_b64 v[64:65], v48 offset:3648
  ds_read_b64 v[66:67], v48 offset:3656
  v_mfma_f32_16x16x32_bf16 v[212:215], v[100:103], v[176:179], v[212:215]
  v_mfma_f32_16x16x32_bf16 v[216:219], v[104:107], v[176:179], v[216:219]
  ds_read_b128 v[128:131], v49 offset:16992
  v_mfma_f32_16x16x32_bf16 v[220:223], v[108:111], v[176:179], v[220:223]
  v_mfma_f32_16x16x32_bf16 v[208:211], v[112:115], v[160:163], v[208:211]
  ds_read_b64 v[68:69], v48 offset:3136
  ds_read_b64 v[70:71], v48 offset:3144
  v_mfma_f32_16x16x32_bf16 v[212:215], v[112:115], v[164:167], v[212:215]
  v_mfma_f32_16x16x32_bf16 v[216:219], v[112:115], v[168:171], v[216:219]
  v_mfma_f32_16x16x32_bf16 v[220:223], v[112:115], v[172:175], v[220:223]
  s_waitcnt lgkmcnt(11)
  v_mfma_f32_16x16x32_bf16 v[212:215], v[96:99], v[180:183], v[212:215]
  ds_read_b128 v[132:135], v49 offset:17504
  v_mfma_f32_16x16x32_bf16 v[216:219], v[100:103], v[180:183], v[216:219]
  v_mfma_f32_16x16x32_bf16 v[220:223], v[104:107], v[180:183], v[220:223]
  ds_read_b64 v[72:73], v48 offset:2624
  ds_read_b64 v[74:75], v48 offset:2632
  v_mfma_f32_16x16x32_bf16 v[212:215], v[116:119], v[160:163], v[212:215]
  v_mfma_f32_16x16x32_bf16 v[216:219], v[116:119], v[164:167], v[216:219]
  v_mfma_f32_16x16x32_bf16 v[220:223], v[116:119], v[168:171], v[220:223]
  s_waitcnt lgkmcnt(11)
  v_mfma_f32_16x16x32_bf16 v[216:219], v[96:99], v[184:187], v[216:219]
  ds_read_b128 v[136:139], v49 offset:18016
  v_mfma_f32_16x16x32_bf16 v[220:223], v[100:103], v[184:187], v[220:223]
  v_mfma_f32_16x16x32_bf16 v[216:219], v[120:123], v[160:163], v[216:219]
  ds_read_b64 v[76:77], v48 offset:2112
  ds_read_b64 v[78:79], v48 offset:2120
  v_mfma_f32_16x16x32_bf16 v[220:223], v[120:123], v[164:167], v[220:223]
  s_waitcnt lgkmcnt(11)
  v_mfma_f32_16x16x32_bf16 v[220:223], v[96:99], v[188:191], v[220:223]
  ds_read_b128 v[140:143], v49 offset:18528
  v_mfma_f32_16x16x32_bf16 v[220:223], v[124:127], v[160:163], v[220:223]
  s_waitcnt lgkmcnt(10)
  s_waitcnt lgkmcnt(9)
  v_mfma_f32_16x16x32_bf16 v[192:195], v[64:67], v[128:131], v[192:195]
  ds_read_b64 v[80:81], v48 offset:1600
  ds_read_b64 v[82:83], v48 offset:1608
  s_waitcnt lgkmcnt(8)
  v_mfma_f32_16x16x32_bf16 v[196:199], v[64:67], v[132:135], v[196:199]
  v_mfma_f32_16x16x32_bf16 v[196:199], v[68:71], v[128:131], v[196:199]
  ds_read_b128 v[144:147], v49 offset:19040
  v_mfma_f32_16x16x32_bf16 v[200:203], v[68:71], v[132:135], v[200:203]
  s_waitcnt lgkmcnt(6)
  v_mfma_f32_16x16x32_bf16 v[200:203], v[64:67], v[136:139], v[200:203]
  ds_read_b64 v[84:85], v48 offset:1088
  ds_read_b64 v[86:87], v48 offset:1096
  v_mfma_f32_16x16x32_bf16 v[204:207], v[68:71], v[136:139], v[204:207]
  v_mfma_f32_16x16x32_bf16 v[200:203], v[72:75], v[128:131], v[200:203]
  ds_read_b128 v[148:151], v49 offset:19552
  v_mfma_f32_16x16x32_bf16 v[204:207], v[72:75], v[132:135], v[204:207]
  v_mfma_f32_16x16x32_bf16 v[208:211], v[72:75], v[136:139], v[208:211]
  ds_read_b64 v[88:89], v48 offset:576
  ds_read_b64 v[90:91], v48 offset:584
  s_waitcnt lgkmcnt(8)
  v_mfma_f32_16x16x32_bf16 v[204:207], v[64:67], v[140:143], v[204:207]
  v_mfma_f32_16x16x32_bf16 v[208:211], v[68:71], v[140:143], v[208:211]
  ds_read_b128 v[152:155], v49 offset:20064
  v_mfma_f32_16x16x32_bf16 v[212:215], v[72:75], v[140:143], v[212:215]
  v_mfma_f32_16x16x32_bf16 v[204:207], v[76:79], v[128:131], v[204:207]
  ds_read_b64 v[92:93], v48 offset:64
  ds_read_b64 v[94:95], v48 offset:72
  v_mfma_f32_16x16x32_bf16 v[208:211], v[76:79], v[132:135], v[208:211]
  v_mfma_f32_16x16x32_bf16 v[212:215], v[76:79], v[136:139], v[212:215]
  ds_read_b128 v[156:159], v49 offset:20576
  v_mfma_f32_16x16x32_bf16 v[216:219], v[76:79], v[140:143], v[216:219]
  s_waitcnt lgkmcnt(9)
  v_mfma_f32_16x16x32_bf16 v[208:211], v[64:67], v[144:147], v[208:211]
  ds_read_b64 v[96:97], v48 offset:3584
  ds_read_b64 v[98:99], v48 offset:3592
  v_mfma_f32_16x16x32_bf16 v[212:215], v[68:71], v[144:147], v[212:215]
  v_mfma_f32_16x16x32_bf16 v[216:219], v[72:75], v[144:147], v[216:219]
  ds_read_b128 v[160:163], v49 offset:16928
  v_mfma_f32_16x16x32_bf16 v[220:223], v[76:79], v[144:147], v[220:223]
  v_mfma_f32_16x16x32_bf16 v[208:211], v[80:83], v[128:131], v[208:211]
  ds_read_b64 v[100:101], v48 offset:3072
  ds_read_b64 v[102:103], v48 offset:3080
  v_mfma_f32_16x16x32_bf16 v[212:215], v[80:83], v[132:135], v[212:215]
  v_mfma_f32_16x16x32_bf16 v[216:219], v[80:83], v[136:139], v[216:219]
  v_mfma_f32_16x16x32_bf16 v[220:223], v[80:83], v[140:143], v[220:223]
  s_waitcnt lgkmcnt(11)
  v_mfma_f32_16x16x32_bf16 v[212:215], v[64:67], v[148:151], v[212:215]
  ds_read_b128 v[164:167], v49 offset:17440
  v_mfma_f32_16x16x32_bf16 v[216:219], v[68:71], v[148:151], v[216:219]
  v_mfma_f32_16x16x32_bf16 v[220:223], v[72:75], v[148:151], v[220:223]
  ds_read_b64 v[104:105], v48 offset:2560
  ds_read_b64 v[106:107], v48 offset:2568
  v_mfma_f32_16x16x32_bf16 v[212:215], v[84:87], v[128:131], v[212:215]
  v_mfma_f32_16x16x32_bf16 v[216:219], v[84:87], v[132:135], v[216:219]
  v_mfma_f32_16x16x32_bf16 v[220:223], v[84:87], v[136:139], v[220:223]
  s_waitcnt lgkmcnt(11)
  v_mfma_f32_16x16x32_bf16 v[216:219], v[64:67], v[152:155], v[216:219]
  ds_read_b128 v[168:171], v49 offset:17952
  v_mfma_f32_16x16x32_bf16 v[220:223], v[68:71], v[152:155], v[220:223]
  v_mfma_f32_16x16x32_bf16 v[216:219], v[88:91], v[128:131], v[216:219]
  ds_read_b64 v[108:109], v48 offset:2048
  ds_read_b64 v[110:111], v48 offset:2056
  v_mfma_f32_16x16x32_bf16 v[220:223], v[88:91], v[132:135], v[220:223]
  s_waitcnt lgkmcnt(11)
  v_mfma_f32_16x16x32_bf16 v[220:223], v[64:67], v[156:159], v[220:223]
  ds_read_b128 v[172:175], v49 offset:18464
  v_mfma_f32_16x16x32_bf16 v[220:223], v[92:95], v[128:131], v[220:223]
  s_waitcnt lgkmcnt(10)
  s_waitcnt lgkmcnt(9)
  v_mfma_f32_16x16x32_bf16 v[192:195], v[96:99], v[160:163], v[192:195]
  ds_read_b64 v[112:113], v48 offset:1536
  ds_read_b64 v[114:115], v48 offset:1544
  s_waitcnt lgkmcnt(8)
  v_mfma_f32_16x16x32_bf16 v[196:199], v[96:99], v[164:167], v[196:199]
  v_mfma_f32_16x16x32_bf16 v[196:199], v[100:103], v[160:163], v[196:199]
  ds_read_b128 v[176:179], v49 offset:18976
  v_mfma_f32_16x16x32_bf16 v[200:203], v[100:103], v[164:167], v[200:203]
  s_waitcnt lgkmcnt(6)
  v_mfma_f32_16x16x32_bf16 v[200:203], v[96:99], v[168:171], v[200:203]
  ds_read_b64 v[116:117], v48 offset:1024
  ds_read_b64 v[118:119], v48 offset:1032
  v_mfma_f32_16x16x32_bf16 v[204:207], v[100:103], v[168:171], v[204:207]
  v_mfma_f32_16x16x32_bf16 v[200:203], v[104:107], v[160:163], v[200:203]
  ds_read_b128 v[180:183], v49 offset:19488
  v_mfma_f32_16x16x32_bf16 v[204:207], v[104:107], v[164:167], v[204:207]
  v_mfma_f32_16x16x32_bf16 v[208:211], v[104:107], v[168:171], v[208:211]
  ds_read_b64 v[120:121], v48 offset:512
  ds_read_b64 v[122:123], v48 offset:520
  s_waitcnt lgkmcnt(8)
  v_mfma_f32_16x16x32_bf16 v[204:207], v[96:99], v[172:175], v[204:207]
  v_mfma_f32_16x16x32_bf16 v[208:211], v[100:103], v[172:175], v[208:211]
  ds_read_b128 v[184:187], v49 offset:20000
  v_mfma_f32_16x16x32_bf16 v[212:215], v[104:107], v[172:175], v[212:215]
  v_mfma_f32_16x16x32_bf16 v[204:207], v[108:111], v[160:163], v[204:207]
  ds_read_b64 v[124:125], v48 offset:0
  ds_read_b64 v[126:127], v48 offset:8
  v_mfma_f32_16x16x32_bf16 v[208:211], v[108:111], v[164:167], v[208:211]
  v_mfma_f32_16x16x32_bf16 v[212:215], v[108:111], v[168:171], v[212:215]
  ds_read_b128 v[188:191], v49 offset:20512
  v_mfma_f32_16x16x32_bf16 v[216:219], v[108:111], v[172:175], v[216:219]
  s_waitcnt lgkmcnt(9)
  v_mfma_f32_16x16x32_bf16 v[208:211], v[96:99], v[176:179], v[208:211]
  v_mfma_f32_16x16x32_bf16 v[212:215], v[100:103], v[176:179], v[212:215]
  v_mfma_f32_16x16x32_bf16 v[216:219], v[104:107], v[176:179], v[216:219]
  v_mfma_f32_16x16x32_bf16 v[220:223], v[108:111], v[176:179], v[220:223]
  v_mfma_f32_16x16x32_bf16 v[208:211], v[112:115], v[160:163], v[208:211]
  v_mfma_f32_16x16x32_bf16 v[212:215], v[112:115], v[164:167], v[212:215]
  v_mfma_f32_16x16x32_bf16 v[216:219], v[112:115], v[168:171], v[216:219]
  v_mfma_f32_16x16x32_bf16 v[220:223], v[112:115], v[172:175], v[220:223]
  s_waitcnt lgkmcnt(6)
  v_mfma_f32_16x16x32_bf16 v[212:215], v[96:99], v[180:183], v[212:215]
  v_mfma_f32_16x16x32_bf16 v[216:219], v[100:103], v[180:183], v[216:219]
  v_mfma_f32_16x16x32_bf16 v[220:223], v[104:107], v[180:183], v[220:223]
  v_mfma_f32_16x16x32_bf16 v[212:215], v[116:119], v[160:163], v[212:215]
  v_mfma_f32_16x16x32_bf16 v[216:219], v[116:119], v[164:167], v[216:219]
  v_mfma_f32_16x16x32_bf16 v[220:223], v[116:119], v[168:171], v[220:223]
  s_waitcnt lgkmcnt(3)
  v_mfma_f32_16x16x32_bf16 v[216:219], v[96:99], v[184:187], v[216:219]
  v_mfma_f32_16x16x32_bf16 v[220:223], v[100:103], v[184:187], v[220:223]
  v_mfma_f32_16x16x32_bf16 v[216:219], v[120:123], v[160:163], v[216:219]
  v_mfma_f32_16x16x32_bf16 v[220:223], v[120:123], v[164:167], v[220:223]
  s_waitcnt lgkmcnt(0)
  v_mfma_f32_16x16x32_bf16 v[220:223], v[96:99], v[188:191], v[220:223]
  v_mfma_f32_16x16x32_bf16 v[220:223], v[124:127], v[160:163], v[220:223]
  v_subrev_u32 v48, 256, v48
  v_subrev_u32 v49, 256, v49
  s_sub_u32 s14, s14, 1
  s_cmp_lg_u32 s14, 0
  s_cbranch_scc1 Lcv_159
  s_setpc_b64 s[34:35]
Lcode_end:
.section .rodata,"a"
.p2align 6
.amdhsa_kernel parallel_sum__ssm_conv_s4__swiglu_ffn__prompt_kernel
  .amdhsa_next_free_vgpr 256
  .amdhsa_next_free_sgpr 102
  .amdhsa_accum_offset 256
  .amdhsa_group_segment_fixed_size 0
  .amdhsa_kernarg_size 128
  .amdhsa_user_sgpr_count 2
  .amdhsa_user_sgpr_kernarg_segment_ptr 1
  .amdhsa_system_sgpr_workgroup_id_x 1
.end_amdhsa_kernel
```
